```python
import torch

def _softmax(x, axis=-1):
    return torch.softmax(x, dim=axis)
def _gelu(x):
    return torch.nn.functional.gelu(x, approximate="tanh")
def _silu(x):
    return torch.nn.functional.silu(x)
def _sigmoid(x):
    return torch.sigmoid(x)
def _layernorm(x, axis=-1, eps=1e-5):
    m = x.mean(dim=axis, keepdim=True)
    v = x.var(dim=axis, keepdim=True, unbiased=False)
    return (x - m) / torch.sqrt(v + eps)
def _scatter_add(tgt, idx, src, axis=0):
    return tgt.clone().index_add_(axis, idx, src)
def _segment_sum(src, seg, n):
    out = torch.zeros((n,) + src.shape[1:], dtype=src.dtype)
    return out.index_add_(0, seg, src)
def _pad(x, pw):
    flat = tuple(v for pair in reversed(pw) for v in pair)
    return torch.nn.functional.pad(x, flat)

kernel_name = 'parallel_sum__softmax_full_mha__glu_gated_glu__prompt'

def setup_inputs():

    _w = (lambda a: (lambda t: t.to(torch.bfloat16) if t.is_floating_point() else t)(torch.as_tensor(a)))
    def _A_setup():
        B, S, D = 1, 2048, 512
        return {
            "x": _w((lambda *s: torch.randn(*s, dtype=torch.bfloat16) * 0.05)(B, S, D)),
            "wqkv": _w((lambda *s: torch.randn(*s, dtype=torch.bfloat16) * 0.2)(D, 3 * D)),
            "wo": _w((lambda *s: torch.randn(*s, dtype=torch.bfloat16) * 0.1)(D, D)),
        }
    _A_in = _A_setup()

    def _B_setup():
        B, S, D, F = 1, 2048, 512, 1792
        return {
            "x": _w((lambda *s: torch.randn(*s, dtype=torch.bfloat16) * 0.05)(B, S, D)),
            "w_gate": _w((lambda *s: torch.randn(*s, dtype=torch.bfloat16) * 0.8)(D, F)),
            "w_up": _w((lambda *s: torch.randn(*s, dtype=torch.bfloat16) * 0.2)(D, F)),
            "w_down": _w((lambda *s: torch.randn(*s, dtype=torch.bfloat16) * 0.2)(F, D)),
        }
    _B_in = _B_setup()

    return {
        "A_x": _A_in["x"],
        "A_wqkv": _A_in["wqkv"],
        "A_wo": _A_in["wo"],
        "B_x": _B_in["x"],
        "B_w_gate": _B_in["w_gate"],
        "B_w_up": _B_in["w_up"],
        "B_w_down": _B_in["w_down"],
    }

def reference(A_x, A_wqkv, A_wo, B_x, B_w_gate, B_w_up, B_w_down):
    def _A_ref(x, wqkv, wo):
        B, S, D = x.shape
        H = 32; Dh = D // H
        qkv = (lambda x, *d: x.permute(*d))((x @ wqkv).reshape(B, S, 3, H, Dh), 2, 0, 3, 1, 4)
        q, k, v = qkv[0], qkv[1], qkv[2]
        scale = Dh ** -0.5
        scores = torch.einsum("bhqd,bhkd->bhqk", q, k) * scale
        p = _softmax(scores, axis=-1)
        o = torch.einsum("bhqk,bhkd->bhqd", p, v)
        return (lambda x, *d: x.permute(*d))(o, 0, 2, 1, 3).reshape(B, S, D) @ wo

    def _B_ref(x, w_gate, w_up, w_down):
        g = torch.einsum("bsd,df->bsf", x, w_gate)
        u = torch.einsum("bsd,df->bsf", x, w_up)
        h = _sigmoid(g) * u
        return torch.einsum("bsf,fd->bsd", h, w_down)

    x = A_x
    xn = _layernorm(x, axis=-1)
    return x + _A_ref(xn, A_wqkv, A_wo) + _B_ref(xn, B_w_gate, B_w_up, B_w_down)
```

```asm
; @launch kernel=f1_fused_kernel grid=(512,1,1) block=(256,1,1) lds=81920
.amdgcn_target "amdgcn-amd-amdhsa--gfx950"
.text
.globl f1_fused_kernel
.p2align 8
.type f1_fused_kernel,@function
f1_fused_kernel:
    s_cmp_ge_u32 s2, 512
    s_cbranch_scc1 L_end_f1_fused_kernel
    s_load_dwordx2 s[8:9], s[0:1], 0
    s_load_dwordx2 s[20:21], s[0:1], 72
    s_load_dwordx2 s[56:57], s[0:1], 64
    v_lshrrev_b32 v10, 6, v0
    s_nop 1
    v_readfirstlane_b32 s24, v10
    s_cmp_ge_u32 s2, 256
    s_cbranch_scc1 L_f1_g
    s_load_dwordx2 s[12:13], s[0:1], 8
    s_mov_b32 s10, 0x200000
    s_mov_b32 s11, 0x00020000
    s_mov_b32 s22, 0x1300000
    s_mov_b32 s23, 0x00020000
    s_mov_b32 s14, 0x180000
    s_mov_b32 s15, 0x00020000
    s_setprio 3
    s_and_b32 s3, s2, 7
    s_lshr_b32 s4, s2, 3
    s_and_b32 s5, s3, 1
    s_lshl_b32 s26, s5, 2
    s_and_b32 s5, s4, 3
    s_add_u32 s26, s26, s5
    s_lshr_b32 s25, s3, 1
    s_lshl_b32 s25, s25, 3
    s_lshr_b32 s5, s4, 2
    s_add_u32 s25, s25, s5
    s_and_b32 s53, s26, 3
    s_lshl_b32 s53, s53, 1
    s_add_u32 s53, s53, s25
    s_and_b32 s53, s53, 7
    s_lshl_b32 s44, s3, 2
    s_and_b32 s5, s4, 3
    s_add_u32 s44, s44, s5
    s_lshr_b32 s45, s4, 2
    v_and_b32 v1, 63, v0
    v_and_b32 v11, 31, v1
    v_lshrrev_b32 v12, 5, v1
    s_and_b32 s27, s24, 1
    s_lshr_b32 s28, s24, 1
    v_lshrrev_b32 v13, 3, v1
    v_lshrrev_b32 v14, 4, v1
    v_and_b32 v15, 7, v1
    v_xor_b32 v7, v15, v14
    v_lshlrev_b32 v7, 4, v7
    v_lshl_add_u32 v7, v13, 10, v7
    s_lshl_b32 s29, s25, 16
    s_lshl_b32 s30, s24, 14
    s_add_u32 s29, s29, s30
    v_add_u32 v7, s29, v7
    v_xor_b32 v8, 64, v7
    v_add_u32 v8, 8192, v8
    v_and_b32 v14, 1, v14
    v_lshlrev_b32 v14, 2, v14
    v_xor_b32 v9, v15, v14
    v_lshlrev_b32 v9, 4, v9
    s_lshl_b32 s30, s24, 3
    v_add_u32 v13, s30, v13
    v_mul_u32_u24 v13, 3072, v13
    v_add_u32 v9, v9, v13
    s_xor_b32 s30, s26, 0
    s_lshl_b32 s30, s30, 7
    v_add_u32 v9, s30, v9
    s_lshl_b32 s31, s24, 11
    s_add_u32 s31, s31, 49152
    s_lshl_b32 s32, s24, 10
    s_lshl_b32 s51, s53, 7
    s_mul_i32 s50, s53, 196608
    s_waitcnt lgkmcnt(0)
    s_or_b32 s54, s2, s24
    s_cmp_lg_u32 s54, 0
    s_cbranch_scc1 L_f1_fused_ker_ep_1
    s_memrealtime s[58:59]
    v_mov_b32 v131, 0
    s_waitcnt lgkmcnt(0)
    s_or_b32 s58, s58, 1
    v_mov_b32 v132, s58
    v_mov_b32 v133, s59
    s_mov_b64 exec, 1
    global_store_dwordx2 v131, v[132:133], s[56:57] sc1
    s_mov_b64 exec, -1
L_f1_fused_ker_ep_1:
    s_add_u32 m0, s31, 0
    s_add_u32 s33, s51, 0x0
    buffer_load_dwordx4 v7, s[8:11], s33 offen lds
    s_add_u32 m0, s31, 1024
    s_add_u32 s33, s51, 0x0
    buffer_load_dwordx4 v8, s[8:11], s33 offen lds
    s_add_u32 s51, s51, 128
    s_and_b32 s51, s51, 1023
    s_add_u32 m0, s32, 0
    s_add_u32 s33, s50, 0x0
    buffer_load_dwordx4 v9, s[12:15], s33 offen lds
    s_add_u32 m0, s32, 3072
    s_add_u32 s33, s50, 0x0
    buffer_load_dwordx4 v9, s[12:15], s33 offen offset:1024 lds
    s_add_u32 m0, s32, 6144
    s_add_u32 s33, s50, 0x0
    buffer_load_dwordx4 v9, s[12:15], s33 offen offset:2048 lds
    s_add_u32 s50, s50, 98304
    s_cmp_ge_u32 s50, 1572864
    s_cselect_b32 s52, 1572864, 0
    s_sub_u32 s50, s50, s52
    s_add_u32 m0, s32, 12288
    s_add_u32 s33, s50, 0x0
    buffer_load_dwordx4 v9, s[12:15], s33 offen lds
    s_add_u32 m0, s32, 15360
    s_add_u32 s33, s50, 0x0
    buffer_load_dwordx4 v9, s[12:15], s33 offen offset:1024 lds
    s_add_u32 m0, s32, 18432
    s_add_u32 s33, s50, 0x0
    buffer_load_dwordx4 v9, s[12:15], s33 offen offset:2048 lds
    s_add_u32 s50, s50, 98304
    s_cmp_ge_u32 s50, 1572864
    s_cselect_b32 s52, 1572864, 0
    s_sub_u32 s50, s50, s52
    s_add_u32 m0, s31, 8192
    s_add_u32 s33, s51, 0x0
    buffer_load_dwordx4 v7, s[8:11], s33 offen lds
    s_add_u32 m0, s31, 9216
    s_add_u32 s33, s51, 0x0
    buffer_load_dwordx4 v8, s[8:11], s33 offen lds
    s_add_u32 s51, s51, 128
    s_and_b32 s51, s51, 1023
    s_add_u32 m0, s32, 24576
    s_add_u32 s33, s50, 0x0
    buffer_load_dwordx4 v9, s[12:15], s33 offen lds
    s_add_u32 m0, s32, 27648
    s_add_u32 s33, s50, 0x0
    buffer_load_dwordx4 v9, s[12:15], s33 offen offset:1024 lds
    s_add_u32 m0, s32, 30720
    s_add_u32 s33, s50, 0x0
    buffer_load_dwordx4 v9, s[12:15], s33 offen offset:2048 lds
    s_add_u32 s50, s50, 98304
    s_cmp_ge_u32 s50, 1572864
    s_cselect_b32 s52, 1572864, 0
    s_sub_u32 s50, s50, s52
    s_lshl_b32 s36, s27, 5
    v_add_u32 v13, s36, v11
    v_bfe_u32 v14, v13, 1, 3
    v_xor_b32 v14, v14, v12
    v_lshlrev_b32 v14, 4, v14
    v_lshl_add_u32 v2, v13, 7, v14
    v_add_u32 v2, 49152, v2
    v_xor_b32 v3, 32, v2
    v_xor_b32 v4, 64, v2
    v_xor_b32 v5, 96, v2
    v_bfe_u32 v13, v1, 2, 2
    v_lshl_add_u32 v13, v12, 3, v13
    v_lshlrev_b32 v6, 7, v13
    v_bfe_u32 v13, v1, 4, 1
    v_lshlrev_b32 v13, 1, v13
    v_bfe_u32 v14, v1, 1, 1
    v_add_u32 v13, v13, v14
    s_lshl_b32 s36, s28, 2
    v_add_u32 v13, s36, v13
    v_bfe_u32 v14, v1, 3, 1
    v_lshlrev_b32 v14, 2, v14
    v_xor_b32 v13, v13, v14
    v_lshl_add_u32 v6, v13, 4, v6
    v_and_b32 v14, 1, v1
    v_lshl_add_u32 v6, v14, 3, v6
    v_xor_b32 v10, 2048, v6
    s_lshl_b32 s34, s25, 6
    s_lshl_b32 s35, s27, 5
    s_add_u32 s34, s34, s35
    v_add_u32 v117, s34, v11
    v_lshlrev_b32 v117, 5, v117
    s_lshl_b32 s35, s26, 6
    s_lshl_b32 s36, s28, 5
    s_add_u32 s35, s35, s36
    v_add_u32 v118, s35, v11
    v_lshlrev_b32 v118, 4, v118
    v_mul_u32_u24 v13, 0x14000, v12
    v_add_u32 v118, v118, v13
    s_waitcnt vmcnt(8)
    s_barrier
    ds_read_b128 v[16:19], v2 offset:0
    ds_read_b64_tr_b16 v[20:21], v6 offset:0
    ds_read_b64_tr_b16 v[22:23], v6 offset:512
    ds_read_b64_tr_b16 v[24:25], v6 offset:4096
    ds_read_b64_tr_b16 v[26:27], v6 offset:4608
    ds_read_b64_tr_b16 v[28:29], v6 offset:8192
    ds_read_b64_tr_b16 v[30:31], v6 offset:8704
    ds_read_b128 v[32:35], v3 offset:0
    ds_read_b64_tr_b16 v[36:37], v10 offset:0
    ds_read_b64_tr_b16 v[38:39], v10 offset:512
    ds_read_b64_tr_b16 v[40:41], v10 offset:4096
    ds_read_b64_tr_b16 v[42:43], v10 offset:4608
    ds_read_b64_tr_b16 v[44:45], v10 offset:8192
    ds_read_b64_tr_b16 v[46:47], v10 offset:8704
    s_waitcnt lgkmcnt(11)
    v_mfma_f32_32x32x16_bf16 v[64:79], v[20:23], v[16:19], 0
    s_add_u32 m0, s32, 36864
    s_add_u32 s33, s50, 0x0
    buffer_load_dwordx4 v9, s[12:15], s33 offen lds
    s_add_u32 m0, s32, 39936
    s_add_u32 s33, s50, 0x0
    buffer_load_dwordx4 v9, s[12:15], s33 offen offset:1024 lds
    s_waitcnt lgkmcnt(9)
    v_mfma_f32_32x32x16_bf16 v[80:95], v[24:27], v[16:19], 0
    s_add_u32 m0, s32, 43008
    s_add_u32 s33, s50, 0x0
    buffer_load_dwordx4 v9, s[12:15], s33 offen offset:2048 lds
    s_add_u32 s50, s50, 98304
    s_cmp_ge_u32 s50, 1572864
    s_cselect_b32 s52, 1572864, 0
    s_sub_u32 s50, s50, s52
    s_add_u32 m0, s31, 16384
    s_add_u32 s33, s51, 0x0
    buffer_load_dwordx4 v7, s[8:11], s33 offen lds
    s_waitcnt lgkmcnt(7)
    v_mfma_f32_32x32x16_bf16 v[96:111], v[16:19], v[28:31], 0
    s_add_u32 m0, s31, 17408
    s_add_u32 s33, s51, 0x0
    buffer_load_dwordx4 v8, s[8:11], s33 offen lds
    s_add_u32 s51, s51, 128
    s_and_b32 s51, s51, 1023
    s_waitcnt vmcnt(10)
    s_waitcnt lgkmcnt(0)
    s_barrier
    v_mfma_f32_32x32x16_bf16 v[64:79], v[36:39], v[32:35], v[64:79]
    ds_read_b128 v[16:19], v4 offset:0
    ds_read_b64_tr_b16 v[20:21], v6 offset:12288
    ds_read_b64_tr_b16 v[22:23], v6 offset:12800
    ds_read_b64_tr_b16 v[24:25], v6 offset:16384
    ds_read_b64_tr_b16 v[26:27], v6 offset:16896
    s_add_u32 m0, s32, 0
    s_add_u32 s33, s50, 0x0
    buffer_load_dwordx4 v9, s[12:15], s33 offen lds
    s_add_u32 m0, s32, 3072
    s_add_u32 s33, s50, 0x0
    buffer_load_dwordx4 v9, s[12:15], s33 offen offset:1024 lds
    v_mfma_f32_32x32x16_bf16 v[80:95], v[40:43], v[32:35], v[80:95]
    ds_read_b64_tr_b16 v[28:29], v6 offset:20480
    ds_read_b64_tr_b16 v[30:31], v6 offset:20992
    ds_read_b64_tr_b16 v[36:37], v10 offset:12288
    ds_read_b64_tr_b16 v[38:39], v10 offset:12800
    ds_read_b64_tr_b16 v[40:41], v10 offset:16384
    s_add_u32 m0, s32, 6144
    s_add_u32 s33, s50, 0x0
    buffer_load_dwordx4 v9, s[12:15], s33 offen offset:2048 lds
    s_add_u32 s50, s50, 98304
    s_cmp_ge_u32 s50, 1572864
    s_cselect_b32 s52, 1572864, 0
    s_sub_u32 s50, s50, s52
    v_mfma_f32_32x32x16_bf16 v[96:111], v[32:35], v[44:47], v[96:111]
    ds_read_b128 v[32:35], v5 offset:0
    ds_read_b64_tr_b16 v[42:43], v10 offset:16896
    ds_read_b64_tr_b16 v[44:45], v10 offset:20480
    ds_read_b64_tr_b16 v[46:47], v10 offset:20992
    s_waitcnt lgkmcnt(11)
    v_mfma_f32_32x32x16_bf16 v[64:79], v[20:23], v[16:19], v[64:79]
    s_waitcnt lgkmcnt(9)
    v_mfma_f32_32x32x16_bf16 v[80:95], v[24:27], v[16:19], v[80:95]
    s_waitcnt lgkmcnt(7)
    v_mfma_f32_32x32x16_bf16 v[96:111], v[16:19], v[28:31], v[96:111]
    s_waitcnt vmcnt(8)
    s_waitcnt lgkmcnt(0)
    s_barrier
    v_mfma_f32_32x32x16_bf16 v[64:79], v[36:39], v[32:35], v[64:79]
    ds_read_b128 v[16:19], v2 offset:8192
    ds_read_b64_tr_b16 v[20:21], v6 offset:24576
    ds_read_b64_tr_b16 v[22:23], v6 offset:25088
    ds_read_b64_tr_b16 v[24:25], v6 offset:28672
    ds_read_b64_tr_b16 v[26:27], v6 offset:29184
    s_add_u32 m0, s32, 12288
    s_add_u32 s33, s50, 0x0
    buffer_load_dwordx4 v9, s[12:15], s33 offen lds
    s_add_u32 m0, s32, 15360
    s_add_u32 s33, s50, 0x0
    buffer_load_dwordx4 v9, s[12:15], s33 offen offset:1024 lds
    v_mfma_f32_32x32x16_bf16 v[80:95], v[40:43], v[32:35], v[80:95]
    ds_read_b64_tr_b16 v[28:29], v6 offset:32768
    ds_read_b64_tr_b16 v[30:31], v6 offset:33280
    ds_read_b64_tr_b16 v[36:37], v10 offset:24576
    ds_read_b64_tr_b16 v[38:39], v10 offset:25088
    ds_read_b64_tr_b16 v[40:41], v10 offset:28672
    s_add_u32 m0, s32, 18432
    s_add_u32 s33, s50, 0x0
    buffer_load_dwordx4 v9, s[12:15], s33 offen offset:2048 lds
    s_add_u32 s50, s50, 98304
    s_cmp_ge_u32 s50, 1572864
    s_cselect_b32 s52, 1572864, 0
    s_sub_u32 s50, s50, s52
    s_add_u32 m0, s31, 0
    s_add_u32 s33, s51, 0x0
    buffer_load_dwordx4 v7, s[8:11], s33 offen lds
    v_mfma_f32_32x32x16_bf16 v[96:111], v[32:35], v[44:47], v[96:111]
    ds_read_b128 v[32:35], v3 offset:8192
    ds_read_b64_tr_b16 v[42:43], v10 offset:29184
    ds_read_b64_tr_b16 v[44:45], v10 offset:32768
    ds_read_b64_tr_b16 v[46:47], v10 offset:33280
    s_add_u32 m0, s31, 1024
    s_add_u32 s33, s51, 0x0
    buffer_load_dwordx4 v8, s[8:11], s33 offen lds
    s_add_u32 s51, s51, 128
    s_and_b32 s51, s51, 1023
    s_waitcnt lgkmcnt(11)
    v_mfma_f32_32x32x16_bf16 v[64:79], v[20:23], v[16:19], v[64:79]
    s_waitcnt lgkmcnt(9)
    v_mfma_f32_32x32x16_bf16 v[80:95], v[24:27], v[16:19], v[80:95]
    s_waitcnt lgkmcnt(7)
    v_mfma_f32_32x32x16_bf16 v[96:111], v[16:19], v[28:31], v[96:111]
    s_waitcnt vmcnt(10)
    s_waitcnt lgkmcnt(0)
    s_barrier
    v_mfma_f32_32x32x16_bf16 v[64:79], v[36:39], v[32:35], v[64:79]
    ds_read_b128 v[16:19], v4 offset:8192
    ds_read_b64_tr_b16 v[20:21], v6 offset:36864
    ds_read_b64_tr_b16 v[22:23], v6 offset:37376
    ds_read_b64_tr_b16 v[24:25], v6 offset:40960
    ds_read_b64_tr_b16 v[26:27], v6 offset:41472
    s_add_u32 m0, s32, 24576
    s_add_u32 s33, s50, 0x0
    buffer_load_dwordx4 v9, s[12:15], s33 offen lds
    s_add_u32 m0, s32, 27648
    s_add_u32 s33, s50, 0x0
    buffer_load_dwordx4 v9, s[12:15], s33 offen offset:1024 lds
    v_mfma_f32_32x32x16_bf16 v[80:95], v[40:43], v[32:35], v[80:95]
    ds_read_b64_tr_b16 v[28:29], v6 offset:45056
    ds_read_b64_tr_b16 v[30:31], v6 offset:45568
    ds_read_b64_tr_b16 v[36:37], v10 offset:36864
    ds_read_b64_tr_b16 v[38:39], v10 offset:37376
    ds_read_b64_tr_b16 v[40:41], v10 offset:40960
    s_add_u32 m0, s32, 30720
    s_add_u32 s33, s50, 0x0
    buffer_load_dwordx4 v9, s[12:15], s33 offen offset:2048 lds
    s_add_u32 s50, s50, 98304
    s_cmp_ge_u32 s50, 1572864
    s_cselect_b32 s52, 1572864, 0
    s_sub_u32 s50, s50, s52
    v_mfma_f32_32x32x16_bf16 v[96:111], v[32:35], v[44:47], v[96:111]
    ds_read_b128 v[32:35], v5 offset:8192
    ds_read_b64_tr_b16 v[42:43], v10 offset:41472
    ds_read_b64_tr_b16 v[44:45], v10 offset:45056
    ds_read_b64_tr_b16 v[46:47], v10 offset:45568
    s_waitcnt lgkmcnt(11)
    v_mfma_f32_32x32x16_bf16 v[64:79], v[20:23], v[16:19], v[64:79]
    s_waitcnt lgkmcnt(9)
    v_mfma_f32_32x32x16_bf16 v[80:95], v[24:27], v[16:19], v[80:95]
    s_waitcnt lgkmcnt(7)
    v_mfma_f32_32x32x16_bf16 v[96:111], v[16:19], v[28:31], v[96:111]
    s_waitcnt vmcnt(8)
    s_waitcnt lgkmcnt(0)
    s_barrier
    v_mfma_f32_32x32x16_bf16 v[64:79], v[36:39], v[32:35], v[64:79]
    ds_read_b128 v[16:19], v2 offset:16384
    ds_read_b64_tr_b16 v[20:21], v6 offset:0
    ds_read_b64_tr_b16 v[22:23], v6 offset:512
    ds_read_b64_tr_b16 v[24:25], v6 offset:4096
    ds_read_b64_tr_b16 v[26:27], v6 offset:4608
    s_add_u32 m0, s32, 36864
    s_add_u32 s33, s50, 0x0
    buffer_load_dwordx4 v9, s[12:15], s33 offen lds
    s_add_u32 m0, s32, 39936
    s_add_u32 s33, s50, 0x0
    buffer_load_dwordx4 v9, s[12:15], s33 offen offset:1024 lds
    v_mfma_f32_32x32x16_bf16 v[80:95], v[40:43], v[32:35], v[80:95]
    ds_read_b64_tr_b16 v[28:29], v6 offset:8192
    ds_read_b64_tr_b16 v[30:31], v6 offset:8704
    ds_read_b64_tr_b16 v[36:37], v10 offset:0
    ds_read_b64_tr_b16 v[38:39], v10 offset:512
    ds_read_b64_tr_b16 v[40:41], v10 offset:4096
    s_add_u32 m0, s32, 43008
    s_add_u32 s33, s50, 0x0
    buffer_load_dwordx4 v9, s[12:15], s33 offen offset:2048 lds
    s_add_u32 s50, s50, 98304
    s_cmp_ge_u32 s50, 1572864
    s_cselect_b32 s52, 1572864, 0
    s_sub_u32 s50, s50, s52
    s_add_u32 m0, s31, 8192
    s_add_u32 s33, s51, 0x0
    buffer_load_dwordx4 v7, s[8:11], s33 offen lds
    v_mfma_f32_32x32x16_bf16 v[96:111], v[32:35], v[44:47], v[96:111]
    ds_read_b128 v[32:35], v3 offset:16384
    ds_read_b64_tr_b16 v[42:43], v10 offset:4608
    ds_read_b64_tr_b16 v[44:45], v10 offset:8192
    ds_read_b64_tr_b16 v[46:47], v10 offset:8704
    s_add_u32 m0, s31, 9216
    s_add_u32 s33, s51, 0x0
    buffer_load_dwordx4 v8, s[8:11], s33 offen lds
    s_add_u32 s51, s51, 128
    s_and_b32 s51, s51, 1023
    s_waitcnt lgkmcnt(11)
    v_mfma_f32_32x32x16_bf16 v[64:79], v[20:23], v[16:19], v[64:79]
    s_waitcnt lgkmcnt(9)
    v_mfma_f32_32x32x16_bf16 v[80:95], v[24:27], v[16:19], v[80:95]
    s_waitcnt lgkmcnt(7)
    v_mfma_f32_32x32x16_bf16 v[96:111], v[16:19], v[28:31], v[96:111]
    s_waitcnt vmcnt(10)
    s_waitcnt lgkmcnt(0)
    s_barrier
    v_mfma_f32_32x32x16_bf16 v[64:79], v[36:39], v[32:35], v[64:79]
    ds_read_b128 v[16:19], v4 offset:16384
    ds_read_b64_tr_b16 v[20:21], v6 offset:12288
    ds_read_b64_tr_b16 v[22:23], v6 offset:12800
    ds_read_b64_tr_b16 v[24:25], v6 offset:16384
    ds_read_b64_tr_b16 v[26:27], v6 offset:16896
    s_add_u32 m0, s32, 0
    s_add_u32 s33, s50, 0x0
    buffer_load_dwordx4 v9, s[12:15], s33 offen lds
    s_add_u32 m0, s32, 3072
    s_add_u32 s33, s50, 0x0
    buffer_load_dwordx4 v9, s[12:15], s33 offen offset:1024 lds
    v_mfma_f32_32x32x16_bf16 v[80:95], v[40:43], v[32:35], v[80:95]
    ds_read_b64_tr_b16 v[28:29], v6 offset:20480
    ds_read_b64_tr_b16 v[30:31], v6 offset:20992
    ds_read_b64_tr_b16 v[36:37], v10 offset:12288
    ds_read_b64_tr_b16 v[38:39], v10 offset:12800
    ds_read_b64_tr_b16 v[40:41], v10 offset:16384
    s_add_u32 m0, s32, 6144
    s_add_u32 s33, s50, 0x0
    buffer_load_dwordx4 v9, s[12:15], s33 offen offset:2048 lds
    s_add_u32 s50, s50, 98304
    s_cmp_ge_u32 s50, 1572864
    s_cselect_b32 s52, 1572864, 0
    s_sub_u32 s50, s50, s52
    v_mfma_f32_32x32x16_bf16 v[96:111], v[32:35], v[44:47], v[96:111]
    ds_read_b128 v[32:35], v5 offset:16384
    ds_read_b64_tr_b16 v[42:43], v10 offset:16896
    ds_read_b64_tr_b16 v[44:45], v10 offset:20480
    ds_read_b64_tr_b16 v[46:47], v10 offset:20992
    s_waitcnt lgkmcnt(11)
    v_mfma_f32_32x32x16_bf16 v[64:79], v[20:23], v[16:19], v[64:79]
    s_waitcnt lgkmcnt(9)
    v_mfma_f32_32x32x16_bf16 v[80:95], v[24:27], v[16:19], v[80:95]
    s_waitcnt lgkmcnt(7)
    v_mfma_f32_32x32x16_bf16 v[96:111], v[16:19], v[28:31], v[96:111]
    s_waitcnt vmcnt(8)
    s_waitcnt lgkmcnt(0)
    s_barrier
    v_mfma_f32_32x32x16_bf16 v[64:79], v[36:39], v[32:35], v[64:79]
    ds_read_b128 v[16:19], v2 offset:0
    ds_read_b64_tr_b16 v[20:21], v6 offset:24576
    ds_read_b64_tr_b16 v[22:23], v6 offset:25088
    ds_read_b64_tr_b16 v[24:25], v6 offset:28672
    ds_read_b64_tr_b16 v[26:27], v6 offset:29184
    s_add_u32 m0, s32, 12288
    s_add_u32 s33, s50, 0x0
    buffer_load_dwordx4 v9, s[12:15], s33 offen lds
    s_add_u32 m0, s32, 15360
    s_add_u32 s33, s50, 0x0
    buffer_load_dwordx4 v9, s[12:15], s33 offen offset:1024 lds
    v_mfma_f32_32x32x16_bf16 v[80:95], v[40:43], v[32:35], v[80:95]
    ds_read_b64_tr_b16 v[28:29], v6 offset:32768
    ds_read_b64_tr_b16 v[30:31], v6 offset:33280
    ds_read_b64_tr_b16 v[36:37], v10 offset:24576
    ds_read_b64_tr_b16 v[38:39], v10 offset:25088
    ds_read_b64_tr_b16 v[40:41], v10 offset:28672
    s_add_u32 m0, s32, 18432
    s_add_u32 s33, s50, 0x0
    buffer_load_dwordx4 v9, s[12:15], s33 offen offset:2048 lds
    s_add_u32 s50, s50, 98304
    s_cmp_ge_u32 s50, 1572864
    s_cselect_b32 s52, 1572864, 0
    s_sub_u32 s50, s50, s52
    s_add_u32 m0, s31, 16384
    s_add_u32 s33, s51, 0x0
    buffer_load_dwordx4 v7, s[8:11], s33 offen lds
    v_mfma_f32_32x32x16_bf16 v[96:111], v[32:35], v[44:47], v[96:111]
    ds_read_b128 v[32:35], v3 offset:0
    ds_read_b64_tr_b16 v[42:43], v10 offset:29184
    ds_read_b64_tr_b16 v[44:45], v10 offset:32768
    ds_read_b64_tr_b16 v[46:47], v10 offset:33280
    s_add_u32 m0, s31, 17408
    s_add_u32 s33, s51, 0x0
    buffer_load_dwordx4 v8, s[8:11], s33 offen lds
    s_add_u32 s51, s51, 128
    s_and_b32 s51, s51, 1023
    s_waitcnt lgkmcnt(11)
    v_mfma_f32_32x32x16_bf16 v[64:79], v[20:23], v[16:19], v[64:79]
    s_waitcnt lgkmcnt(9)
    v_mfma_f32_32x32x16_bf16 v[80:95], v[24:27], v[16:19], v[80:95]
    s_waitcnt lgkmcnt(7)
    v_mfma_f32_32x32x16_bf16 v[96:111], v[16:19], v[28:31], v[96:111]
    s_waitcnt vmcnt(10)
    s_waitcnt lgkmcnt(0)
    s_barrier
    v_mfma_f32_32x32x16_bf16 v[64:79], v[36:39], v[32:35], v[64:79]
    ds_read_b128 v[16:19], v4 offset:0
    ds_read_b64_tr_b16 v[20:21], v6 offset:36864
    ds_read_b64_tr_b16 v[22:23], v6 offset:37376
    ds_read_b64_tr_b16 v[24:25], v6 offset:40960
    ds_read_b64_tr_b16 v[26:27], v6 offset:41472
    s_add_u32 m0, s32, 24576
    s_add_u32 s33, s50, 0x0
    buffer_load_dwordx4 v9, s[12:15], s33 offen lds
    s_add_u32 m0, s32, 27648
    s_add_u32 s33, s50, 0x0
    buffer_load_dwordx4 v9, s[12:15], s33 offen offset:1024 lds
    v_mfma_f32_32x32x16_bf16 v[80:95], v[40:43], v[32:35], v[80:95]
    ds_read_b64_tr_b16 v[28:29], v6 offset:45056
    ds_read_b64_tr_b16 v[30:31], v6 offset:45568
    ds_read_b64_tr_b16 v[36:37], v10 offset:36864
    ds_read_b64_tr_b16 v[38:39], v10 offset:37376
    ds_read_b64_tr_b16 v[40:41], v10 offset:40960
    s_add_u32 m0, s32, 30720
    s_add_u32 s33, s50, 0x0
    buffer_load_dwordx4 v9, s[12:15], s33 offen offset:2048 lds
    s_add_u32 s50, s50, 98304
    s_cmp_ge_u32 s50, 1572864
    s_cselect_b32 s52, 1572864, 0
    s_sub_u32 s50, s50, s52
    v_mfma_f32_32x32x16_bf16 v[96:111], v[32:35], v[44:47], v[96:111]
    ds_read_b128 v[32:35], v5 offset:0
    ds_read_b64_tr_b16 v[42:43], v10 offset:41472
    ds_read_b64_tr_b16 v[44:45], v10 offset:45056
    ds_read_b64_tr_b16 v[46:47], v10 offset:45568
    s_waitcnt lgkmcnt(11)
    v_mfma_f32_32x32x16_bf16 v[64:79], v[20:23], v[16:19], v[64:79]
    s_waitcnt lgkmcnt(9)
    v_mfma_f32_32x32x16_bf16 v[80:95], v[24:27], v[16:19], v[80:95]
    s_waitcnt lgkmcnt(7)
    v_mfma_f32_32x32x16_bf16 v[96:111], v[16:19], v[28:31], v[96:111]
    s_waitcnt vmcnt(8)
    s_waitcnt lgkmcnt(0)
    s_barrier
    v_mfma_f32_32x32x16_bf16 v[64:79], v[36:39], v[32:35], v[64:79]
    ds_read_b128 v[16:19], v2 offset:8192
    ds_read_b64_tr_b16 v[20:21], v6 offset:0
    ds_read_b64_tr_b16 v[22:23], v6 offset:512
    ds_read_b64_tr_b16 v[24:25], v6 offset:4096
    ds_read_b64_tr_b16 v[26:27], v6 offset:4608
    s_add_u32 m0, s32, 36864
    s_add_u32 s33, s50, 0x0
    buffer_load_dwordx4 v9, s[12:15], s33 offen lds
    s_add_u32 m0, s32, 39936
    s_add_u32 s33, s50, 0x0
    buffer_load_dwordx4 v9, s[12:15], s33 offen offset:1024 lds
    v_mfma_f32_32x32x16_bf16 v[80:95], v[40:43], v[32:35], v[80:95]
    ds_read_b64_tr_b16 v[28:29], v6 offset:8192
    ds_read_b64_tr_b16 v[30:31], v6 offset:8704
    ds_read_b64_tr_b16 v[36:37], v10 offset:0
    ds_read_b64_tr_b16 v[38:39], v10 offset:512
    ds_read_b64_tr_b16 v[40:41], v10 offset:4096
    s_add_u32 m0, s32, 43008
    s_add_u32 s33, s50, 0x0
    buffer_load_dwordx4 v9, s[12:15], s33 offen offset:2048 lds
    s_add_u32 s50, s50, 98304
    s_cmp_ge_u32 s50, 1572864
    s_cselect_b32 s52, 1572864, 0
    s_sub_u32 s50, s50, s52
    s_add_u32 m0, s31, 0
    s_add_u32 s33, s51, 0x0
    buffer_load_dwordx4 v7, s[8:11], s33 offen lds
    v_mfma_f32_32x32x16_bf16 v[96:111], v[32:35], v[44:47], v[96:111]
    ds_read_b128 v[32:35], v3 offset:8192
    ds_read_b64_tr_b16 v[42:43], v10 offset:4608
    ds_read_b64_tr_b16 v[44:45], v10 offset:8192
    ds_read_b64_tr_b16 v[46:47], v10 offset:8704
    s_add_u32 m0, s31, 1024
    s_add_u32 s33, s51, 0x0
    buffer_load_dwordx4 v8, s[8:11], s33 offen lds
    s_add_u32 s51, s51, 128
    s_and_b32 s51, s51, 1023
    s_waitcnt lgkmcnt(11)
    v_mfma_f32_32x32x16_bf16 v[64:79], v[20:23], v[16:19], v[64:79]
    s_waitcnt lgkmcnt(9)
    v_mfma_f32_32x32x16_bf16 v[80:95], v[24:27], v[16:19], v[80:95]
    s_waitcnt lgkmcnt(7)
    v_mfma_f32_32x32x16_bf16 v[96:111], v[16:19], v[28:31], v[96:111]
    s_waitcnt vmcnt(10)
    s_waitcnt lgkmcnt(0)
    s_barrier
    v_mfma_f32_32x32x16_bf16 v[64:79], v[36:39], v[32:35], v[64:79]
    ds_read_b128 v[16:19], v4 offset:8192
    ds_read_b64_tr_b16 v[20:21], v6 offset:12288
    ds_read_b64_tr_b16 v[22:23], v6 offset:12800
    ds_read_b64_tr_b16 v[24:25], v6 offset:16384
    ds_read_b64_tr_b16 v[26:27], v6 offset:16896
    s_add_u32 m0, s32, 0
    s_add_u32 s33, s50, 0x0
    buffer_load_dwordx4 v9, s[12:15], s33 offen lds
    s_add_u32 m0, s32, 3072
    s_add_u32 s33, s50, 0x0
    buffer_load_dwordx4 v9, s[12:15], s33 offen offset:1024 lds
    v_mfma_f32_32x32x16_bf16 v[80:95], v[40:43], v[32:35], v[80:95]
    ds_read_b64_tr_b16 v[28:29], v6 offset:20480
    ds_read_b64_tr_b16 v[30:31], v6 offset:20992
    ds_read_b64_tr_b16 v[36:37], v10 offset:12288
    ds_read_b64_tr_b16 v[38:39], v10 offset:12800
    ds_read_b64_tr_b16 v[40:41], v10 offset:16384
    s_add_u32 m0, s32, 6144
    s_add_u32 s33, s50, 0x0
    buffer_load_dwordx4 v9, s[12:15], s33 offen offset:2048 lds
    s_add_u32 s50, s50, 98304
    s_cmp_ge_u32 s50, 1572864
    s_cselect_b32 s52, 1572864, 0
    s_sub_u32 s50, s50, s52
    v_mfma_f32_32x32x16_bf16 v[96:111], v[32:35], v[44:47], v[96:111]
    ds_read_b128 v[32:35], v5 offset:8192
    ds_read_b64_tr_b16 v[42:43], v10 offset:16896
    ds_read_b64_tr_b16 v[44:45], v10 offset:20480
    ds_read_b64_tr_b16 v[46:47], v10 offset:20992
    s_waitcnt lgkmcnt(11)
    v_mfma_f32_32x32x16_bf16 v[64:79], v[20:23], v[16:19], v[64:79]
    s_waitcnt lgkmcnt(9)
    v_mfma_f32_32x32x16_bf16 v[80:95], v[24:27], v[16:19], v[80:95]
    s_waitcnt lgkmcnt(7)
    v_mfma_f32_32x32x16_bf16 v[96:111], v[16:19], v[28:31], v[96:111]
    s_waitcnt vmcnt(8)
    s_waitcnt lgkmcnt(0)
    s_barrier
    v_mfma_f32_32x32x16_bf16 v[64:79], v[36:39], v[32:35], v[64:79]
    ds_read_b128 v[16:19], v2 offset:16384
    ds_read_b64_tr_b16 v[20:21], v6 offset:24576
    ds_read_b64_tr_b16 v[22:23], v6 offset:25088
    ds_read_b64_tr_b16 v[24:25], v6 offset:28672
    ds_read_b64_tr_b16 v[26:27], v6 offset:29184
    s_add_u32 m0, s32, 12288
    s_add_u32 s33, s50, 0x0
    buffer_load_dwordx4 v9, s[12:15], s33 offen lds
    s_add_u32 m0, s32, 15360
    s_add_u32 s33, s50, 0x0
    buffer_load_dwordx4 v9, s[12:15], s33 offen offset:1024 lds
    v_mfma_f32_32x32x16_bf16 v[80:95], v[40:43], v[32:35], v[80:95]
    ds_read_b64_tr_b16 v[28:29], v6 offset:32768
    ds_read_b64_tr_b16 v[30:31], v6 offset:33280
    ds_read_b64_tr_b16 v[36:37], v10 offset:24576
    ds_read_b64_tr_b16 v[38:39], v10 offset:25088
    ds_read_b64_tr_b16 v[40:41], v10 offset:28672
    s_add_u32 m0, s32, 18432
    s_add_u32 s33, s50, 0x0
    buffer_load_dwordx4 v9, s[12:15], s33 offen offset:2048 lds
    s_add_u32 s50, s50, 98304
    s_cmp_ge_u32 s50, 1572864
    s_cselect_b32 s52, 1572864, 0
    s_sub_u32 s50, s50, s52
    s_add_u32 m0, s31, 8192
    s_add_u32 s33, s51, 0x0
    buffer_load_dwordx4 v7, s[8:11], s33 offen lds
    v_mfma_f32_32x32x16_bf16 v[96:111], v[32:35], v[44:47], v[96:111]
    ds_read_b128 v[32:35], v3 offset:16384
    ds_read_b64_tr_b16 v[42:43], v10 offset:29184
    ds_read_b64_tr_b16 v[44:45], v10 offset:32768
    ds_read_b64_tr_b16 v[46:47], v10 offset:33280
    s_add_u32 m0, s31, 9216
    s_add_u32 s33, s51, 0x0
    buffer_load_dwordx4 v8, s[8:11], s33 offen lds
    s_add_u32 s51, s51, 128
    s_and_b32 s51, s51, 1023
    s_waitcnt lgkmcnt(11)
    v_mfma_f32_32x32x16_bf16 v[64:79], v[20:23], v[16:19], v[64:79]
    s_waitcnt lgkmcnt(9)
    v_mfma_f32_32x32x16_bf16 v[80:95], v[24:27], v[16:19], v[80:95]
    s_waitcnt lgkmcnt(7)
    v_mfma_f32_32x32x16_bf16 v[96:111], v[16:19], v[28:31], v[96:111]
    s_waitcnt vmcnt(10)
    s_waitcnt lgkmcnt(0)
    s_barrier
    v_mfma_f32_32x32x16_bf16 v[64:79], v[36:39], v[32:35], v[64:79]
    ds_read_b128 v[16:19], v4 offset:16384
    ds_read_b64_tr_b16 v[20:21], v6 offset:36864
    ds_read_b64_tr_b16 v[22:23], v6 offset:37376
    ds_read_b64_tr_b16 v[24:25], v6 offset:40960
    ds_read_b64_tr_b16 v[26:27], v6 offset:41472
    s_add_u32 m0, s32, 24576
    s_add_u32 s33, s50, 0x0
    buffer_load_dwordx4 v9, s[12:15], s33 offen lds
    s_add_u32 m0, s32, 27648
    s_add_u32 s33, s50, 0x0
    buffer_load_dwordx4 v9, s[12:15], s33 offen offset:1024 lds
    v_mfma_f32_32x32x16_bf16 v[80:95], v[40:43], v[32:35], v[80:95]
    ds_read_b64_tr_b16 v[28:29], v6 offset:45056
    ds_read_b64_tr_b16 v[30:31], v6 offset:45568
    ds_read_b64_tr_b16 v[36:37], v10 offset:36864
    ds_read_b64_tr_b16 v[38:39], v10 offset:37376
    ds_read_b64_tr_b16 v[40:41], v10 offset:40960
    s_add_u32 m0, s32, 30720
    s_add_u32 s33, s50, 0x0
    buffer_load_dwordx4 v9, s[12:15], s33 offen offset:2048 lds
    s_add_u32 s50, s50, 98304
    s_cmp_ge_u32 s50, 1572864
    s_cselect_b32 s52, 1572864, 0
    s_sub_u32 s50, s50, s52
    v_mfma_f32_32x32x16_bf16 v[96:111], v[32:35], v[44:47], v[96:111]
    ds_read_b128 v[32:35], v5 offset:16384
    ds_read_b64_tr_b16 v[42:43], v10 offset:41472
    ds_read_b64_tr_b16 v[44:45], v10 offset:45056
    ds_read_b64_tr_b16 v[46:47], v10 offset:45568
    s_waitcnt lgkmcnt(11)
    v_mfma_f32_32x32x16_bf16 v[64:79], v[20:23], v[16:19], v[64:79]
    s_waitcnt lgkmcnt(9)
    v_mfma_f32_32x32x16_bf16 v[80:95], v[24:27], v[16:19], v[80:95]
    s_waitcnt lgkmcnt(7)
    v_mfma_f32_32x32x16_bf16 v[96:111], v[16:19], v[28:31], v[96:111]
    s_waitcnt vmcnt(8)
    s_waitcnt lgkmcnt(0)
    s_barrier
    v_mfma_f32_32x32x16_bf16 v[64:79], v[36:39], v[32:35], v[64:79]
    ds_read_b128 v[16:19], v2 offset:0
    ds_read_b64_tr_b16 v[20:21], v6 offset:0
    ds_read_b64_tr_b16 v[22:23], v6 offset:512
    ds_read_b64_tr_b16 v[24:25], v6 offset:4096
    ds_read_b64_tr_b16 v[26:27], v6 offset:4608
    s_add_u32 m0, s32, 36864
    s_add_u32 s33, s50, 0x0
    buffer_load_dwordx4 v9, s[12:15], s33 offen lds
    s_add_u32 m0, s32, 39936
    s_add_u32 s33, s50, 0x0
    buffer_load_dwordx4 v9, s[12:15], s33 offen offset:1024 lds
    v_mfma_f32_32x32x16_bf16 v[80:95], v[40:43], v[32:35], v[80:95]
    ds_read_b64_tr_b16 v[28:29], v6 offset:8192
    ds_read_b64_tr_b16 v[30:31], v6 offset:8704
    ds_read_b64_tr_b16 v[36:37], v10 offset:0
    ds_read_b64_tr_b16 v[38:39], v10 offset:512
    ds_read_b64_tr_b16 v[40:41], v10 offset:4096
    s_add_u32 m0, s32, 43008
    s_add_u32 s33, s50, 0x0
    buffer_load_dwordx4 v9, s[12:15], s33 offen offset:2048 lds
    s_add_u32 s50, s50, 98304
    s_cmp_ge_u32 s50, 1572864
    s_cselect_b32 s52, 1572864, 0
    s_sub_u32 s50, s50, s52
    v_mfma_f32_32x32x16_bf16 v[96:111], v[32:35], v[44:47], v[96:111]
    ds_read_b128 v[32:35], v3 offset:0
    ds_read_b64_tr_b16 v[42:43], v10 offset:4608
    ds_read_b64_tr_b16 v[44:45], v10 offset:8192
    ds_read_b64_tr_b16 v[46:47], v10 offset:8704
    s_waitcnt lgkmcnt(11)
    v_mfma_f32_32x32x16_bf16 v[64:79], v[20:23], v[16:19], v[64:79]
    s_waitcnt lgkmcnt(9)
    v_mfma_f32_32x32x16_bf16 v[80:95], v[24:27], v[16:19], v[80:95]
    s_waitcnt lgkmcnt(7)
    v_mfma_f32_32x32x16_bf16 v[96:111], v[16:19], v[28:31], v[96:111]
    v_mov_b32 v122, 0
    global_load_dwordx2 v[120:121], v122, s[56:57] sc1
    s_waitcnt vmcnt(9)
    s_waitcnt lgkmcnt(0)
    s_barrier
    v_mfma_f32_32x32x16_bf16 v[64:79], v[36:39], v[32:35], v[64:79]
    ds_read_b128 v[16:19], v4 offset:0
    ds_read_b64_tr_b16 v[20:21], v6 offset:12288
    ds_read_b64_tr_b16 v[22:23], v6 offset:12800
    ds_read_b64_tr_b16 v[24:25], v6 offset:16384
    ds_read_b64_tr_b16 v[26:27], v6 offset:16896
    v_mfma_f32_32x32x16_bf16 v[80:95], v[40:43], v[32:35], v[80:95]
    ds_read_b64_tr_b16 v[28:29], v6 offset:20480
    ds_read_b64_tr_b16 v[30:31], v6 offset:20992
    ds_read_b64_tr_b16 v[36:37], v10 offset:12288
    ds_read_b64_tr_b16 v[38:39], v10 offset:12800
    ds_read_b64_tr_b16 v[40:41], v10 offset:16384
    v_mfma_f32_32x32x16_bf16 v[96:111], v[32:35], v[44:47], v[96:111]
    ds_read_b128 v[32:35], v5 offset:0
    ds_read_b64_tr_b16 v[42:43], v10 offset:16896
    ds_read_b64_tr_b16 v[44:45], v10 offset:20480
    ds_read_b64_tr_b16 v[46:47], v10 offset:20992
    s_waitcnt lgkmcnt(11)
    v_mfma_f32_32x32x16_bf16 v[64:79], v[20:23], v[16:19], v[64:79]
    s_waitcnt lgkmcnt(9)
    v_mfma_f32_32x32x16_bf16 v[80:95], v[24:27], v[16:19], v[80:95]
    s_waitcnt lgkmcnt(7)
    v_mfma_f32_32x32x16_bf16 v[96:111], v[16:19], v[28:31], v[96:111]
    buffer_load_dwordx4 v[48:51], v117, s[20:23], 0 offen offset:0 sc1
    buffer_load_dwordx4 v[112:115], v117, s[20:23], 0 offen offset:16 sc1
    s_mov_b32 s36, 65536
    buffer_load_dwordx4 v[52:55], v118, s[20:23], s36 offen sc1
    s_mov_b32 s36, 73728
    buffer_load_dwordx4 v[56:59], v118, s[20:23], s36 offen sc1
    s_mov_b32 s36, 81920
    buffer_load_dwordx4 v[60:63], v118, s[20:23], s36 offen sc1
    s_waitcnt vmcnt(9)
    s_waitcnt lgkmcnt(0)
    s_barrier
    v_mfma_f32_32x32x16_bf16 v[64:79], v[36:39], v[32:35], v[64:79]
    ds_read_b128 v[16:19], v2 offset:8192
    ds_read_b64_tr_b16 v[20:21], v6 offset:24576
    ds_read_b64_tr_b16 v[22:23], v6 offset:25088
    ds_read_b64_tr_b16 v[24:25], v6 offset:28672
    ds_read_b64_tr_b16 v[26:27], v6 offset:29184
    v_mfma_f32_32x32x16_bf16 v[80:95], v[40:43], v[32:35], v[80:95]
    ds_read_b64_tr_b16 v[28:29], v6 offset:32768
    ds_read_b64_tr_b16 v[30:31], v6 offset:33280
    ds_read_b64_tr_b16 v[36:37], v10 offset:24576
    ds_read_b64_tr_b16 v[38:39], v10 offset:25088
    ds_read_b64_tr_b16 v[40:41], v10 offset:28672
    v_mfma_f32_32x32x16_bf16 v[96:111], v[32:35], v[44:47], v[96:111]
    ds_read_b128 v[32:35], v3 offset:8192
    ds_read_b64_tr_b16 v[42:43], v10 offset:29184
    ds_read_b64_tr_b16 v[44:45], v10 offset:32768
    ds_read_b64_tr_b16 v[46:47], v10 offset:33280
    s_waitcnt lgkmcnt(11)
    v_mfma_f32_32x32x16_bf16 v[64:79], v[20:23], v[16:19], v[64:79]
    s_waitcnt lgkmcnt(9)
    v_mfma_f32_32x32x16_bf16 v[80:95], v[24:27], v[16:19], v[80:95]
    s_waitcnt lgkmcnt(7)
    v_mfma_f32_32x32x16_bf16 v[96:111], v[16:19], v[28:31], v[96:111]
    s_waitcnt vmcnt(6)
    s_waitcnt lgkmcnt(0)
    s_barrier
    v_mfma_f32_32x32x16_bf16 v[64:79], v[36:39], v[32:35], v[64:79]
    ds_read_b128 v[16:19], v4 offset:8192
    ds_read_b64_tr_b16 v[20:21], v6 offset:36864
    ds_read_b64_tr_b16 v[22:23], v6 offset:37376
    ds_read_b64_tr_b16 v[24:25], v6 offset:40960
    ds_read_b64_tr_b16 v[26:27], v6 offset:41472
    v_mfma_f32_32x32x16_bf16 v[80:95], v[40:43], v[32:35], v[80:95]
    ds_read_b64_tr_b16 v[28:29], v6 offset:45056
    ds_read_b64_tr_b16 v[30:31], v6 offset:45568
    ds_read_b64_tr_b16 v[36:37], v10 offset:36864
    ds_read_b64_tr_b16 v[38:39], v10 offset:37376
    ds_read_b64_tr_b16 v[40:41], v10 offset:40960
    v_mfma_f32_32x32x16_bf16 v[96:111], v[32:35], v[44:47], v[96:111]
    ds_read_b128 v[32:35], v5 offset:8192
    ds_read_b64_tr_b16 v[42:43], v10 offset:41472
    ds_read_b64_tr_b16 v[44:45], v10 offset:45056
    ds_read_b64_tr_b16 v[46:47], v10 offset:45568
    s_waitcnt lgkmcnt(11)
    v_mfma_f32_32x32x16_bf16 v[64:79], v[20:23], v[16:19], v[64:79]
    s_waitcnt lgkmcnt(9)
    v_mfma_f32_32x32x16_bf16 v[80:95], v[24:27], v[16:19], v[80:95]
    s_waitcnt lgkmcnt(7)
    v_mfma_f32_32x32x16_bf16 v[96:111], v[16:19], v[28:31], v[96:111]
    s_waitcnt lgkmcnt(0)
    v_mfma_f32_32x32x16_bf16 v[64:79], v[36:39], v[32:35], v[64:79]
    v_mfma_f32_32x32x16_bf16 v[80:95], v[40:43], v[32:35], v[80:95]
    v_mfma_f32_32x32x16_bf16 v[96:111], v[32:35], v[44:47], v[96:111]
    s_waitcnt vmcnt(5)
    v_readfirstlane_b32 s58, v120
    v_readfirstlane_b32 s59, v121
    s_nop 3
    s_cmp_eq_u32 s58, 0
    s_cbranch_scc1 L_f1_fused_ker_eps_2
L_f1_fused_ker_epc_3:
    s_waitcnt vmcnt(0)
    v_cmp_eq_u32 vcc, s58, v51
    v_cmp_eq_u32 s[36:37], s58, v114
    s_nop 1
    s_and_b64 vcc, vcc, s[36:37]
    v_cmp_eq_u32 s[36:37], s58, v55
    s_nop 1
    s_and_b64 vcc, vcc, s[36:37]
    v_cmp_eq_u32 s[36:37], s58, v59
    s_nop 1
    s_and_b64 vcc, vcc, s[36:37]
    v_cmp_eq_u32 s[36:37], s58, v63
    s_nop 1
    s_and_b64 vcc, vcc, s[36:37]
    s_cmp_eq_u64 vcc, -1
    s_cbranch_scc0 L_f1_fused_ker_x1s_4
L_f1_fused_ker_x1c_5:
    v_mov_b32 v51, 0
    v_mov_b32 v55, 0
    v_mov_b32 v59, 0
    v_mov_b32 v63, 0
    s_nop 1
    v_mfma_f32_32x32x16_bf16 v[64:79], v[52:55], v[48:51], v[64:79]
    v_mfma_f32_32x32x16_bf16 v[80:95], v[56:59], v[48:51], v[80:95]
    v_mfma_f32_32x32x16_bf16 v[96:111], v[48:51], v[60:63], v[96:111]
    s_lshl_b32 s36, s24, 7
    v_lshlrev_b32 v13, 2, v11
    v_add_u32 v13, s36, v13
    ds_write_b32 v13, v112
    v_lshlrev_b32 v13, 4, v12
    v_add_u32 v13, s36, v13
    s_waitcnt lgkmcnt(0)
    ds_read_b128 v[32:35], v13 offset:0
    ds_read_b128 v[36:39], v13 offset:32
    ds_read_b128 v[40:43], v13 offset:64
    ds_read_b128 v[44:47], v13 offset:96
    v_mul_f32 v113, 0x3eb8aa3b, v112
    v_lshlrev_b32 v10, 4, v1
    s_lshl_b32 s36, s26, 2
    s_lshl_b32 s37, s28, 1
    s_add_u32 s36, s36, s37
    s_lshl_b32 s36, s36, 16
    s_lshl_b32 s37, s25, 1
    s_add_u32 s37, s37, s27
    s_lshl_b32 s37, s37, 10
    s_add_u32 s36, s36, s37
    v_lshrrev_b32 v17, 4, v11
    v_lshlrev_b32 v17, 16, v17
    v_lshl_add_u32 v17, v12, 8, v17
    v_and_b32 v18, 15, v11
    v_lshl_add_u32 v17, v18, 4, v17
    s_nop 4
    v_mul_f32 v64, v64, v113
    v_mul_f32 v65, v65, v113
    v_mul_f32 v66, v66, v113
    v_mul_f32 v67, v67, v113
    v_mul_f32 v68, v68, v113
    v_mul_f32 v69, v69, v113
    v_mul_f32 v70, v70, v113
    v_mul_f32 v71, v71, v113
    v_mul_f32 v72, v72, v113
    v_mul_f32 v73, v73, v113
    v_mul_f32 v74, v74, v113
    v_mul_f32 v75, v75, v113
    v_mul_f32 v76, v76, v113
    v_mul_f32 v77, v77, v113
    v_mul_f32 v78, v78, v113
    v_mul_f32 v79, v79, v113
    v_cvt_pk_bf16_f32 v20, v64, v65
    v_cvt_pk_bf16_f32 v21, v66, v67
    v_cvt_pk_bf16_f32 v22, v68, v69
    v_cvt_pk_bf16_f32 v23, v70, v71
    s_add_u32 s37, s36, 0x100000
    buffer_store_dwordx4 v[20:23], v10, s[20:23], s37 offen sc1
    v_cvt_pk_bf16_f32 v24, v72, v73
    v_cvt_pk_bf16_f32 v25, v74, v75
    v_cvt_pk_bf16_f32 v26, v76, v77
    v_cvt_pk_bf16_f32 v27, v78, v79
    s_add_u32 s37, s36, 0x110000
    buffer_store_dwordx4 v[24:27], v10, s[20:23], s37 offen sc1
    v_mul_f32 v80, v80, v112
    v_mul_f32 v81, v81, v112
    v_mul_f32 v82, v82, v112
    v_mul_f32 v83, v83, v112
    v_mul_f32 v84, v84, v112
    v_mul_f32 v85, v85, v112
    v_mul_f32 v86, v86, v112
    v_mul_f32 v87, v87, v112
    v_mul_f32 v88, v88, v112
    v_mul_f32 v89, v89, v112
    v_mul_f32 v90, v90, v112
    v_mul_f32 v91, v91, v112
    v_mul_f32 v92, v92, v112
    v_mul_f32 v93, v93, v112
    v_mul_f32 v94, v94, v112
    v_mul_f32 v95, v95, v112
    v_cvt_pk_bf16_f32 v48, v80, v81
    v_cvt_pk_bf16_f32 v49, v82, v83
    v_cvt_pk_bf16_f32 v50, v84, v85
    v_cvt_pk_bf16_f32 v51, v86, v87
    s_add_u32 s37, s36, 0x300000
    buffer_store_dwordx4 v[48:51], v10, s[20:23], s37 offen sc1
    v_cvt_pk_bf16_f32 v52, v88, v89
    v_cvt_pk_bf16_f32 v53, v90, v91
    v_cvt_pk_bf16_f32 v54, v92, v93
    v_cvt_pk_bf16_f32 v55, v94, v95
    s_add_u32 s37, s36, 0x310000
    buffer_store_dwordx4 v[52:55], v10, s[20:23], s37 offen sc1
    s_waitcnt lgkmcnt(0)
    v_mul_f32 v96, v96, v32
    v_mul_f32 v97, v97, v33
    v_mul_f32 v98, v98, v34
    v_mul_f32 v99, v99, v35
    v_mul_f32 v100, v100, v36
    v_mul_f32 v101, v101, v37
    v_mul_f32 v102, v102, v38
    v_mul_f32 v103, v103, v39
    v_mul_f32 v104, v104, v40
    v_mul_f32 v105, v105, v41
    v_mul_f32 v106, v106, v42
    v_mul_f32 v107, v107, v43
    v_mul_f32 v108, v108, v44
    v_mul_f32 v109, v109, v45
    v_mul_f32 v110, v110, v46
    v_mul_f32 v111, v111, v47
    s_add_u32 s37, s36, 0x500000
    v_cvt_pk_bf16_f32 v56, v96, v97
    v_cvt_pk_bf16_f32 v57, v98, v99
    v_cvt_pk_bf16_f32 v58, v100, v101
    v_cvt_pk_bf16_f32 v59, v102, v103
    buffer_store_dwordx4 v[56:59], v17, s[20:23], s37 offen offset:0 sc1
    v_cvt_pk_bf16_f32 v60, v104, v105
    v_cvt_pk_bf16_f32 v61, v106, v107
    v_cvt_pk_bf16_f32 v62, v108, v109
    v_cvt_pk_bf16_f32 v63, v110, v111
    buffer_store_dwordx4 v[60:63], v17, s[20:23], s37 offen offset:512 sc1
    s_lshl_b32 s48, s26, 5
    s_add_u32 s48, s48, s25
    s_lshl_b32 s48, s48, 3
    s_add_u32 s48, s48, 0x41000
    s_waitcnt vmcnt(0)
    s_barrier
    s_cmp_lg_u32 s24, 0
    s_cbranch_scc1 L_f1_fused_ker_w0_6
    v_mov_b32 v19, s48
    v_mov_b32 v20, s58
    v_mov_b32 v21, s59
    s_mov_b64 exec, 1
    buffer_store_dwordx2 v[20:21], v19, s[20:23], 0 offen sc1
    s_mov_b64 exec, -1
L_f1_fused_ker_w0_6:
    v_mov_b32 v204, -1
    v_mov_b32 v205, -1
    v_mov_b32 v206, -1
    v_mov_b32 v207, -1
    v_lshlrev_b32 v203, 4, v1
    s_lshl_b32 s46, s45, 3
    s_lshl_b32 s47, s24, 1
    s_add_u32 s46, s46, s47
    s_lshl_b32 s46, s46, 5
    s_add_u32 s46, s46, s44
    s_lshl_b32 s46, s46, 10
    s_add_u32 s46, s46, 0xe00000
    buffer_store_dwordx4 v[204:207], v203, s[20:23], s46 offen sc1
    s_add_u32 s46, s46, 32768
    buffer_store_dwordx4 v[204:207], v203, s[20:23], s46 offen sc1
    s_mov_b32 s25, s44
    s_mov_b32 s26, s45
    s_setprio 0
    v_and_b32 v1, 63, v0
    v_lshrrev_b32 v10, 6, v0
    s_nop 0
    v_readfirstlane_b32 s24, v10
    v_lshlrev_b32 v2, 4, v1
    v_lshrrev_b32 v3, 5, v1
    v_lshlrev_b32 v3, 8, v3
    v_and_b32 v4, 15, v1
    v_lshl_add_u32 v3, v4, 4, v3
    s_mov_b32 s28, 0x0000ffff
    s_mov_b32 s29, 0x0000ffff
    s_lshl_b32 s34, s24, 10
    v_add_u32 v14, s34, v2
    s_add_u32 s34, s34, 0x1ffc00
    v_add_u32 v15, s34, v3
    v_subrev_u32 v16, 512, v15
    s_lshl_b32 s33, s25, 16
    s_add_u32 s30, s33, 0x300000
    s_mul_i32 s32, s24, 3072
    v_and_b32 v9, 27, v1
    v_cmp_eq_u32 vcc, 16, v9
    v_mov_b32 v4, 0x3f803f80
    v_mov_b32 v5, 0
    s_nop 1
    v_cndmask_b32 v4, v5, v4, vcc
    v_mov_b32 v5, v4
    v_mov_b32 v6, v4
    v_mov_b32 v7, v4
    s_mul_i32 s33, s24, 12288
    v_add_u32 v8, s33, v2
    s_mov_b32 s38, 0xffff0000
    s_mov_b32 s39, 0xffff0000
    s_mov_b64 exec, s[38:39]
    ds_write_b128 v8, v[4:7] offset:1024
    ds_write_b128 v8, v[4:7] offset:2048
    ds_write_b128 v8, v[4:7] offset:4096
    ds_write_b128 v8, v[4:7] offset:5120
    ds_write_b128 v8, v[4:7] offset:7168
    ds_write_b128 v8, v[4:7] offset:8192
    ds_write_b128 v8, v[4:7] offset:10240
    ds_write_b128 v8, v[4:7] offset:11264
    s_mov_b64 exec, -1
    v_and_b32 v20, 31, v1
    v_lshlrev_b32 v20, 3, v20
    s_lshr_b32 s36, s25, 2
    s_lshl_b32 s36, s36, 8
    s_add_u32 s36, s36, 0x41000
    v_add_u32 v20, s36, v20
    s_cmp_lg_u32 s24, 0
    s_cbranch_scc1 L_f1_fused_ker_w0_7
    s_mov_b32 s54, 0
L_f1_fused_ker_qw_8:
    buffer_load_dwordx2 v[22:23], v20, s[20:23], 0 offen sc1
    s_add_u32 s54, s54, 1
    s_waitcnt vmcnt(0)
    v_cmp_eq_u64 vcc, s[58:59], v[22:23]
    s_nop 3
    s_cmp_eq_u64 vcc, -1
    s_cbranch_scc1 L_f1_fused_ker_w0_7
    s_bcnt1_i32_b64 s36, vcc
    s_cmp_lt_u32 s36, 44
    s_cbranch_scc1 L_f1_fused_ker_qa_9
    s_cmp_lt_u32 s36, 60
    s_cbranch_scc1 L_f1_fused_ker_qb_10
    s_sleep 2
    s_branch L_f1_fused_ker_qc_11
L_f1_fused_ker_qa_9:
    s_sleep 32
    s_branch L_f1_fused_ker_qc_11
L_f1_fused_ker_qb_10:
    s_sleep 10
L_f1_fused_ker_qc_11:
    s_cmp_lt_u32 s54, 0x4000
    s_cbranch_scc1 L_f1_fused_ker_qw_8
L_f1_fused_ker_w0_7:
    s_waitcnt lgkmcnt(0)
    s_barrier
    s_lshl_b32 s36, s26, 3
    s_lshl_b32 s37, s24, 1
    s_add_u32 s36, s36, s37
    s_lshl_b32 s37, s25, 6
    s_add_u32 s37, s37, s36
    s_lshl_b32 s37, s37, 10
    s_add_u32 s37, s37, 0x100000
    s_add_u32 m0, s32, 0
    s_nop 0
    buffer_load_dwordx4 v14, s[20:23], s30 offen sc1 lds
    s_mov_b64 exec, s[28:29]
    buffer_load_dwordx4 v15, s[20:23], s30 offen offset:1024 sc1 lds
    buffer_load_dwordx4 v16, s[20:23], s30 offen offset:2048 sc1 lds
    s_mov_b64 exec, -1
    s_add_u32 s30, s30, 4096
    buffer_load_dwordx4 v[176:179], v2, s[20:23], s37 offen sc1
    buffer_load_dwordx4 v[180:183], v2, s[20:23], s37 offen offset:1024 sc1
    s_add_u32 m0, s32, 12288
    s_nop 0
    buffer_load_dwordx4 v14, s[20:23], s30 offen sc1 lds
    s_mov_b64 exec, s[28:29]
    buffer_load_dwordx4 v15, s[20:23], s30 offen offset:1024 sc1 lds
    buffer_load_dwordx4 v16, s[20:23], s30 offen offset:2048 sc1 lds
    s_mov_b64 exec, -1
    s_add_u32 s30, s30, 4096
    s_add_u32 m0, s32, 24576
    s_nop 0
    buffer_load_dwordx4 v14, s[20:23], s30 offen sc1 lds
    s_mov_b64 exec, s[28:29]
    buffer_load_dwordx4 v15, s[20:23], s30 offen offset:1024 sc1 lds
    buffer_load_dwordx4 v16, s[20:23], s30 offen offset:2048 sc1 lds
    s_mov_b64 exec, -1
    s_add_u32 s30, s30, 4096
    v_mov_b32 v96, 0
    v_mov_b32 v112, 0
    v_mov_b32 v97, 0
    v_mov_b32 v113, 0
    v_mov_b32 v98, 0
    v_mov_b32 v114, 0
    v_mov_b32 v99, 0
    v_mov_b32 v115, 0
    v_mov_b32 v100, 0
    v_mov_b32 v116, 0
    v_mov_b32 v101, 0
    v_mov_b32 v117, 0
    v_mov_b32 v102, 0
    v_mov_b32 v118, 0
    v_mov_b32 v103, 0
    v_mov_b32 v119, 0
    v_mov_b32 v104, 0
    v_mov_b32 v120, 0
    v_mov_b32 v105, 0
    v_mov_b32 v121, 0
    v_mov_b32 v106, 0
    v_mov_b32 v122, 0
    v_mov_b32 v107, 0
    v_mov_b32 v123, 0
    v_mov_b32 v108, 0
    v_mov_b32 v124, 0
    v_mov_b32 v109, 0
    v_mov_b32 v125, 0
    v_mov_b32 v110, 0
    v_mov_b32 v126, 0
    v_mov_b32 v111, 0
    v_mov_b32 v127, 0
    v_mov_b32 v168, 0
    v_mov_b32 v200, 0
    v_mov_b32 v169, 0
    v_mov_b32 v201, 0
    v_mov_b32 v170, 0
    v_mov_b32 v202, 0
    v_mov_b32 v171, 0
    v_mov_b32 v203, 0
    v_mov_b32 v172, 0
    v_mov_b32 v204, 0
    v_mov_b32 v173, 0
    v_mov_b32 v205, 0
    v_mov_b32 v174, 0
    v_mov_b32 v206, 0
    v_mov_b32 v175, 0
    v_mov_b32 v207, 0
    s_lshl_b32 s36, s26, 2
    s_add_u32 s36, s36, s24
    s_lshl_b32 s36, s36, 8
    s_lshl_b32 s37, s25, 3
    s_add_u32 s36, s36, s37
    s_add_u32 s36, s36, 0x46000
    v_mov_b32 v24, s36
    v_mov_b32 v26, s58
    v_mov_b32 v27, s59
    s_waitcnt vmcnt(6)
    s_barrier
    ds_read_b128 v[184:187], v2 offset:0
    ds_read_b128 v[188:191], v2 offset:3072
    s_waitcnt lgkmcnt(0)
    v_mfma_f32_32x32x16_bf16 v[64:79], v[184:187], v[176:179], 0
    v_mfma_f32_32x32x16_bf16 v[80:95], v[184:187], v[180:183], 0
    v_mfma_f32_32x32x16_bf16 v[128:143], v[188:191], v[176:179], 0
    v_mfma_f32_32x32x16_bf16 v[144:159], v[188:191], v[180:183], 0
    s_nop 9
    v_max3_f32 v10, v64, v65, v66
    v_max3_f32 v10, v67, v68, v10
    v_max3_f32 v10, v69, v70, v10
    v_max3_f32 v10, v71, v72, v10
    v_max3_f32 v10, v73, v74, v10
    v_max3_f32 v10, v75, v76, v10
    v_max3_f32 v10, v77, v78, v10
    v_max_f32 v10, v79, v10
    v_max3_f32 v11, v80, v81, v82
    v_max3_f32 v11, v83, v84, v11
    v_max3_f32 v11, v85, v86, v11
    v_max3_f32 v11, v87, v88, v11
    v_max3_f32 v11, v89, v90, v11
    v_max3_f32 v11, v91, v92, v11
    v_max3_f32 v11, v93, v94, v11
    v_max_f32 v11, v95, v11
    s_nop 4
    v_max3_f32 v10, v128, v129, v10
    v_max3_f32 v10, v130, v131, v10
    v_max3_f32 v10, v132, v133, v10
    v_max3_f32 v10, v134, v135, v10
    v_max3_f32 v10, v136, v137, v10
    v_max3_f32 v10, v138, v139, v10
    v_max3_f32 v10, v140, v141, v10
    v_max3_f32 v10, v142, v143, v10
    v_max3_f32 v11, v144, v145, v11
    v_max3_f32 v11, v146, v147, v11
    v_max3_f32 v11, v148, v149, v11
    v_max3_f32 v11, v150, v151, v11
    v_max3_f32 v11, v152, v153, v11
    v_max3_f32 v11, v154, v155, v11
    v_max3_f32 v11, v156, v157, v11
    v_max3_f32 v11, v158, v159, v11
    v_mov_b32 v12, v10
    v_mov_b32 v13, v11
    s_nop 1
    v_permlane32_swap_b32 v10, v12
    v_permlane32_swap_b32 v11, v13
    s_nop 1
    v_max_f32 v10, v10, v12
    v_max_f32 v11, v11, v13
    v_sub_f32 v10, 0xc2b40000, v10
    v_sub_f32 v11, 0xc2b40000, v11
    v_mov_b32 v128, v10
    v_mov_b32 v144, v11
    v_mov_b32 v129, v10
    v_mov_b32 v145, v11
    v_mov_b32 v130, v10
    v_mov_b32 v146, v11
    v_mov_b32 v131, v10
    v_mov_b32 v147, v11
    v_mov_b32 v132, v10
    v_mov_b32 v148, v11
    v_mov_b32 v133, v10
    v_mov_b32 v149, v11
    v_mov_b32 v134, v10
    v_mov_b32 v150, v11
    v_mov_b32 v135, v10
    v_mov_b32 v151, v11
    v_mov_b32 v136, v10
    v_mov_b32 v152, v11
    v_mov_b32 v137, v10
    v_mov_b32 v153, v11
    v_mov_b32 v138, v10
    v_mov_b32 v154, v11
    v_mov_b32 v139, v10
    v_mov_b32 v155, v11
    v_mov_b32 v140, v10
    v_mov_b32 v156, v11
    v_mov_b32 v141, v10
    v_mov_b32 v157, v11
    v_mov_b32 v142, v10
    v_mov_b32 v158, v11
    v_mov_b32 v143, v10
    v_mov_b32 v159, v11
    s_nop 1
    v_mfma_f32_32x32x16_bf16 v[64:79], v[184:187], v[176:179], v[128:143]
    s_nop 11
    s_mov_b32 s36, 3
L_e2_loop:
    v_mfma_f32_32x32x16_bf16 v[80:95], v[184:187], v[180:183], v[144:159]
    ds_read_b128 v[192:195], v2 offset:1024
    v_exp_f32 v64, v64
    v_exp_f32 v65, v65
    v_exp_f32 v66, v66
    v_exp_f32 v67, v67
    v_cvt_pk_bf16_f32 v160, v64, v65
    v_exp_f32 v68, v68
    v_mfma_f32_32x32x16_bf16 v[112:127], v[200:203], v[168:171], v[112:127]
    ds_read_b128 v[196:199], v2 offset:2048
    v_exp_f32 v69, v69
    v_cvt_pk_bf16_f32 v161, v66, v67
    v_exp_f32 v70, v70
    v_exp_f32 v71, v71
    v_cvt_pk_bf16_f32 v162, v68, v69
    v_exp_f32 v72, v72
    v_exp_f32 v73, v73
    v_cvt_pk_bf16_f32 v163, v70, v71
    v_mfma_f32_32x32x16_bf16 v[112:127], v[204:207], v[172:175], v[112:127]
    s_waitcnt lgkmcnt(1)
    v_exp_f32 v74, v74
    v_exp_f32 v75, v75
    v_cvt_pk_bf16_f32 v164, v72, v73
    v_exp_f32 v76, v76
    v_exp_f32 v77, v77
    v_cvt_pk_bf16_f32 v165, v74, v75
    v_exp_f32 v78, v78
    v_exp_f32 v79, v79
    v_cvt_pk_bf16_f32 v166, v76, v77
    v_cvt_pk_bf16_f32 v167, v78, v79
    v_mfma_f32_32x32x16_bf16 v[64:79], v[188:191], v[176:179], v[128:143]
    ds_read_b128 v[184:187], v2 offset:6144
    v_exp_f32 v80, v80
    v_exp_f32 v81, v81
    v_exp_f32 v82, v82
    v_exp_f32 v83, v83
    v_cvt_pk_bf16_f32 v168, v80, v81
    v_exp_f32 v84, v84
    v_mfma_f32_32x32x16_bf16 v[96:111], v[192:195], v[160:163], v[96:111]
    s_waitcnt lgkmcnt(1)
    v_exp_f32 v85, v85
    v_cvt_pk_bf16_f32 v169, v82, v83
    v_exp_f32 v86, v86
    v_exp_f32 v87, v87
    v_cvt_pk_bf16_f32 v170, v84, v85
    v_exp_f32 v88, v88
    v_exp_f32 v89, v89
    v_cvt_pk_bf16_f32 v171, v86, v87
    v_mfma_f32_32x32x16_bf16 v[96:111], v[196:199], v[164:167], v[96:111]
    v_exp_f32 v90, v90
    v_exp_f32 v91, v91
    v_cvt_pk_bf16_f32 v172, v88, v89
    v_exp_f32 v92, v92
    v_exp_f32 v93, v93
    v_cvt_pk_bf16_f32 v173, v90, v91
    v_exp_f32 v94, v94
    v_exp_f32 v95, v95
    v_cvt_pk_bf16_f32 v174, v92, v93
    v_cvt_pk_bf16_f32 v175, v94, v95
    v_mfma_f32_32x32x16_bf16 v[80:95], v[188:191], v[180:183], v[144:159]
    ds_read_b128 v[200:203], v2 offset:4096
    v_exp_f32 v64, v64
    v_exp_f32 v65, v65
    v_exp_f32 v66, v66
    v_exp_f32 v67, v67
    v_cvt_pk_bf16_f32 v160, v64, v65
    v_exp_f32 v68, v68
    v_mfma_f32_32x32x16_bf16 v[112:127], v[192:195], v[168:171], v[112:127]
    ds_read_b128 v[204:207], v2 offset:5120
    v_exp_f32 v69, v69
    v_cvt_pk_bf16_f32 v161, v66, v67
    v_exp_f32 v70, v70
    v_exp_f32 v71, v71
    v_cvt_pk_bf16_f32 v162, v68, v69
    v_exp_f32 v72, v72
    v_exp_f32 v73, v73
    v_cvt_pk_bf16_f32 v163, v70, v71
    v_mfma_f32_32x32x16_bf16 v[112:127], v[196:199], v[172:175], v[112:127]
    s_waitcnt lgkmcnt(1)
    v_exp_f32 v74, v74
    v_exp_f32 v75, v75
    v_cvt_pk_bf16_f32 v164, v72, v73
    v_exp_f32 v76, v76
    v_exp_f32 v77, v77
    v_cvt_pk_bf16_f32 v165, v74, v75
    v_exp_f32 v78, v78
    v_exp_f32 v79, v79
    v_cvt_pk_bf16_f32 v166, v76, v77
    v_cvt_pk_bf16_f32 v167, v78, v79
    v_mfma_f32_32x32x16_bf16 v[64:79], v[184:187], v[176:179], v[128:143]
    ds_read_b128 v[188:191], v2 offset:9216
    v_exp_f32 v80, v80
    v_exp_f32 v81, v81
    v_exp_f32 v82, v82
    v_exp_f32 v83, v83
    v_cvt_pk_bf16_f32 v168, v80, v81
    v_exp_f32 v84, v84
    v_mfma_f32_32x32x16_bf16 v[96:111], v[200:203], v[160:163], v[96:111]
    s_waitcnt lgkmcnt(1)
    v_exp_f32 v85, v85
    v_cvt_pk_bf16_f32 v169, v82, v83
    v_exp_f32 v86, v86
    v_exp_f32 v87, v87
    v_cvt_pk_bf16_f32 v170, v84, v85
    v_exp_f32 v88, v88
    v_exp_f32 v89, v89
    v_cvt_pk_bf16_f32 v171, v86, v87
    v_mfma_f32_32x32x16_bf16 v[96:111], v[204:207], v[164:167], v[96:111]
    v_exp_f32 v90, v90
    v_exp_f32 v91, v91
    v_cvt_pk_bf16_f32 v172, v88, v89
    v_exp_f32 v92, v92
    v_exp_f32 v93, v93
    v_cvt_pk_bf16_f32 v173, v90, v91
    v_exp_f32 v94, v94
    v_exp_f32 v95, v95
    v_cvt_pk_bf16_f32 v174, v92, v93
    v_cvt_pk_bf16_f32 v175, v94, v95
    v_mfma_f32_32x32x16_bf16 v[80:95], v[184:187], v[180:183], v[144:159]
    ds_read_b128 v[192:195], v2 offset:7168
    v_exp_f32 v64, v64
    v_exp_f32 v65, v65
    v_exp_f32 v66, v66
    v_exp_f32 v67, v67
    v_cvt_pk_bf16_f32 v160, v64, v65
    v_exp_f32 v68, v68
    v_mfma_f32_32x32x16_bf16 v[112:127], v[200:203], v[168:171], v[112:127]
    ds_read_b128 v[196:199], v2 offset:8192
    v_exp_f32 v69, v69
    v_cvt_pk_bf16_f32 v161, v66, v67
    v_exp_f32 v70, v70
    v_exp_f32 v71, v71
    v_cvt_pk_bf16_f32 v162, v68, v69
    v_exp_f32 v72, v72
    v_exp_f32 v73, v73
    v_cvt_pk_bf16_f32 v163, v70, v71
    v_mfma_f32_32x32x16_bf16 v[112:127], v[204:207], v[172:175], v[112:127]
    s_waitcnt vmcnt(3) lgkmcnt(1)
    s_barrier
    v_exp_f32 v74, v74
    v_exp_f32 v75, v75
    v_cvt_pk_bf16_f32 v164, v72, v73
    v_exp_f32 v76, v76
    v_exp_f32 v77, v77
    v_cvt_pk_bf16_f32 v165, v74, v75
    v_exp_f32 v78, v78
    v_exp_f32 v79, v79
    v_cvt_pk_bf16_f32 v166, v76, v77
    v_cvt_pk_bf16_f32 v167, v78, v79
    v_mfma_f32_32x32x16_bf16 v[64:79], v[188:191], v[176:179], v[128:143]
    ds_read_b128 v[184:187], v2 offset:12288
    v_exp_f32 v80, v80
    v_exp_f32 v81, v81
    v_exp_f32 v82, v82
    v_exp_f32 v83, v83
    v_cvt_pk_bf16_f32 v168, v80, v81
    v_exp_f32 v84, v84
    v_mfma_f32_32x32x16_bf16 v[96:111], v[192:195], v[160:163], v[96:111]
    s_waitcnt lgkmcnt(1)
    s_add_u32 m0, s32, 36864
    s_nop 0
    buffer_load_dwordx4 v14, s[20:23], s30 offen sc1 lds
    v_exp_f32 v85, v85
    v_cvt_pk_bf16_f32 v169, v82, v83
    v_exp_f32 v86, v86
    v_exp_f32 v87, v87
    v_cvt_pk_bf16_f32 v170, v84, v85
    v_exp_f32 v88, v88
    v_exp_f32 v89, v89
    v_cvt_pk_bf16_f32 v171, v86, v87
    v_mfma_f32_32x32x16_bf16 v[96:111], v[196:199], v[164:167], v[96:111]
    s_mov_b64 exec, s[28:29]
    buffer_load_dwordx4 v15, s[20:23], s30 offen offset:1024 sc1 lds
    buffer_load_dwordx4 v16, s[20:23], s30 offen offset:2048 sc1 lds
    s_mov_b64 exec, -1
    s_add_u32 s30, s30, 4096
    v_exp_f32 v90, v90
    v_exp_f32 v91, v91
    v_cvt_pk_bf16_f32 v172, v88, v89
    v_exp_f32 v92, v92
    v_exp_f32 v93, v93
    v_cvt_pk_bf16_f32 v173, v90, v91
    v_exp_f32 v94, v94
    v_exp_f32 v95, v95
    v_cvt_pk_bf16_f32 v174, v92, v93
    v_cvt_pk_bf16_f32 v175, v94, v95
    v_mfma_f32_32x32x16_bf16 v[80:95], v[188:191], v[180:183], v[144:159]
    ds_read_b128 v[200:203], v2 offset:10240
    v_exp_f32 v64, v64
    v_exp_f32 v65, v65
    v_exp_f32 v66, v66
    v_exp_f32 v67, v67
    v_cvt_pk_bf16_f32 v160, v64, v65
    v_exp_f32 v68, v68
    v_mfma_f32_32x32x16_bf16 v[112:127], v[192:195], v[168:171], v[112:127]
    ds_read_b128 v[204:207], v2 offset:11264
    v_exp_f32 v69, v69
    v_cvt_pk_bf16_f32 v161, v66, v67
    v_exp_f32 v70, v70
    v_exp_f32 v71, v71
    v_cvt_pk_bf16_f32 v162, v68, v69
    v_exp_f32 v72, v72
    v_exp_f32 v73, v73
    v_cvt_pk_bf16_f32 v163, v70, v71
    v_mfma_f32_32x32x16_bf16 v[112:127], v[196:199], v[172:175], v[112:127]
    s_waitcnt lgkmcnt(1)
    v_exp_f32 v74, v74
    v_exp_f32 v75, v75
    v_cvt_pk_bf16_f32 v164, v72, v73
    v_exp_f32 v76, v76
    v_exp_f32 v77, v77
    v_cvt_pk_bf16_f32 v165, v74, v75
    v_exp_f32 v78, v78
    v_exp_f32 v79, v79
    v_cvt_pk_bf16_f32 v166, v76, v77
    v_cvt_pk_bf16_f32 v167, v78, v79
    v_mfma_f32_32x32x16_bf16 v[64:79], v[184:187], v[176:179], v[128:143]
    ds_read_b128 v[188:191], v2 offset:15360
    v_exp_f32 v80, v80
    v_exp_f32 v81, v81
    v_exp_f32 v82, v82
    v_exp_f32 v83, v83
    v_cvt_pk_bf16_f32 v168, v80, v81
    v_exp_f32 v84, v84
    v_mfma_f32_32x32x16_bf16 v[96:111], v[200:203], v[160:163], v[96:111]
    s_waitcnt lgkmcnt(1)
    v_exp_f32 v85, v85
    v_cvt_pk_bf16_f32 v169, v82, v83
    v_exp_f32 v86, v86
    v_exp_f32 v87, v87
    v_cvt_pk_bf16_f32 v170, v84, v85
    v_exp_f32 v88, v88
    v_exp_f32 v89, v89
    v_cvt_pk_bf16_f32 v171, v86, v87
    v_mfma_f32_32x32x16_bf16 v[96:111], v[204:207], v[164:167], v[96:111]
    v_exp_f32 v90, v90
    v_exp_f32 v91, v91
    v_cvt_pk_bf16_f32 v172, v88, v89
    v_exp_f32 v92, v92
    v_exp_f32 v93, v93
    v_cvt_pk_bf16_f32 v173, v90, v91
    v_exp_f32 v94, v94
    v_exp_f32 v95, v95
    v_cvt_pk_bf16_f32 v174, v92, v93
    v_cvt_pk_bf16_f32 v175, v94, v95
    v_mfma_f32_32x32x16_bf16 v[80:95], v[184:187], v[180:183], v[144:159]
    ds_read_b128 v[192:195], v2 offset:13312
    v_exp_f32 v64, v64
    v_exp_f32 v65, v65
    v_exp_f32 v66, v66
    v_exp_f32 v67, v67
    v_cvt_pk_bf16_f32 v160, v64, v65
    v_exp_f32 v68, v68
    v_mfma_f32_32x32x16_bf16 v[112:127], v[200:203], v[168:171], v[112:127]
    ds_read_b128 v[196:199], v2 offset:14336
    v_exp_f32 v69, v69
    v_cvt_pk_bf16_f32 v161, v66, v67
    v_exp_f32 v70, v70
    v_exp_f32 v71, v71
    v_cvt_pk_bf16_f32 v162, v68, v69
    v_exp_f32 v72, v72
    v_exp_f32 v73, v73
    v_cvt_pk_bf16_f32 v163, v70, v71
    v_mfma_f32_32x32x16_bf16 v[112:127], v[204:207], v[172:175], v[112:127]
    s_waitcnt lgkmcnt(1)
    v_exp_f32 v74, v74
    v_exp_f32 v75, v75
    v_cvt_pk_bf16_f32 v164, v72, v73
    v_exp_f32 v76, v76
    v_exp_f32 v77, v77
    v_cvt_pk_bf16_f32 v165, v74, v75
    v_exp_f32 v78, v78
    v_exp_f32 v79, v79
    v_cvt_pk_bf16_f32 v166, v76, v77
    v_cvt_pk_bf16_f32 v167, v78, v79
    v_mfma_f32_32x32x16_bf16 v[64:79], v[188:191], v[176:179], v[128:143]
    ds_read_b128 v[184:187], v2 offset:18432
    v_exp_f32 v80, v80
    v_exp_f32 v81, v81
    v_exp_f32 v82, v82
    v_exp_f32 v83, v83
    v_cvt_pk_bf16_f32 v168, v80, v81
    v_exp_f32 v84, v84
    v_mfma_f32_32x32x16_bf16 v[96:111], v[192:195], v[160:163], v[96:111]
    s_waitcnt lgkmcnt(1)
    v_exp_f32 v85, v85
    v_cvt_pk_bf16_f32 v169, v82, v83
    v_exp_f32 v86, v86
    v_exp_f32 v87, v87
    v_cvt_pk_bf16_f32 v170, v84, v85
    v_exp_f32 v88, v88
    v_exp_f32 v89, v89
    v_cvt_pk_bf16_f32 v171, v86, v87
    v_mfma_f32_32x32x16_bf16 v[96:111], v[196:199], v[164:167], v[96:111]
    v_exp_f32 v90, v90
    v_exp_f32 v91, v91
    v_cvt_pk_bf16_f32 v172, v88, v89
    v_exp_f32 v92, v92
    v_exp_f32 v93, v93
    v_cvt_pk_bf16_f32 v173, v90, v91
    v_exp_f32 v94, v94
    v_exp_f32 v95, v95
    v_cvt_pk_bf16_f32 v174, v92, v93
    v_cvt_pk_bf16_f32 v175, v94, v95
    v_mfma_f32_32x32x16_bf16 v[80:95], v[188:191], v[180:183], v[144:159]
    ds_read_b128 v[200:203], v2 offset:16384
    v_exp_f32 v64, v64
    v_exp_f32 v65, v65
    v_exp_f32 v66, v66
    v_exp_f32 v67, v67
    v_cvt_pk_bf16_f32 v160, v64, v65
    v_exp_f32 v68, v68
    v_mfma_f32_32x32x16_bf16 v[112:127], v[192:195], v[168:171], v[112:127]
    ds_read_b128 v[204:207], v2 offset:17408
    v_exp_f32 v69, v69
    v_cvt_pk_bf16_f32 v161, v66, v67
    v_exp_f32 v70, v70
    v_exp_f32 v71, v71
    v_cvt_pk_bf16_f32 v162, v68, v69
    v_exp_f32 v72, v72
    v_exp_f32 v73, v73
    v_cvt_pk_bf16_f32 v163, v70, v71
    v_mfma_f32_32x32x16_bf16 v[112:127], v[196:199], v[172:175], v[112:127]
    s_waitcnt lgkmcnt(1)
    v_exp_f32 v74, v74
    v_exp_f32 v75, v75
    v_cvt_pk_bf16_f32 v164, v72, v73
    v_exp_f32 v76, v76
    v_exp_f32 v77, v77
    v_cvt_pk_bf16_f32 v165, v74, v75
    v_exp_f32 v78, v78
    v_exp_f32 v79, v79
    v_cvt_pk_bf16_f32 v166, v76, v77
    v_cvt_pk_bf16_f32 v167, v78, v79
    v_mfma_f32_32x32x16_bf16 v[64:79], v[184:187], v[176:179], v[128:143]
    ds_read_b128 v[188:191], v2 offset:21504
    v_exp_f32 v80, v80
    v_exp_f32 v81, v81
    v_exp_f32 v82, v82
    v_exp_f32 v83, v83
    v_cvt_pk_bf16_f32 v168, v80, v81
    v_exp_f32 v84, v84
    v_mfma_f32_32x32x16_bf16 v[96:111], v[200:203], v[160:163], v[96:111]
    s_waitcnt lgkmcnt(1)
    v_exp_f32 v85, v85
    v_cvt_pk_bf16_f32 v169, v82, v83
    v_exp_f32 v86, v86
    v_exp_f32 v87, v87
    v_cvt_pk_bf16_f32 v170, v84, v85
    v_exp_f32 v88, v88
    v_exp_f32 v89, v89
    v_cvt_pk_bf16_f32 v171, v86, v87
    v_mfma_f32_32x32x16_bf16 v[96:111], v[204:207], v[164:167], v[96:111]
    v_exp_f32 v90, v90
    v_exp_f32 v91, v91
    v_cvt_pk_bf16_f32 v172, v88, v89
    v_exp_f32 v92, v92
    v_exp_f32 v93, v93
    v_cvt_pk_bf16_f32 v173, v90, v91
    v_exp_f32 v94, v94
    v_exp_f32 v95, v95
    v_cvt_pk_bf16_f32 v174, v92, v93
    v_cvt_pk_bf16_f32 v175, v94, v95
    v_mfma_f32_32x32x16_bf16 v[80:95], v[184:187], v[180:183], v[144:159]
    ds_read_b128 v[192:195], v2 offset:19456
    v_exp_f32 v64, v64
    v_exp_f32 v65, v65
    v_exp_f32 v66, v66
    v_exp_f32 v67, v67
    v_cvt_pk_bf16_f32 v160, v64, v65
    v_exp_f32 v68, v68
    v_mfma_f32_32x32x16_bf16 v[112:127], v[200:203], v[168:171], v[112:127]
    ds_read_b128 v[196:199], v2 offset:20480
    v_exp_f32 v69, v69
    v_cvt_pk_bf16_f32 v161, v66, v67
    v_exp_f32 v70, v70
    v_exp_f32 v71, v71
    v_cvt_pk_bf16_f32 v162, v68, v69
    v_exp_f32 v72, v72
    v_exp_f32 v73, v73
    v_cvt_pk_bf16_f32 v163, v70, v71
    v_mfma_f32_32x32x16_bf16 v[112:127], v[204:207], v[172:175], v[112:127]
    s_waitcnt vmcnt(3) lgkmcnt(1)
    s_barrier
    v_exp_f32 v74, v74
    v_exp_f32 v75, v75
    v_cvt_pk_bf16_f32 v164, v72, v73
    v_exp_f32 v76, v76
    v_exp_f32 v77, v77
    v_cvt_pk_bf16_f32 v165, v74, v75
    v_exp_f32 v78, v78
    v_exp_f32 v79, v79
    v_cvt_pk_bf16_f32 v166, v76, v77
    v_cvt_pk_bf16_f32 v167, v78, v79
    v_mfma_f32_32x32x16_bf16 v[64:79], v[188:191], v[176:179], v[128:143]
    ds_read_b128 v[184:187], v2 offset:24576
    v_exp_f32 v80, v80
    v_exp_f32 v81, v81
    v_exp_f32 v82, v82
    v_exp_f32 v83, v83
    v_cvt_pk_bf16_f32 v168, v80, v81
    v_exp_f32 v84, v84
    v_mfma_f32_32x32x16_bf16 v[96:111], v[192:195], v[160:163], v[96:111]
    s_waitcnt lgkmcnt(1)
    s_add_u32 m0, s32, 0
    s_nop 0
    buffer_load_dwordx4 v14, s[20:23], s30 offen sc1 lds
    v_exp_f32 v85, v85
    v_cvt_pk_bf16_f32 v169, v82, v83
    v_exp_f32 v86, v86
    v_exp_f32 v87, v87
    v_cvt_pk_bf16_f32 v170, v84, v85
    v_exp_f32 v88, v88
    v_exp_f32 v89, v89
    v_cvt_pk_bf16_f32 v171, v86, v87
    v_mfma_f32_32x32x16_bf16 v[96:111], v[196:199], v[164:167], v[96:111]
    s_mov_b64 exec, s[28:29]
    buffer_load_dwordx4 v15, s[20:23], s30 offen offset:1024 sc1 lds
    buffer_load_dwordx4 v16, s[20:23], s30 offen offset:2048 sc1 lds
    s_mov_b64 exec, -1
    s_add_u32 s30, s30, 4096
    v_exp_f32 v90, v90
    v_exp_f32 v91, v91
    v_cvt_pk_bf16_f32 v172, v88, v89
    v_exp_f32 v92, v92
    v_exp_f32 v93, v93
    v_cvt_pk_bf16_f32 v173, v90, v91
    v_exp_f32 v94, v94
    v_exp_f32 v95, v95
    v_cvt_pk_bf16_f32 v174, v92, v93
    v_cvt_pk_bf16_f32 v175, v94, v95
    v_mfma_f32_32x32x16_bf16 v[80:95], v[188:191], v[180:183], v[144:159]
    ds_read_b128 v[200:203], v2 offset:22528
    v_exp_f32 v64, v64
    v_exp_f32 v65, v65
    v_exp_f32 v66, v66
    v_exp_f32 v67, v67
    v_cvt_pk_bf16_f32 v160, v64, v65
    v_exp_f32 v68, v68
    v_mfma_f32_32x32x16_bf16 v[112:127], v[192:195], v[168:171], v[112:127]
    ds_read_b128 v[204:207], v2 offset:23552
    v_exp_f32 v69, v69
    v_cvt_pk_bf16_f32 v161, v66, v67
    v_exp_f32 v70, v70
    v_exp_f32 v71, v71
    v_cvt_pk_bf16_f32 v162, v68, v69
    v_exp_f32 v72, v72
    v_exp_f32 v73, v73
    v_cvt_pk_bf16_f32 v163, v70, v71
    v_mfma_f32_32x32x16_bf16 v[112:127], v[196:199], v[172:175], v[112:127]
    s_waitcnt lgkmcnt(1)
    v_exp_f32 v74, v74
    v_exp_f32 v75, v75
    v_cvt_pk_bf16_f32 v164, v72, v73
    v_exp_f32 v76, v76
    v_exp_f32 v77, v77
    v_cvt_pk_bf16_f32 v165, v74, v75
    v_exp_f32 v78, v78
    v_exp_f32 v79, v79
    v_cvt_pk_bf16_f32 v166, v76, v77
    v_cvt_pk_bf16_f32 v167, v78, v79
    v_mfma_f32_32x32x16_bf16 v[64:79], v[184:187], v[176:179], v[128:143]
    ds_read_b128 v[188:191], v2 offset:27648
    v_exp_f32 v80, v80
    v_exp_f32 v81, v81
    v_exp_f32 v82, v82
    v_exp_f32 v83, v83
    v_cvt_pk_bf16_f32 v168, v80, v81
    v_exp_f32 v84, v84
    v_mfma_f32_32x32x16_bf16 v[96:111], v[200:203], v[160:163], v[96:111]
    s_waitcnt lgkmcnt(1)
    v_exp_f32 v85, v85
    v_cvt_pk_bf16_f32 v169, v82, v83
    v_exp_f32 v86, v86
    v_exp_f32 v87, v87
    v_cvt_pk_bf16_f32 v170, v84, v85
    v_exp_f32 v88, v88
    v_exp_f32 v89, v89
    v_cvt_pk_bf16_f32 v171, v86, v87
    v_mfma_f32_32x32x16_bf16 v[96:111], v[204:207], v[164:167], v[96:111]
    v_exp_f32 v90, v90
    v_exp_f32 v91, v91
    v_cvt_pk_bf16_f32 v172, v88, v89
    v_exp_f32 v92, v92
    v_exp_f32 v93, v93
    v_cvt_pk_bf16_f32 v173, v90, v91
    v_exp_f32 v94, v94
    v_exp_f32 v95, v95
    v_cvt_pk_bf16_f32 v174, v92, v93
    v_cvt_pk_bf16_f32 v175, v94, v95
    v_mfma_f32_32x32x16_bf16 v[80:95], v[184:187], v[180:183], v[144:159]
    ds_read_b128 v[192:195], v2 offset:25600
    v_exp_f32 v64, v64
    v_exp_f32 v65, v65
    v_exp_f32 v66, v66
    v_exp_f32 v67, v67
    v_cvt_pk_bf16_f32 v160, v64, v65
    v_exp_f32 v68, v68
    v_mfma_f32_32x32x16_bf16 v[112:127], v[200:203], v[168:171], v[112:127]
    ds_read_b128 v[196:199], v2 offset:26624
    v_exp_f32 v69, v69
    v_cvt_pk_bf16_f32 v161, v66, v67
    v_exp_f32 v70, v70
    v_exp_f32 v71, v71
    v_cvt_pk_bf16_f32 v162, v68, v69
    v_exp_f32 v72, v72
    v_exp_f32 v73, v73
    v_cvt_pk_bf16_f32 v163, v70, v71
    v_mfma_f32_32x32x16_bf16 v[112:127], v[204:207], v[172:175], v[112:127]
    s_waitcnt lgkmcnt(1)
    v_exp_f32 v74, v74
    v_exp_f32 v75, v75
    v_cvt_pk_bf16_f32 v164, v72, v73
    v_exp_f32 v76, v76
    v_exp_f32 v77, v77
    v_cvt_pk_bf16_f32 v165, v74, v75
    v_exp_f32 v78, v78
    v_exp_f32 v79, v79
    v_cvt_pk_bf16_f32 v166, v76, v77
    v_cvt_pk_bf16_f32 v167, v78, v79
    v_mfma_f32_32x32x16_bf16 v[64:79], v[188:191], v[176:179], v[128:143]
    ds_read_b128 v[184:187], v2 offset:30720
    v_exp_f32 v80, v80
    v_exp_f32 v81, v81
    v_exp_f32 v82, v82
    v_exp_f32 v83, v83
    v_cvt_pk_bf16_f32 v168, v80, v81
    v_exp_f32 v84, v84
    v_mfma_f32_32x32x16_bf16 v[96:111], v[192:195], v[160:163], v[96:111]
    s_waitcnt lgkmcnt(1)
    v_exp_f32 v85, v85
    v_cvt_pk_bf16_f32 v169, v82, v83
    v_exp_f32 v86, v86
    v_exp_f32 v87, v87
    v_cvt_pk_bf16_f32 v170, v84, v85
    v_exp_f32 v88, v88
    v_exp_f32 v89, v89
    v_cvt_pk_bf16_f32 v171, v86, v87
    v_mfma_f32_32x32x16_bf16 v[96:111], v[196:199], v[164:167], v[96:111]
    v_exp_f32 v90, v90
    v_exp_f32 v91, v91
    v_cvt_pk_bf16_f32 v172, v88, v89
    v_exp_f32 v92, v92
    v_exp_f32 v93, v93
    v_cvt_pk_bf16_f32 v173, v90, v91
    v_exp_f32 v94, v94
    v_exp_f32 v95, v95
    v_cvt_pk_bf16_f32 v174, v92, v93
    v_cvt_pk_bf16_f32 v175, v94, v95
    v_mfma_f32_32x32x16_bf16 v[80:95], v[188:191], v[180:183], v[144:159]
    ds_read_b128 v[200:203], v2 offset:28672
    v_exp_f32 v64, v64
    v_exp_f32 v65, v65
    v_exp_f32 v66, v66
    v_exp_f32 v67, v67
    v_cvt_pk_bf16_f32 v160, v64, v65
    v_exp_f32 v68, v68
    v_mfma_f32_32x32x16_bf16 v[112:127], v[192:195], v[168:171], v[112:127]
    ds_read_b128 v[204:207], v2 offset:29696
    v_exp_f32 v69, v69
    v_cvt_pk_bf16_f32 v161, v66, v67
    v_exp_f32 v70, v70
    v_exp_f32 v71, v71
    v_cvt_pk_bf16_f32 v162, v68, v69
    v_exp_f32 v72, v72
    v_exp_f32 v73, v73
    v_cvt_pk_bf16_f32 v163, v70, v71
    v_mfma_f32_32x32x16_bf16 v[112:127], v[196:199], v[172:175], v[112:127]
    s_waitcnt lgkmcnt(1)
    v_exp_f32 v74, v74
    v_exp_f32 v75, v75
    v_cvt_pk_bf16_f32 v164, v72, v73
    v_exp_f32 v76, v76
    v_exp_f32 v77, v77
    v_cvt_pk_bf16_f32 v165, v74, v75
    v_exp_f32 v78, v78
    v_exp_f32 v79, v79
    v_cvt_pk_bf16_f32 v166, v76, v77
    v_cvt_pk_bf16_f32 v167, v78, v79
    v_mfma_f32_32x32x16_bf16 v[64:79], v[184:187], v[176:179], v[128:143]
    ds_read_b128 v[188:191], v2 offset:33792
    v_exp_f32 v80, v80
    v_exp_f32 v81, v81
    v_exp_f32 v82, v82
    v_exp_f32 v83, v83
    v_cvt_pk_bf16_f32 v168, v80, v81
    v_exp_f32 v84, v84
    v_mfma_f32_32x32x16_bf16 v[96:111], v[200:203], v[160:163], v[96:111]
    s_waitcnt lgkmcnt(1)
    v_exp_f32 v85, v85
    v_cvt_pk_bf16_f32 v169, v82, v83
    v_exp_f32 v86, v86
    v_exp_f32 v87, v87
    v_cvt_pk_bf16_f32 v170, v84, v85
    v_exp_f32 v88, v88
    v_exp_f32 v89, v89
    v_cvt_pk_bf16_f32 v171, v86, v87
    v_mfma_f32_32x32x16_bf16 v[96:111], v[204:207], v[164:167], v[96:111]
    v_exp_f32 v90, v90
    v_exp_f32 v91, v91
    v_cvt_pk_bf16_f32 v172, v88, v89
    v_exp_f32 v92, v92
    v_exp_f32 v93, v93
    v_cvt_pk_bf16_f32 v173, v90, v91
    v_exp_f32 v94, v94
    v_exp_f32 v95, v95
    v_cvt_pk_bf16_f32 v174, v92, v93
    v_cvt_pk_bf16_f32 v175, v94, v95
    v_mfma_f32_32x32x16_bf16 v[80:95], v[184:187], v[180:183], v[144:159]
    ds_read_b128 v[192:195], v2 offset:31744
    v_exp_f32 v64, v64
    v_exp_f32 v65, v65
    v_exp_f32 v66, v66
    v_exp_f32 v67, v67
    v_cvt_pk_bf16_f32 v160, v64, v65
    v_exp_f32 v68, v68
    v_mfma_f32_32x32x16_bf16 v[112:127], v[200:203], v[168:171], v[112:127]
    ds_read_b128 v[196:199], v2 offset:32768
    v_exp_f32 v69, v69
    v_cvt_pk_bf16_f32 v161, v66, v67
    v_exp_f32 v70, v70
    v_exp_f32 v71, v71
    v_cvt_pk_bf16_f32 v162, v68, v69
    v_exp_f32 v72, v72
    v_exp_f32 v73, v73
    v_cvt_pk_bf16_f32 v163, v70, v71
    v_mfma_f32_32x32x16_bf16 v[112:127], v[204:207], v[172:175], v[112:127]
    s_waitcnt vmcnt(3) lgkmcnt(1)
    s_barrier
    v_exp_f32 v74, v74
    v_exp_f32 v75, v75
    v_cvt_pk_bf16_f32 v164, v72, v73
    v_exp_f32 v76, v76
    v_exp_f32 v77, v77
    v_cvt_pk_bf16_f32 v165, v74, v75
    v_exp_f32 v78, v78
    v_exp_f32 v79, v79
    v_cvt_pk_bf16_f32 v166, v76, v77
    v_cvt_pk_bf16_f32 v167, v78, v79
    v_mfma_f32_32x32x16_bf16 v[64:79], v[188:191], v[176:179], v[128:143]
    ds_read_b128 v[184:187], v2 offset:36864
    v_exp_f32 v80, v80
    v_exp_f32 v81, v81
    v_exp_f32 v82, v82
    v_exp_f32 v83, v83
    v_cvt_pk_bf16_f32 v168, v80, v81
    v_exp_f32 v84, v84
    v_mfma_f32_32x32x16_bf16 v[96:111], v[192:195], v[160:163], v[96:111]
    s_waitcnt lgkmcnt(1)
    s_add_u32 m0, s32, 12288
    s_nop 0
    buffer_load_dwordx4 v14, s[20:23], s30 offen sc1 lds
    v_exp_f32 v85, v85
    v_cvt_pk_bf16_f32 v169, v82, v83
    v_exp_f32 v86, v86
    v_exp_f32 v87, v87
    v_cvt_pk_bf16_f32 v170, v84, v85
    v_exp_f32 v88, v88
    v_exp_f32 v89, v89
    v_cvt_pk_bf16_f32 v171, v86, v87
    v_mfma_f32_32x32x16_bf16 v[96:111], v[196:199], v[164:167], v[96:111]
    s_mov_b64 exec, s[28:29]
    buffer_load_dwordx4 v15, s[20:23], s30 offen offset:1024 sc1 lds
    buffer_load_dwordx4 v16, s[20:23], s30 offen offset:2048 sc1 lds
    s_mov_b64 exec, -1
    s_add_u32 s30, s30, 4096
    v_exp_f32 v90, v90
    v_exp_f32 v91, v91
    v_cvt_pk_bf16_f32 v172, v88, v89
    v_exp_f32 v92, v92
    v_exp_f32 v93, v93
    v_cvt_pk_bf16_f32 v173, v90, v91
    v_exp_f32 v94, v94
    v_exp_f32 v95, v95
    v_cvt_pk_bf16_f32 v174, v92, v93
    v_cvt_pk_bf16_f32 v175, v94, v95
    v_mfma_f32_32x32x16_bf16 v[80:95], v[188:191], v[180:183], v[144:159]
    ds_read_b128 v[200:203], v2 offset:34816
    v_exp_f32 v64, v64
    v_exp_f32 v65, v65
    v_exp_f32 v66, v66
    v_exp_f32 v67, v67
    v_cvt_pk_bf16_f32 v160, v64, v65
    v_exp_f32 v68, v68
    v_mfma_f32_32x32x16_bf16 v[112:127], v[192:195], v[168:171], v[112:127]
    ds_read_b128 v[204:207], v2 offset:35840
    v_exp_f32 v69, v69
    v_cvt_pk_bf16_f32 v161, v66, v67
    v_exp_f32 v70, v70
    v_exp_f32 v71, v71
    v_cvt_pk_bf16_f32 v162, v68, v69
    v_exp_f32 v72, v72
    v_exp_f32 v73, v73
    v_cvt_pk_bf16_f32 v163, v70, v71
    v_mfma_f32_32x32x16_bf16 v[112:127], v[196:199], v[172:175], v[112:127]
    s_waitcnt lgkmcnt(1)
    v_exp_f32 v74, v74
    v_exp_f32 v75, v75
    v_cvt_pk_bf16_f32 v164, v72, v73
    v_exp_f32 v76, v76
    v_exp_f32 v77, v77
    v_cvt_pk_bf16_f32 v165, v74, v75
    v_exp_f32 v78, v78
    v_exp_f32 v79, v79
    v_cvt_pk_bf16_f32 v166, v76, v77
    v_cvt_pk_bf16_f32 v167, v78, v79
    v_mfma_f32_32x32x16_bf16 v[64:79], v[184:187], v[176:179], v[128:143]
    ds_read_b128 v[188:191], v2 offset:39936
    v_exp_f32 v80, v80
    v_exp_f32 v81, v81
    v_exp_f32 v82, v82
    v_exp_f32 v83, v83
    v_cvt_pk_bf16_f32 v168, v80, v81
    v_exp_f32 v84, v84
    v_mfma_f32_32x32x16_bf16 v[96:111], v[200:203], v[160:163], v[96:111]
    s_waitcnt lgkmcnt(1)
    v_exp_f32 v85, v85
    v_cvt_pk_bf16_f32 v169, v82, v83
    v_exp_f32 v86, v86
    v_exp_f32 v87, v87
    v_cvt_pk_bf16_f32 v170, v84, v85
    v_exp_f32 v88, v88
    v_exp_f32 v89, v89
    v_cvt_pk_bf16_f32 v171, v86, v87
    v_mfma_f32_32x32x16_bf16 v[96:111], v[204:207], v[164:167], v[96:111]
    v_exp_f32 v90, v90
    v_exp_f32 v91, v91
    v_cvt_pk_bf16_f32 v172, v88, v89
    v_exp_f32 v92, v92
    v_exp_f32 v93, v93
    v_cvt_pk_bf16_f32 v173, v90, v91
    v_exp_f32 v94, v94
    v_exp_f32 v95, v95
    v_cvt_pk_bf16_f32 v174, v92, v93
    v_cvt_pk_bf16_f32 v175, v94, v95
    v_mfma_f32_32x32x16_bf16 v[80:95], v[184:187], v[180:183], v[144:159]
    ds_read_b128 v[192:195], v2 offset:37888
    v_exp_f32 v64, v64
    v_exp_f32 v65, v65
    v_exp_f32 v66, v66
    v_exp_f32 v67, v67
    v_cvt_pk_bf16_f32 v160, v64, v65
    v_exp_f32 v68, v68
    v_mfma_f32_32x32x16_bf16 v[112:127], v[200:203], v[168:171], v[112:127]
    ds_read_b128 v[196:199], v2 offset:38912
    v_exp_f32 v69, v69
    v_cvt_pk_bf16_f32 v161, v66, v67
    v_exp_f32 v70, v70
    v_exp_f32 v71, v71
    v_cvt_pk_bf16_f32 v162, v68, v69
    v_exp_f32 v72, v72
    v_exp_f32 v73, v73
    v_cvt_pk_bf16_f32 v163, v70, v71
    v_mfma_f32_32x32x16_bf16 v[112:127], v[204:207], v[172:175], v[112:127]
    s_waitcnt lgkmcnt(1)
    v_exp_f32 v74, v74
    v_exp_f32 v75, v75
    v_cvt_pk_bf16_f32 v164, v72, v73
    v_exp_f32 v76, v76
    v_exp_f32 v77, v77
    v_cvt_pk_bf16_f32 v165, v74, v75
    v_exp_f32 v78, v78
    v_exp_f32 v79, v79
    v_cvt_pk_bf16_f32 v166, v76, v77
    v_cvt_pk_bf16_f32 v167, v78, v79
    v_mfma_f32_32x32x16_bf16 v[64:79], v[188:191], v[176:179], v[128:143]
    ds_read_b128 v[184:187], v2 offset:43008
    v_exp_f32 v80, v80
    v_exp_f32 v81, v81
    v_exp_f32 v82, v82
    v_exp_f32 v83, v83
    v_cvt_pk_bf16_f32 v168, v80, v81
    v_exp_f32 v84, v84
    v_mfma_f32_32x32x16_bf16 v[96:111], v[192:195], v[160:163], v[96:111]
    s_waitcnt lgkmcnt(1)
    v_exp_f32 v85, v85
    v_cvt_pk_bf16_f32 v169, v82, v83
    v_exp_f32 v86, v86
    v_exp_f32 v87, v87
    v_cvt_pk_bf16_f32 v170, v84, v85
    v_exp_f32 v88, v88
    v_exp_f32 v89, v89
    v_cvt_pk_bf16_f32 v171, v86, v87
    v_mfma_f32_32x32x16_bf16 v[96:111], v[196:199], v[164:167], v[96:111]
    v_exp_f32 v90, v90
    v_exp_f32 v91, v91
    v_cvt_pk_bf16_f32 v172, v88, v89
    v_exp_f32 v92, v92
    v_exp_f32 v93, v93
    v_cvt_pk_bf16_f32 v173, v90, v91
    v_exp_f32 v94, v94
    v_exp_f32 v95, v95
    v_cvt_pk_bf16_f32 v174, v92, v93
    v_cvt_pk_bf16_f32 v175, v94, v95
    v_mfma_f32_32x32x16_bf16 v[80:95], v[188:191], v[180:183], v[144:159]
    ds_read_b128 v[200:203], v2 offset:40960
    v_exp_f32 v64, v64
    v_exp_f32 v65, v65
    v_exp_f32 v66, v66
    v_exp_f32 v67, v67
    v_cvt_pk_bf16_f32 v160, v64, v65
    v_exp_f32 v68, v68
    v_mfma_f32_32x32x16_bf16 v[112:127], v[192:195], v[168:171], v[112:127]
    ds_read_b128 v[204:207], v2 offset:41984
    v_exp_f32 v69, v69
    v_cvt_pk_bf16_f32 v161, v66, v67
    v_exp_f32 v70, v70
    v_exp_f32 v71, v71
    v_cvt_pk_bf16_f32 v162, v68, v69
    v_exp_f32 v72, v72
    v_exp_f32 v73, v73
    v_cvt_pk_bf16_f32 v163, v70, v71
    v_mfma_f32_32x32x16_bf16 v[112:127], v[196:199], v[172:175], v[112:127]
    s_waitcnt lgkmcnt(1)
    v_exp_f32 v74, v74
    v_exp_f32 v75, v75
    v_cvt_pk_bf16_f32 v164, v72, v73
    v_exp_f32 v76, v76
    v_exp_f32 v77, v77
    v_cvt_pk_bf16_f32 v165, v74, v75
    v_exp_f32 v78, v78
    v_exp_f32 v79, v79
    v_cvt_pk_bf16_f32 v166, v76, v77
    v_cvt_pk_bf16_f32 v167, v78, v79
    v_mfma_f32_32x32x16_bf16 v[64:79], v[184:187], v[176:179], v[128:143]
    ds_read_b128 v[188:191], v2 offset:46080
    v_exp_f32 v80, v80
    v_exp_f32 v81, v81
    v_exp_f32 v82, v82
    v_exp_f32 v83, v83
    v_cvt_pk_bf16_f32 v168, v80, v81
    v_exp_f32 v84, v84
    v_mfma_f32_32x32x16_bf16 v[96:111], v[200:203], v[160:163], v[96:111]
    s_waitcnt lgkmcnt(1)
    v_exp_f32 v85, v85
    v_cvt_pk_bf16_f32 v169, v82, v83
    v_exp_f32 v86, v86
    v_exp_f32 v87, v87
    v_cvt_pk_bf16_f32 v170, v84, v85
    v_exp_f32 v88, v88
    v_exp_f32 v89, v89
    v_cvt_pk_bf16_f32 v171, v86, v87
    v_mfma_f32_32x32x16_bf16 v[96:111], v[204:207], v[164:167], v[96:111]
    v_exp_f32 v90, v90
    v_exp_f32 v91, v91
    v_cvt_pk_bf16_f32 v172, v88, v89
    v_exp_f32 v92, v92
    v_exp_f32 v93, v93
    v_cvt_pk_bf16_f32 v173, v90, v91
    v_exp_f32 v94, v94
    v_exp_f32 v95, v95
    v_cvt_pk_bf16_f32 v174, v92, v93
    v_cvt_pk_bf16_f32 v175, v94, v95
    v_mfma_f32_32x32x16_bf16 v[80:95], v[184:187], v[180:183], v[144:159]
    ds_read_b128 v[192:195], v2 offset:44032
    v_exp_f32 v64, v64
    v_exp_f32 v65, v65
    v_exp_f32 v66, v66
    v_exp_f32 v67, v67
    v_cvt_pk_bf16_f32 v160, v64, v65
    v_exp_f32 v68, v68
    v_mfma_f32_32x32x16_bf16 v[112:127], v[200:203], v[168:171], v[112:127]
    ds_read_b128 v[196:199], v2 offset:45056
    v_exp_f32 v69, v69
    v_cvt_pk_bf16_f32 v161, v66, v67
    v_exp_f32 v70, v70
    v_exp_f32 v71, v71
    v_cvt_pk_bf16_f32 v162, v68, v69
    v_exp_f32 v72, v72
    v_exp_f32 v73, v73
    v_cvt_pk_bf16_f32 v163, v70, v71
    v_mfma_f32_32x32x16_bf16 v[112:127], v[204:207], v[172:175], v[112:127]
    s_waitcnt vmcnt(3) lgkmcnt(1)
    s_barrier
    v_exp_f32 v74, v74
    v_exp_f32 v75, v75
    v_cvt_pk_bf16_f32 v164, v72, v73
    v_exp_f32 v76, v76
    v_exp_f32 v77, v77
    v_cvt_pk_bf16_f32 v165, v74, v75
    v_exp_f32 v78, v78
    v_exp_f32 v79, v79
    v_cvt_pk_bf16_f32 v166, v76, v77
    v_cvt_pk_bf16_f32 v167, v78, v79
    v_mfma_f32_32x32x16_bf16 v[64:79], v[188:191], v[176:179], v[128:143]
    ds_read_b128 v[184:187], v2 offset:0
    v_exp_f32 v80, v80
    v_exp_f32 v81, v81
    v_exp_f32 v82, v82
    v_exp_f32 v83, v83
    v_cvt_pk_bf16_f32 v168, v80, v81
    v_exp_f32 v84, v84
    v_mfma_f32_32x32x16_bf16 v[96:111], v[192:195], v[160:163], v[96:111]
    s_waitcnt lgkmcnt(1)
    s_add_u32 m0, s32, 24576
    s_nop 0
    buffer_load_dwordx4 v14, s[20:23], s30 offen sc1 lds
    v_exp_f32 v85, v85
    v_cvt_pk_bf16_f32 v169, v82, v83
    v_exp_f32 v86, v86
    v_exp_f32 v87, v87
    v_cvt_pk_bf16_f32 v170, v84, v85
    v_exp_f32 v88, v88
    v_exp_f32 v89, v89
    v_cvt_pk_bf16_f32 v171, v86, v87
    v_mfma_f32_32x32x16_bf16 v[96:111], v[196:199], v[164:167], v[96:111]
    s_mov_b64 exec, s[28:29]
    buffer_load_dwordx4 v15, s[20:23], s30 offen offset:1024 sc1 lds
    buffer_load_dwordx4 v16, s[20:23], s30 offen offset:2048 sc1 lds
    s_mov_b64 exec, -1
    s_add_u32 s30, s30, 4096
    v_exp_f32 v90, v90
    v_exp_f32 v91, v91
    v_cvt_pk_bf16_f32 v172, v88, v89
    v_exp_f32 v92, v92
    v_exp_f32 v93, v93
    v_cvt_pk_bf16_f32 v173, v90, v91
    v_exp_f32 v94, v94
    v_exp_f32 v95, v95
    v_cvt_pk_bf16_f32 v174, v92, v93
    v_cvt_pk_bf16_f32 v175, v94, v95
    v_mfma_f32_32x32x16_bf16 v[80:95], v[188:191], v[180:183], v[144:159]
    ds_read_b128 v[200:203], v2 offset:47104
    v_exp_f32 v64, v64
    v_exp_f32 v65, v65
    v_exp_f32 v66, v66
    v_exp_f32 v67, v67
    v_cvt_pk_bf16_f32 v160, v64, v65
    v_exp_f32 v68, v68
    v_mfma_f32_32x32x16_bf16 v[112:127], v[192:195], v[168:171], v[112:127]
    ds_read_b128 v[204:207], v2 offset:48128
    v_exp_f32 v69, v69
    v_cvt_pk_bf16_f32 v161, v66, v67
    v_exp_f32 v70, v70
    v_exp_f32 v71, v71
    v_cvt_pk_bf16_f32 v162, v68, v69
    v_exp_f32 v72, v72
    v_exp_f32 v73, v73
    v_cvt_pk_bf16_f32 v163, v70, v71
    v_mfma_f32_32x32x16_bf16 v[112:127], v[196:199], v[172:175], v[112:127]
    s_waitcnt lgkmcnt(1)
    v_exp_f32 v74, v74
    v_exp_f32 v75, v75
    v_cvt_pk_bf16_f32 v164, v72, v73
    v_exp_f32 v76, v76
    v_exp_f32 v77, v77
    v_cvt_pk_bf16_f32 v165, v74, v75
    v_exp_f32 v78, v78
    v_exp_f32 v79, v79
    v_cvt_pk_bf16_f32 v166, v76, v77
    v_cvt_pk_bf16_f32 v167, v78, v79
    v_mfma_f32_32x32x16_bf16 v[64:79], v[184:187], v[176:179], v[128:143]
    ds_read_b128 v[188:191], v2 offset:3072
    v_exp_f32 v80, v80
    v_exp_f32 v81, v81
    v_exp_f32 v82, v82
    v_exp_f32 v83, v83
    v_cvt_pk_bf16_f32 v168, v80, v81
    v_exp_f32 v84, v84
    v_mfma_f32_32x32x16_bf16 v[96:111], v[200:203], v[160:163], v[96:111]
    s_waitcnt lgkmcnt(1)
    v_exp_f32 v85, v85
    v_cvt_pk_bf16_f32 v169, v82, v83
    v_exp_f32 v86, v86
    v_exp_f32 v87, v87
    v_cvt_pk_bf16_f32 v170, v84, v85
    v_exp_f32 v88, v88
    v_exp_f32 v89, v89
    v_cvt_pk_bf16_f32 v171, v86, v87
    v_mfma_f32_32x32x16_bf16 v[96:111], v[204:207], v[164:167], v[96:111]
    v_exp_f32 v90, v90
    v_exp_f32 v91, v91
    v_cvt_pk_bf16_f32 v172, v88, v89
    v_exp_f32 v92, v92
    v_exp_f32 v93, v93
    v_cvt_pk_bf16_f32 v173, v90, v91
    v_exp_f32 v94, v94
    v_exp_f32 v95, v95
    v_cvt_pk_bf16_f32 v174, v92, v93
    v_cvt_pk_bf16_f32 v175, v94, v95
    s_sub_u32 s36, s36, 1
    s_cmp_lg_u32 s36, 0
    s_cbranch_scc1 L_e2_loop
    v_mfma_f32_32x32x16_bf16 v[80:95], v[184:187], v[180:183], v[144:159]
    ds_read_b128 v[192:195], v2 offset:1024
    v_exp_f32 v64, v64
    v_exp_f32 v65, v65
    v_exp_f32 v66, v66
    v_exp_f32 v67, v67
    v_cvt_pk_bf16_f32 v160, v64, v65
    v_exp_f32 v68, v68
    v_mfma_f32_32x32x16_bf16 v[112:127], v[200:203], v[168:171], v[112:127]
    ds_read_b128 v[196:199], v2 offset:2048
    v_exp_f32 v69, v69
    v_cvt_pk_bf16_f32 v161, v66, v67
    v_exp_f32 v70, v70
    v_exp_f32 v71, v71
    v_cvt_pk_bf16_f32 v162, v68, v69
    v_exp_f32 v72, v72
    v_exp_f32 v73, v73
    v_cvt_pk_bf16_f32 v163, v70, v71
    v_mfma_f32_32x32x16_bf16 v[112:127], v[204:207], v[172:175], v[112:127]
    s_waitcnt lgkmcnt(1)
    v_exp_f32 v74, v74
    v_exp_f32 v75, v75
    v_cvt_pk_bf16_f32 v164, v72, v73
    v_exp_f32 v76, v76
    v_exp_f32 v77, v77
    v_cvt_pk_bf16_f32 v165, v74, v75
    v_exp_f32 v78, v78
    v_exp_f32 v79, v79
    v_cvt_pk_bf16_f32 v166, v76, v77
    v_cvt_pk_bf16_f32 v167, v78, v79
    v_mfma_f32_32x32x16_bf16 v[64:79], v[188:191], v[176:179], v[128:143]
    ds_read_b128 v[184:187], v2 offset:6144
    v_exp_f32 v80, v80
    v_exp_f32 v81, v81
    v_exp_f32 v82, v82
    v_exp_f32 v83, v83
    v_cvt_pk_bf16_f32 v168, v80, v81
    v_exp_f32 v84, v84
    v_mfma_f32_32x32x16_bf16 v[96:111], v[192:195], v[160:163], v[96:111]
    s_waitcnt lgkmcnt(1)
    v_exp_f32 v85, v85
    v_cvt_pk_bf16_f32 v169, v82, v83
    v_exp_f32 v86, v86
    v_exp_f32 v87, v87
    v_cvt_pk_bf16_f32 v170, v84, v85
    v_exp_f32 v88, v88
    v_exp_f32 v89, v89
    v_cvt_pk_bf16_f32 v171, v86, v87
    v_mfma_f32_32x32x16_bf16 v[96:111], v[196:199], v[164:167], v[96:111]
    v_exp_f32 v90, v90
    v_exp_f32 v91, v91
    v_cvt_pk_bf16_f32 v172, v88, v89
    v_exp_f32 v92, v92
    v_exp_f32 v93, v93
    v_cvt_pk_bf16_f32 v173, v90, v91
    v_exp_f32 v94, v94
    v_exp_f32 v95, v95
    v_cvt_pk_bf16_f32 v174, v92, v93
    v_cvt_pk_bf16_f32 v175, v94, v95
    v_mfma_f32_32x32x16_bf16 v[80:95], v[188:191], v[180:183], v[144:159]
    ds_read_b128 v[200:203], v2 offset:4096
    v_exp_f32 v64, v64
    v_exp_f32 v65, v65
    v_exp_f32 v66, v66
    v_exp_f32 v67, v67
    v_cvt_pk_bf16_f32 v160, v64, v65
    v_exp_f32 v68, v68
    v_mfma_f32_32x32x16_bf16 v[112:127], v[192:195], v[168:171], v[112:127]
    ds_read_b128 v[204:207], v2 offset:5120
    v_exp_f32 v69, v69
    v_cvt_pk_bf16_f32 v161, v66, v67
    v_exp_f32 v70, v70
    v_exp_f32 v71, v71
    v_cvt_pk_bf16_f32 v162, v68, v69
    v_exp_f32 v72, v72
    v_exp_f32 v73, v73
    v_cvt_pk_bf16_f32 v163, v70, v71
    v_mfma_f32_32x32x16_bf16 v[112:127], v[196:199], v[172:175], v[112:127]
    s_waitcnt lgkmcnt(1)
    v_exp_f32 v74, v74
    v_exp_f32 v75, v75
    v_cvt_pk_bf16_f32 v164, v72, v73
    v_exp_f32 v76, v76
    v_exp_f32 v77, v77
    v_cvt_pk_bf16_f32 v165, v74, v75
    v_exp_f32 v78, v78
    v_exp_f32 v79, v79
    v_cvt_pk_bf16_f32 v166, v76, v77
    v_cvt_pk_bf16_f32 v167, v78, v79
    v_mfma_f32_32x32x16_bf16 v[64:79], v[184:187], v[176:179], v[128:143]
    ds_read_b128 v[188:191], v2 offset:9216
    v_exp_f32 v80, v80
    v_exp_f32 v81, v81
    v_exp_f32 v82, v82
    v_exp_f32 v83, v83
    v_cvt_pk_bf16_f32 v168, v80, v81
    v_exp_f32 v84, v84
    v_mfma_f32_32x32x16_bf16 v[96:111], v[200:203], v[160:163], v[96:111]
    s_waitcnt lgkmcnt(1)
    v_exp_f32 v85, v85
    v_cvt_pk_bf16_f32 v169, v82, v83
    v_exp_f32 v86, v86
    v_exp_f32 v87, v87
    v_cvt_pk_bf16_f32 v170, v84, v85
    v_exp_f32 v88, v88
    v_exp_f32 v89, v89
    v_cvt_pk_bf16_f32 v171, v86, v87
    v_mfma_f32_32x32x16_bf16 v[96:111], v[204:207], v[164:167], v[96:111]
    v_exp_f32 v90, v90
    v_exp_f32 v91, v91
    v_cvt_pk_bf16_f32 v172, v88, v89
    v_exp_f32 v92, v92
    v_exp_f32 v93, v93
    v_cvt_pk_bf16_f32 v173, v90, v91
    v_exp_f32 v94, v94
    v_exp_f32 v95, v95
    v_cvt_pk_bf16_f32 v174, v92, v93
    v_cvt_pk_bf16_f32 v175, v94, v95
    v_mfma_f32_32x32x16_bf16 v[80:95], v[184:187], v[180:183], v[144:159]
    ds_read_b128 v[192:195], v2 offset:7168
    v_exp_f32 v64, v64
    v_exp_f32 v65, v65
    v_exp_f32 v66, v66
    v_exp_f32 v67, v67
    v_cvt_pk_bf16_f32 v160, v64, v65
    v_exp_f32 v68, v68
    v_mfma_f32_32x32x16_bf16 v[112:127], v[200:203], v[168:171], v[112:127]
    ds_read_b128 v[196:199], v2 offset:8192
    v_exp_f32 v69, v69
    v_cvt_pk_bf16_f32 v161, v66, v67
    v_exp_f32 v70, v70
    v_exp_f32 v71, v71
    v_cvt_pk_bf16_f32 v162, v68, v69
    v_exp_f32 v72, v72
    v_exp_f32 v73, v73
    v_cvt_pk_bf16_f32 v163, v70, v71
    v_mfma_f32_32x32x16_bf16 v[112:127], v[204:207], v[172:175], v[112:127]
    s_waitcnt vmcnt(3) lgkmcnt(1)
    s_barrier
    v_exp_f32 v74, v74
    v_exp_f32 v75, v75
    v_cvt_pk_bf16_f32 v164, v72, v73
    v_exp_f32 v76, v76
    v_exp_f32 v77, v77
    v_cvt_pk_bf16_f32 v165, v74, v75
    v_exp_f32 v78, v78
    v_exp_f32 v79, v79
    v_cvt_pk_bf16_f32 v166, v76, v77
    v_cvt_pk_bf16_f32 v167, v78, v79
    v_mfma_f32_32x32x16_bf16 v[64:79], v[188:191], v[176:179], v[128:143]
    ds_read_b128 v[184:187], v2 offset:12288
    v_exp_f32 v80, v80
    v_exp_f32 v81, v81
    v_exp_f32 v82, v82
    v_exp_f32 v83, v83
    v_cvt_pk_bf16_f32 v168, v80, v81
    v_exp_f32 v84, v84
    v_mfma_f32_32x32x16_bf16 v[96:111], v[192:195], v[160:163], v[96:111]
    s_waitcnt lgkmcnt(1)
    s_add_u32 m0, s32, 36864
    s_nop 0
    buffer_load_dwordx4 v14, s[20:23], s30 offen sc1 lds
    v_exp_f32 v85, v85
    v_cvt_pk_bf16_f32 v169, v82, v83
    v_exp_f32 v86, v86
    v_exp_f32 v87, v87
    v_cvt_pk_bf16_f32 v170, v84, v85
    v_exp_f32 v88, v88
    v_exp_f32 v89, v89
    v_cvt_pk_bf16_f32 v171, v86, v87
    v_mfma_f32_32x32x16_bf16 v[96:111], v[196:199], v[164:167], v[96:111]
    s_mov_b64 exec, s[28:29]
    buffer_load_dwordx4 v15, s[20:23], s30 offen offset:1024 sc1 lds
    buffer_load_dwordx4 v16, s[20:23], s30 offen offset:2048 sc1 lds
    s_mov_b64 exec, -1
    s_add_u32 s30, s30, 4096
    v_exp_f32 v90, v90
    v_exp_f32 v91, v91
    v_cvt_pk_bf16_f32 v172, v88, v89
    v_exp_f32 v92, v92
    v_exp_f32 v93, v93
    v_cvt_pk_bf16_f32 v173, v90, v91
    v_exp_f32 v94, v94
    v_exp_f32 v95, v95
    v_cvt_pk_bf16_f32 v174, v92, v93
    v_cvt_pk_bf16_f32 v175, v94, v95
    v_mfma_f32_32x32x16_bf16 v[80:95], v[188:191], v[180:183], v[144:159]
    ds_read_b128 v[200:203], v2 offset:10240
    v_exp_f32 v64, v64
    v_exp_f32 v65, v65
    v_exp_f32 v66, v66
    v_exp_f32 v67, v67
    v_cvt_pk_bf16_f32 v160, v64, v65
    v_exp_f32 v68, v68
    v_mfma_f32_32x32x16_bf16 v[112:127], v[192:195], v[168:171], v[112:127]
    ds_read_b128 v[204:207], v2 offset:11264
    v_exp_f32 v69, v69
    v_cvt_pk_bf16_f32 v161, v66, v67
    v_exp_f32 v70, v70
    v_exp_f32 v71, v71
    v_cvt_pk_bf16_f32 v162, v68, v69
    v_exp_f32 v72, v72
    v_exp_f32 v73, v73
    v_cvt_pk_bf16_f32 v163, v70, v71
    v_mfma_f32_32x32x16_bf16 v[112:127], v[196:199], v[172:175], v[112:127]
    s_waitcnt lgkmcnt(1)
    v_exp_f32 v74, v74
    v_exp_f32 v75, v75
    v_cvt_pk_bf16_f32 v164, v72, v73
    v_exp_f32 v76, v76
    v_exp_f32 v77, v77
    v_cvt_pk_bf16_f32 v165, v74, v75
    v_exp_f32 v78, v78
    v_exp_f32 v79, v79
    v_cvt_pk_bf16_f32 v166, v76, v77
    v_cvt_pk_bf16_f32 v167, v78, v79
    v_mfma_f32_32x32x16_bf16 v[64:79], v[184:187], v[176:179], v[128:143]
    ds_read_b128 v[188:191], v2 offset:15360
    v_exp_f32 v80, v80
    v_exp_f32 v81, v81
    v_exp_f32 v82, v82
    v_exp_f32 v83, v83
    v_cvt_pk_bf16_f32 v168, v80, v81
    v_exp_f32 v84, v84
    v_mfma_f32_32x32x16_bf16 v[96:111], v[200:203], v[160:163], v[96:111]
    s_waitcnt lgkmcnt(1)
    v_exp_f32 v85, v85
    v_cvt_pk_bf16_f32 v169, v82, v83
    v_exp_f32 v86, v86
    v_exp_f32 v87, v87
    v_cvt_pk_bf16_f32 v170, v84, v85
    v_exp_f32 v88, v88
    v_exp_f32 v89, v89
    v_cvt_pk_bf16_f32 v171, v86, v87
    v_mfma_f32_32x32x16_bf16 v[96:111], v[204:207], v[164:167], v[96:111]
    v_exp_f32 v90, v90
    v_exp_f32 v91, v91
    v_cvt_pk_bf16_f32 v172, v88, v89
    v_exp_f32 v92, v92
    v_exp_f32 v93, v93
    v_cvt_pk_bf16_f32 v173, v90, v91
    v_exp_f32 v94, v94
    v_exp_f32 v95, v95
    v_cvt_pk_bf16_f32 v174, v92, v93
    v_cvt_pk_bf16_f32 v175, v94, v95
    v_mfma_f32_32x32x16_bf16 v[80:95], v[184:187], v[180:183], v[144:159]
    ds_read_b128 v[192:195], v2 offset:13312
    v_exp_f32 v64, v64
    v_exp_f32 v65, v65
    v_exp_f32 v66, v66
    v_exp_f32 v67, v67
    v_cvt_pk_bf16_f32 v160, v64, v65
    v_exp_f32 v68, v68
    v_mfma_f32_32x32x16_bf16 v[112:127], v[200:203], v[168:171], v[112:127]
    ds_read_b128 v[196:199], v2 offset:14336
    v_exp_f32 v69, v69
    v_cvt_pk_bf16_f32 v161, v66, v67
    v_exp_f32 v70, v70
    v_exp_f32 v71, v71
    v_cvt_pk_bf16_f32 v162, v68, v69
    v_exp_f32 v72, v72
    v_exp_f32 v73, v73
    v_cvt_pk_bf16_f32 v163, v70, v71
    v_mfma_f32_32x32x16_bf16 v[112:127], v[204:207], v[172:175], v[112:127]
    s_waitcnt lgkmcnt(1)
    v_exp_f32 v74, v74
    v_exp_f32 v75, v75
    v_cvt_pk_bf16_f32 v164, v72, v73
    v_exp_f32 v76, v76
    v_exp_f32 v77, v77
    v_cvt_pk_bf16_f32 v165, v74, v75
    v_exp_f32 v78, v78
    v_exp_f32 v79, v79
    v_cvt_pk_bf16_f32 v166, v76, v77
    v_cvt_pk_bf16_f32 v167, v78, v79
    v_mfma_f32_32x32x16_bf16 v[64:79], v[188:191], v[176:179], v[128:143]
    ds_read_b128 v[184:187], v2 offset:18432
    v_exp_f32 v80, v80
    v_exp_f32 v81, v81
    v_exp_f32 v82, v82
    v_exp_f32 v83, v83
    v_cvt_pk_bf16_f32 v168, v80, v81
    v_exp_f32 v84, v84
    v_mfma_f32_32x32x16_bf16 v[96:111], v[192:195], v[160:163], v[96:111]
    s_waitcnt lgkmcnt(1)
    v_exp_f32 v85, v85
    v_cvt_pk_bf16_f32 v169, v82, v83
    v_exp_f32 v86, v86
    v_exp_f32 v87, v87
    v_cvt_pk_bf16_f32 v170, v84, v85
    v_exp_f32 v88, v88
    v_exp_f32 v89, v89
    v_cvt_pk_bf16_f32 v171, v86, v87
    v_mfma_f32_32x32x16_bf16 v[96:111], v[196:199], v[164:167], v[96:111]
    v_exp_f32 v90, v90
    v_exp_f32 v91, v91
    v_cvt_pk_bf16_f32 v172, v88, v89
    v_exp_f32 v92, v92
    v_exp_f32 v93, v93
    v_cvt_pk_bf16_f32 v173, v90, v91
    v_exp_f32 v94, v94
    v_exp_f32 v95, v95
    v_cvt_pk_bf16_f32 v174, v92, v93
    v_cvt_pk_bf16_f32 v175, v94, v95
    v_mfma_f32_32x32x16_bf16 v[80:95], v[188:191], v[180:183], v[144:159]
    ds_read_b128 v[200:203], v2 offset:16384
    v_exp_f32 v64, v64
    v_exp_f32 v65, v65
    v_exp_f32 v66, v66
    v_exp_f32 v67, v67
    v_cvt_pk_bf16_f32 v160, v64, v65
    v_exp_f32 v68, v68
    v_mfma_f32_32x32x16_bf16 v[112:127], v[192:195], v[168:171], v[112:127]
    ds_read_b128 v[204:207], v2 offset:17408
    v_exp_f32 v69, v69
    v_cvt_pk_bf16_f32 v161, v66, v67
    v_exp_f32 v70, v70
    v_exp_f32 v71, v71
    v_cvt_pk_bf16_f32 v162, v68, v69
    v_exp_f32 v72, v72
    v_exp_f32 v73, v73
    v_cvt_pk_bf16_f32 v163, v70, v71
    v_mfma_f32_32x32x16_bf16 v[112:127], v[196:199], v[172:175], v[112:127]
    s_waitcnt lgkmcnt(1)
    v_exp_f32 v74, v74
    v_exp_f32 v75, v75
    v_cvt_pk_bf16_f32 v164, v72, v73
    v_exp_f32 v76, v76
    v_exp_f32 v77, v77
    v_cvt_pk_bf16_f32 v165, v74, v75
    v_exp_f32 v78, v78
    v_exp_f32 v79, v79
    v_cvt_pk_bf16_f32 v166, v76, v77
    v_cvt_pk_bf16_f32 v167, v78, v79
    v_mfma_f32_32x32x16_bf16 v[64:79], v[184:187], v[176:179], v[128:143]
    ds_read_b128 v[188:191], v2 offset:21504
    v_exp_f32 v80, v80
    v_exp_f32 v81, v81
    v_exp_f32 v82, v82
    v_exp_f32 v83, v83
    v_cvt_pk_bf16_f32 v168, v80, v81
    v_exp_f32 v84, v84
    v_mfma_f32_32x32x16_bf16 v[96:111], v[200:203], v[160:163], v[96:111]
    s_waitcnt lgkmcnt(1)
    v_exp_f32 v85, v85
    v_cvt_pk_bf16_f32 v169, v82, v83
    v_exp_f32 v86, v86
    v_exp_f32 v87, v87
    v_cvt_pk_bf16_f32 v170, v84, v85
    v_exp_f32 v88, v88
    v_exp_f32 v89, v89
    v_cvt_pk_bf16_f32 v171, v86, v87
    v_mfma_f32_32x32x16_bf16 v[96:111], v[204:207], v[164:167], v[96:111]
    v_exp_f32 v90, v90
    v_exp_f32 v91, v91
    v_cvt_pk_bf16_f32 v172, v88, v89
    v_exp_f32 v92, v92
    v_exp_f32 v93, v93
    v_cvt_pk_bf16_f32 v173, v90, v91
    v_exp_f32 v94, v94
    v_exp_f32 v95, v95
    v_cvt_pk_bf16_f32 v174, v92, v93
    v_cvt_pk_bf16_f32 v175, v94, v95
    v_mfma_f32_32x32x16_bf16 v[80:95], v[184:187], v[180:183], v[144:159]
    ds_read_b128 v[192:195], v2 offset:19456
    v_exp_f32 v64, v64
    v_exp_f32 v65, v65
    v_exp_f32 v66, v66
    v_exp_f32 v67, v67
    v_cvt_pk_bf16_f32 v160, v64, v65
    v_exp_f32 v68, v68
    v_mfma_f32_32x32x16_bf16 v[112:127], v[200:203], v[168:171], v[112:127]
    ds_read_b128 v[196:199], v2 offset:20480
    v_exp_f32 v69, v69
    v_cvt_pk_bf16_f32 v161, v66, v67
    v_exp_f32 v70, v70
    v_exp_f32 v71, v71
    v_cvt_pk_bf16_f32 v162, v68, v69
    v_exp_f32 v72, v72
    v_exp_f32 v73, v73
    v_cvt_pk_bf16_f32 v163, v70, v71
    v_mfma_f32_32x32x16_bf16 v[112:127], v[204:207], v[172:175], v[112:127]
    s_waitcnt vmcnt(3) lgkmcnt(1)
    s_barrier
    v_exp_f32 v74, v74
    v_exp_f32 v75, v75
    v_cvt_pk_bf16_f32 v164, v72, v73
    v_exp_f32 v76, v76
    v_exp_f32 v77, v77
    v_cvt_pk_bf16_f32 v165, v74, v75
    v_exp_f32 v78, v78
    v_exp_f32 v79, v79
    v_cvt_pk_bf16_f32 v166, v76, v77
    v_cvt_pk_bf16_f32 v167, v78, v79
    v_mfma_f32_32x32x16_bf16 v[64:79], v[188:191], v[176:179], v[128:143]
    ds_read_b128 v[184:187], v2 offset:24576
    v_exp_f32 v80, v80
    v_exp_f32 v81, v81
    v_exp_f32 v82, v82
    v_exp_f32 v83, v83
    v_cvt_pk_bf16_f32 v168, v80, v81
    v_exp_f32 v84, v84
    v_mfma_f32_32x32x16_bf16 v[96:111], v[192:195], v[160:163], v[96:111]
    s_waitcnt lgkmcnt(1)
    v_exp_f32 v85, v85
    v_cvt_pk_bf16_f32 v169, v82, v83
    v_exp_f32 v86, v86
    v_exp_f32 v87, v87
    v_cvt_pk_bf16_f32 v170, v84, v85
    v_exp_f32 v88, v88
    v_exp_f32 v89, v89
    v_cvt_pk_bf16_f32 v171, v86, v87
    v_mfma_f32_32x32x16_bf16 v[96:111], v[196:199], v[164:167], v[96:111]
    v_exp_f32 v90, v90
    v_exp_f32 v91, v91
    v_cvt_pk_bf16_f32 v172, v88, v89
    v_exp_f32 v92, v92
    v_exp_f32 v93, v93
    v_cvt_pk_bf16_f32 v173, v90, v91
    v_exp_f32 v94, v94
    v_exp_f32 v95, v95
    v_cvt_pk_bf16_f32 v174, v92, v93
    v_cvt_pk_bf16_f32 v175, v94, v95
    v_mfma_f32_32x32x16_bf16 v[80:95], v[188:191], v[180:183], v[144:159]
    ds_read_b128 v[200:203], v2 offset:22528
    v_exp_f32 v64, v64
    v_exp_f32 v65, v65
    v_exp_f32 v66, v66
    v_exp_f32 v67, v67
    v_cvt_pk_bf16_f32 v160, v64, v65
    v_exp_f32 v68, v68
    v_mfma_f32_32x32x16_bf16 v[112:127], v[192:195], v[168:171], v[112:127]
    ds_read_b128 v[204:207], v2 offset:23552
    v_exp_f32 v69, v69
    v_cvt_pk_bf16_f32 v161, v66, v67
    v_exp_f32 v70, v70
    v_exp_f32 v71, v71
    v_cvt_pk_bf16_f32 v162, v68, v69
    v_exp_f32 v72, v72
    v_exp_f32 v73, v73
    v_cvt_pk_bf16_f32 v163, v70, v71
    v_mfma_f32_32x32x16_bf16 v[112:127], v[196:199], v[172:175], v[112:127]
    s_waitcnt lgkmcnt(1)
    v_exp_f32 v74, v74
    v_exp_f32 v75, v75
    v_cvt_pk_bf16_f32 v164, v72, v73
    v_exp_f32 v76, v76
    v_exp_f32 v77, v77
    v_cvt_pk_bf16_f32 v165, v74, v75
    v_exp_f32 v78, v78
    v_exp_f32 v79, v79
    v_cvt_pk_bf16_f32 v166, v76, v77
    v_cvt_pk_bf16_f32 v167, v78, v79
    v_mfma_f32_32x32x16_bf16 v[64:79], v[184:187], v[176:179], v[128:143]
    ds_read_b128 v[188:191], v2 offset:27648
    v_exp_f32 v80, v80
    v_exp_f32 v81, v81
    v_exp_f32 v82, v82
    v_exp_f32 v83, v83
    v_cvt_pk_bf16_f32 v168, v80, v81
    v_exp_f32 v84, v84
    v_mfma_f32_32x32x16_bf16 v[96:111], v[200:203], v[160:163], v[96:111]
    s_waitcnt lgkmcnt(1)
    v_exp_f32 v85, v85
    v_cvt_pk_bf16_f32 v169, v82, v83
    v_exp_f32 v86, v86
    v_exp_f32 v87, v87
    v_cvt_pk_bf16_f32 v170, v84, v85
    v_exp_f32 v88, v88
    v_exp_f32 v89, v89
    v_cvt_pk_bf16_f32 v171, v86, v87
    v_mfma_f32_32x32x16_bf16 v[96:111], v[204:207], v[164:167], v[96:111]
    v_exp_f32 v90, v90
    v_exp_f32 v91, v91
    v_cvt_pk_bf16_f32 v172, v88, v89
    v_exp_f32 v92, v92
    v_exp_f32 v93, v93
    v_cvt_pk_bf16_f32 v173, v90, v91
    v_exp_f32 v94, v94
    v_exp_f32 v95, v95
    v_cvt_pk_bf16_f32 v174, v92, v93
    v_cvt_pk_bf16_f32 v175, v94, v95
    v_mfma_f32_32x32x16_bf16 v[80:95], v[184:187], v[180:183], v[144:159]
    ds_read_b128 v[192:195], v2 offset:25600
    v_exp_f32 v64, v64
    v_exp_f32 v65, v65
    v_exp_f32 v66, v66
    v_exp_f32 v67, v67
    v_cvt_pk_bf16_f32 v160, v64, v65
    v_exp_f32 v68, v68
    v_mfma_f32_32x32x16_bf16 v[112:127], v[200:203], v[168:171], v[112:127]
    ds_read_b128 v[196:199], v2 offset:26624
    v_exp_f32 v69, v69
    v_cvt_pk_bf16_f32 v161, v66, v67
    v_exp_f32 v70, v70
    v_exp_f32 v71, v71
    v_cvt_pk_bf16_f32 v162, v68, v69
    v_exp_f32 v72, v72
    v_exp_f32 v73, v73
    v_cvt_pk_bf16_f32 v163, v70, v71
    v_mfma_f32_32x32x16_bf16 v[112:127], v[204:207], v[172:175], v[112:127]
    s_waitcnt lgkmcnt(1)
    v_exp_f32 v74, v74
    v_exp_f32 v75, v75
    v_cvt_pk_bf16_f32 v164, v72, v73
    v_exp_f32 v76, v76
    v_exp_f32 v77, v77
    v_cvt_pk_bf16_f32 v165, v74, v75
    v_exp_f32 v78, v78
    v_exp_f32 v79, v79
    v_cvt_pk_bf16_f32 v166, v76, v77
    v_cvt_pk_bf16_f32 v167, v78, v79
    v_mfma_f32_32x32x16_bf16 v[64:79], v[188:191], v[176:179], v[128:143]
    ds_read_b128 v[184:187], v2 offset:30720
    v_exp_f32 v80, v80
    v_exp_f32 v81, v81
    v_exp_f32 v82, v82
    v_exp_f32 v83, v83
    v_cvt_pk_bf16_f32 v168, v80, v81
    v_exp_f32 v84, v84
    v_mfma_f32_32x32x16_bf16 v[96:111], v[192:195], v[160:163], v[96:111]
    s_waitcnt lgkmcnt(1)
    v_exp_f32 v85, v85
    v_cvt_pk_bf16_f32 v169, v82, v83
    v_exp_f32 v86, v86
    v_exp_f32 v87, v87
    v_cvt_pk_bf16_f32 v170, v84, v85
    v_exp_f32 v88, v88
    v_exp_f32 v89, v89
    v_cvt_pk_bf16_f32 v171, v86, v87
    v_mfma_f32_32x32x16_bf16 v[96:111], v[196:199], v[164:167], v[96:111]
    v_exp_f32 v90, v90
    v_exp_f32 v91, v91
    v_cvt_pk_bf16_f32 v172, v88, v89
    v_exp_f32 v92, v92
    v_exp_f32 v93, v93
    v_cvt_pk_bf16_f32 v173, v90, v91
    v_exp_f32 v94, v94
    v_exp_f32 v95, v95
    v_cvt_pk_bf16_f32 v174, v92, v93
    v_cvt_pk_bf16_f32 v175, v94, v95
    v_mfma_f32_32x32x16_bf16 v[80:95], v[188:191], v[180:183], v[144:159]
    ds_read_b128 v[200:203], v2 offset:28672
    v_exp_f32 v64, v64
    v_exp_f32 v65, v65
    v_exp_f32 v66, v66
    v_exp_f32 v67, v67
    v_cvt_pk_bf16_f32 v160, v64, v65
    v_exp_f32 v68, v68
    v_mfma_f32_32x32x16_bf16 v[112:127], v[192:195], v[168:171], v[112:127]
    ds_read_b128 v[204:207], v2 offset:29696
    v_exp_f32 v69, v69
    v_cvt_pk_bf16_f32 v161, v66, v67
    v_exp_f32 v70, v70
    v_exp_f32 v71, v71
    v_cvt_pk_bf16_f32 v162, v68, v69
    v_exp_f32 v72, v72
    v_exp_f32 v73, v73
    v_cvt_pk_bf16_f32 v163, v70, v71
    v_mfma_f32_32x32x16_bf16 v[112:127], v[196:199], v[172:175], v[112:127]
    s_waitcnt lgkmcnt(1)
    v_exp_f32 v74, v74
    v_exp_f32 v75, v75
    v_cvt_pk_bf16_f32 v164, v72, v73
    v_exp_f32 v76, v76
    v_exp_f32 v77, v77
    v_cvt_pk_bf16_f32 v165, v74, v75
    v_exp_f32 v78, v78
    v_exp_f32 v79, v79
    v_cvt_pk_bf16_f32 v166, v76, v77
    v_cvt_pk_bf16_f32 v167, v78, v79
    v_mfma_f32_32x32x16_bf16 v[64:79], v[184:187], v[176:179], v[128:143]
    ds_read_b128 v[188:191], v2 offset:33792
    v_exp_f32 v80, v80
    v_exp_f32 v81, v81
    v_exp_f32 v82, v82
    v_exp_f32 v83, v83
    v_cvt_pk_bf16_f32 v168, v80, v81
    v_exp_f32 v84, v84
    v_mfma_f32_32x32x16_bf16 v[96:111], v[200:203], v[160:163], v[96:111]
    s_waitcnt lgkmcnt(1)
    v_exp_f32 v85, v85
    v_cvt_pk_bf16_f32 v169, v82, v83
    v_exp_f32 v86, v86
    v_exp_f32 v87, v87
    v_cvt_pk_bf16_f32 v170, v84, v85
    v_exp_f32 v88, v88
    v_exp_f32 v89, v89
    v_cvt_pk_bf16_f32 v171, v86, v87
    v_mfma_f32_32x32x16_bf16 v[96:111], v[204:207], v[164:167], v[96:111]
    v_exp_f32 v90, v90
    v_exp_f32 v91, v91
    v_cvt_pk_bf16_f32 v172, v88, v89
    v_exp_f32 v92, v92
    v_exp_f32 v93, v93
    v_cvt_pk_bf16_f32 v173, v90, v91
    v_exp_f32 v94, v94
    v_exp_f32 v95, v95
    v_cvt_pk_bf16_f32 v174, v92, v93
    v_cvt_pk_bf16_f32 v175, v94, v95
    v_mfma_f32_32x32x16_bf16 v[80:95], v[184:187], v[180:183], v[144:159]
    ds_read_b128 v[192:195], v2 offset:31744
    v_exp_f32 v64, v64
    v_exp_f32 v65, v65
    v_exp_f32 v66, v66
    v_exp_f32 v67, v67
    v_cvt_pk_bf16_f32 v160, v64, v65
    v_exp_f32 v68, v68
    v_mfma_f32_32x32x16_bf16 v[112:127], v[200:203], v[168:171], v[112:127]
    ds_read_b128 v[196:199], v2 offset:32768
    v_exp_f32 v69, v69
    v_cvt_pk_bf16_f32 v161, v66, v67
    v_exp_f32 v70, v70
    v_exp_f32 v71, v71
    v_cvt_pk_bf16_f32 v162, v68, v69
    v_exp_f32 v72, v72
    v_exp_f32 v73, v73
    v_cvt_pk_bf16_f32 v163, v70, v71
    v_mfma_f32_32x32x16_bf16 v[112:127], v[204:207], v[172:175], v[112:127]
    s_waitcnt vmcnt(0) lgkmcnt(1)
    s_barrier
    v_exp_f32 v74, v74
    v_exp_f32 v75, v75
    v_cvt_pk_bf16_f32 v164, v72, v73
    v_exp_f32 v76, v76
    v_exp_f32 v77, v77
    v_cvt_pk_bf16_f32 v165, v74, v75
    v_exp_f32 v78, v78
    v_exp_f32 v79, v79
    v_cvt_pk_bf16_f32 v166, v76, v77
    v_cvt_pk_bf16_f32 v167, v78, v79
    v_mfma_f32_32x32x16_bf16 v[64:79], v[188:191], v[176:179], v[128:143]
    ds_read_b128 v[184:187], v2 offset:36864
    v_exp_f32 v80, v80
    v_exp_f32 v81, v81
    v_exp_f32 v82, v82
    v_exp_f32 v83, v83
    v_cvt_pk_bf16_f32 v168, v80, v81
    v_exp_f32 v84, v84
    v_mfma_f32_32x32x16_bf16 v[96:111], v[192:195], v[160:163], v[96:111]
    s_waitcnt lgkmcnt(1)
    v_exp_f32 v85, v85
    v_cvt_pk_bf16_f32 v169, v82, v83
    v_exp_f32 v86, v86
    v_exp_f32 v87, v87
    v_cvt_pk_bf16_f32 v170, v84, v85
    v_exp_f32 v88, v88
    v_exp_f32 v89, v89
    v_cvt_pk_bf16_f32 v171, v86, v87
    v_mfma_f32_32x32x16_bf16 v[96:111], v[196:199], v[164:167], v[96:111]
    v_exp_f32 v90, v90
    v_exp_f32 v91, v91
    v_cvt_pk_bf16_f32 v172, v88, v89
    v_exp_f32 v92, v92
    v_exp_f32 v93, v93
    v_cvt_pk_bf16_f32 v173, v90, v91
    v_exp_f32 v94, v94
    v_exp_f32 v95, v95
    v_cvt_pk_bf16_f32 v174, v92, v93
    v_cvt_pk_bf16_f32 v175, v94, v95
    v_mfma_f32_32x32x16_bf16 v[80:95], v[188:191], v[180:183], v[144:159]
    ds_read_b128 v[200:203], v2 offset:34816
    v_exp_f32 v64, v64
    v_exp_f32 v65, v65
    v_exp_f32 v66, v66
    v_exp_f32 v67, v67
    v_cvt_pk_bf16_f32 v160, v64, v65
    v_exp_f32 v68, v68
    v_mfma_f32_32x32x16_bf16 v[112:127], v[192:195], v[168:171], v[112:127]
    ds_read_b128 v[204:207], v2 offset:35840
    v_exp_f32 v69, v69
    v_cvt_pk_bf16_f32 v161, v66, v67
    v_exp_f32 v70, v70
    v_exp_f32 v71, v71
    v_cvt_pk_bf16_f32 v162, v68, v69
    v_exp_f32 v72, v72
    v_exp_f32 v73, v73
    v_cvt_pk_bf16_f32 v163, v70, v71
    v_mfma_f32_32x32x16_bf16 v[112:127], v[196:199], v[172:175], v[112:127]
    s_waitcnt lgkmcnt(1)
    v_exp_f32 v74, v74
    v_exp_f32 v75, v75
    v_cvt_pk_bf16_f32 v164, v72, v73
    v_exp_f32 v76, v76
    v_exp_f32 v77, v77
    v_cvt_pk_bf16_f32 v165, v74, v75
    v_exp_f32 v78, v78
    v_exp_f32 v79, v79
    v_cvt_pk_bf16_f32 v166, v76, v77
    v_cvt_pk_bf16_f32 v167, v78, v79
    v_mfma_f32_32x32x16_bf16 v[64:79], v[184:187], v[176:179], v[128:143]
    ds_read_b128 v[188:191], v2 offset:39936
    v_exp_f32 v80, v80
    v_exp_f32 v81, v81
    v_exp_f32 v82, v82
    v_exp_f32 v83, v83
    v_cvt_pk_bf16_f32 v168, v80, v81
    v_exp_f32 v84, v84
    v_mfma_f32_32x32x16_bf16 v[96:111], v[200:203], v[160:163], v[96:111]
    s_waitcnt lgkmcnt(1)
    v_exp_f32 v85, v85
    v_cvt_pk_bf16_f32 v169, v82, v83
    v_exp_f32 v86, v86
    v_exp_f32 v87, v87
    v_cvt_pk_bf16_f32 v170, v84, v85
    v_exp_f32 v88, v88
    v_exp_f32 v89, v89
    v_cvt_pk_bf16_f32 v171, v86, v87
    v_mfma_f32_32x32x16_bf16 v[96:111], v[204:207], v[164:167], v[96:111]
    v_exp_f32 v90, v90
    v_exp_f32 v91, v91
    v_cvt_pk_bf16_f32 v172, v88, v89
    v_exp_f32 v92, v92
    v_exp_f32 v93, v93
    v_cvt_pk_bf16_f32 v173, v90, v91
    v_exp_f32 v94, v94
    v_exp_f32 v95, v95
    v_cvt_pk_bf16_f32 v174, v92, v93
    v_cvt_pk_bf16_f32 v175, v94, v95
    v_mfma_f32_32x32x16_bf16 v[80:95], v[184:187], v[180:183], v[144:159]
    ds_read_b128 v[192:195], v2 offset:37888
    v_exp_f32 v64, v64
    v_exp_f32 v65, v65
    v_exp_f32 v66, v66
    v_exp_f32 v67, v67
    v_cvt_pk_bf16_f32 v160, v64, v65
    v_exp_f32 v68, v68
    v_mfma_f32_32x32x16_bf16 v[112:127], v[200:203], v[168:171], v[112:127]
    ds_read_b128 v[196:199], v2 offset:38912
    v_exp_f32 v69, v69
    v_cvt_pk_bf16_f32 v161, v66, v67
    v_exp_f32 v70, v70
    v_exp_f32 v71, v71
    v_cvt_pk_bf16_f32 v162, v68, v69
    v_exp_f32 v72, v72
    v_exp_f32 v73, v73
    v_cvt_pk_bf16_f32 v163, v70, v71
    v_mfma_f32_32x32x16_bf16 v[112:127], v[204:207], v[172:175], v[112:127]
    s_waitcnt lgkmcnt(1)
    v_exp_f32 v74, v74
    v_exp_f32 v75, v75
    v_cvt_pk_bf16_f32 v164, v72, v73
    v_exp_f32 v76, v76
    v_exp_f32 v77, v77
    v_cvt_pk_bf16_f32 v165, v74, v75
    v_exp_f32 v78, v78
    v_exp_f32 v79, v79
    v_cvt_pk_bf16_f32 v166, v76, v77
    v_cvt_pk_bf16_f32 v167, v78, v79
    v_mfma_f32_32x32x16_bf16 v[64:79], v[188:191], v[176:179], v[128:143]
    ds_read_b128 v[184:187], v2 offset:43008
    v_exp_f32 v80, v80
    v_exp_f32 v81, v81
    v_exp_f32 v82, v82
    v_exp_f32 v83, v83
    v_cvt_pk_bf16_f32 v168, v80, v81
    v_exp_f32 v84, v84
    v_mfma_f32_32x32x16_bf16 v[96:111], v[192:195], v[160:163], v[96:111]
    s_waitcnt lgkmcnt(1)
    v_exp_f32 v85, v85
    v_cvt_pk_bf16_f32 v169, v82, v83
    v_exp_f32 v86, v86
    v_exp_f32 v87, v87
    v_cvt_pk_bf16_f32 v170, v84, v85
    v_exp_f32 v88, v88
    v_exp_f32 v89, v89
    v_cvt_pk_bf16_f32 v171, v86, v87
    v_mfma_f32_32x32x16_bf16 v[96:111], v[196:199], v[164:167], v[96:111]
    v_exp_f32 v90, v90
    v_exp_f32 v91, v91
    v_cvt_pk_bf16_f32 v172, v88, v89
    v_exp_f32 v92, v92
    v_exp_f32 v93, v93
    v_cvt_pk_bf16_f32 v173, v90, v91
    v_exp_f32 v94, v94
    v_exp_f32 v95, v95
    v_cvt_pk_bf16_f32 v174, v92, v93
    v_cvt_pk_bf16_f32 v175, v94, v95
    v_mfma_f32_32x32x16_bf16 v[80:95], v[188:191], v[180:183], v[144:159]
    ds_read_b128 v[200:203], v2 offset:40960
    v_exp_f32 v64, v64
    v_exp_f32 v65, v65
    v_exp_f32 v66, v66
    v_exp_f32 v67, v67
    v_cvt_pk_bf16_f32 v160, v64, v65
    v_exp_f32 v68, v68
    v_mfma_f32_32x32x16_bf16 v[112:127], v[192:195], v[168:171], v[112:127]
    ds_read_b128 v[204:207], v2 offset:41984
    s_mov_b64 exec, 1
    buffer_store_dwordx2 v[26:27], v24, s[20:23], 0 offen sc1
    s_mov_b64 exec, -1
    v_exp_f32 v69, v69
    v_cvt_pk_bf16_f32 v161, v66, v67
    v_exp_f32 v70, v70
    v_exp_f32 v71, v71
    v_cvt_pk_bf16_f32 v162, v68, v69
    v_exp_f32 v72, v72
    v_exp_f32 v73, v73
    v_cvt_pk_bf16_f32 v163, v70, v71
    v_mfma_f32_32x32x16_bf16 v[112:127], v[196:199], v[172:175], v[112:127]
    s_waitcnt lgkmcnt(1)
    v_exp_f32 v74, v74
    v_exp_f32 v75, v75
    v_cvt_pk_bf16_f32 v164, v72, v73
    v_exp_f32 v76, v76
    v_exp_f32 v77, v77
    v_cvt_pk_bf16_f32 v165, v74, v75
    v_exp_f32 v78, v78
    v_exp_f32 v79, v79
    v_cvt_pk_bf16_f32 v166, v76, v77
    v_cvt_pk_bf16_f32 v167, v78, v79
    v_mfma_f32_32x32x16_bf16 v[64:79], v[184:187], v[176:179], v[128:143]
    ds_read_b128 v[188:191], v2 offset:46080
    v_exp_f32 v80, v80
    v_exp_f32 v81, v81
    v_exp_f32 v82, v82
    v_exp_f32 v83, v83
    v_cvt_pk_bf16_f32 v168, v80, v81
    v_exp_f32 v84, v84
    v_mfma_f32_32x32x16_bf16 v[96:111], v[200:203], v[160:163], v[96:111]
    s_waitcnt lgkmcnt(1)
    v_exp_f32 v85, v85
    v_cvt_pk_bf16_f32 v169, v82, v83
    v_exp_f32 v86, v86
    v_exp_f32 v87, v87
    v_cvt_pk_bf16_f32 v170, v84, v85
    v_exp_f32 v88, v88
    v_exp_f32 v89, v89
    v_cvt_pk_bf16_f32 v171, v86, v87
    v_mfma_f32_32x32x16_bf16 v[96:111], v[204:207], v[164:167], v[96:111]
    v_exp_f32 v90, v90
    v_exp_f32 v91, v91
    v_cvt_pk_bf16_f32 v172, v88, v89
    v_exp_f32 v92, v92
    v_exp_f32 v93, v93
    v_cvt_pk_bf16_f32 v173, v90, v91
    v_exp_f32 v94, v94
    v_exp_f32 v95, v95
    v_cvt_pk_bf16_f32 v174, v92, v93
    v_cvt_pk_bf16_f32 v175, v94, v95
    v_mfma_f32_32x32x16_bf16 v[80:95], v[184:187], v[180:183], v[144:159]
    ds_read_b128 v[192:195], v2 offset:44032
    v_exp_f32 v64, v64
    v_exp_f32 v65, v65
    v_exp_f32 v66, v66
    v_exp_f32 v67, v67
    v_cvt_pk_bf16_f32 v160, v64, v65
    v_exp_f32 v68, v68
    v_mfma_f32_32x32x16_bf16 v[112:127], v[200:203], v[168:171], v[112:127]
    ds_read_b128 v[196:199], v2 offset:45056
    v_exp_f32 v69, v69
    v_cvt_pk_bf16_f32 v161, v66, v67
    v_exp_f32 v70, v70
    v_exp_f32 v71, v71
    v_cvt_pk_bf16_f32 v162, v68, v69
    v_exp_f32 v72, v72
    v_exp_f32 v73, v73
    v_cvt_pk_bf16_f32 v163, v70, v71
    v_mfma_f32_32x32x16_bf16 v[112:127], v[204:207], v[172:175], v[112:127]
    s_waitcnt lgkmcnt(1)
    v_exp_f32 v74, v74
    v_exp_f32 v75, v75
    v_cvt_pk_bf16_f32 v164, v72, v73
    v_exp_f32 v76, v76
    v_exp_f32 v77, v77
    v_cvt_pk_bf16_f32 v165, v74, v75
    v_exp_f32 v78, v78
    v_exp_f32 v79, v79
    v_cvt_pk_bf16_f32 v166, v76, v77
    v_cvt_pk_bf16_f32 v167, v78, v79
    v_mfma_f32_32x32x16_bf16 v[64:79], v[188:191], v[176:179], v[128:143]
    s_waitcnt lgkmcnt(0)
    v_exp_f32 v80, v80
    v_exp_f32 v81, v81
    v_exp_f32 v82, v82
    v_exp_f32 v83, v83
    v_cvt_pk_bf16_f32 v168, v80, v81
    v_exp_f32 v84, v84
    v_mfma_f32_32x32x16_bf16 v[96:111], v[192:195], v[160:163], v[96:111]
    v_exp_f32 v85, v85
    v_cvt_pk_bf16_f32 v169, v82, v83
    v_exp_f32 v86, v86
    v_exp_f32 v87, v87
    v_cvt_pk_bf16_f32 v170, v84, v85
    v_exp_f32 v88, v88
    v_exp_f32 v89, v89
    v_cvt_pk_bf16_f32 v171, v86, v87
    v_mfma_f32_32x32x16_bf16 v[96:111], v[196:199], v[164:167], v[96:111]
    v_exp_f32 v90, v90
    v_exp_f32 v91, v91
    v_cvt_pk_bf16_f32 v172, v88, v89
    v_exp_f32 v92, v92
    v_exp_f32 v93, v93
    v_cvt_pk_bf16_f32 v173, v90, v91
    v_exp_f32 v94, v94
    v_exp_f32 v95, v95
    v_cvt_pk_bf16_f32 v174, v92, v93
    v_cvt_pk_bf16_f32 v175, v94, v95
    v_mfma_f32_32x32x16_bf16 v[80:95], v[188:191], v[180:183], v[144:159]
    ds_read_b128 v[200:203], v2 offset:47104
    v_exp_f32 v64, v64
    v_exp_f32 v65, v65
    v_exp_f32 v66, v66
    v_exp_f32 v67, v67
    v_cvt_pk_bf16_f32 v160, v64, v65
    v_exp_f32 v68, v68
    v_mfma_f32_32x32x16_bf16 v[112:127], v[192:195], v[168:171], v[112:127]
    ds_read_b128 v[204:207], v2 offset:48128
    v_exp_f32 v69, v69
    v_cvt_pk_bf16_f32 v161, v66, v67
    v_exp_f32 v70, v70
    v_exp_f32 v71, v71
    v_cvt_pk_bf16_f32 v162, v68, v69
    v_exp_f32 v72, v72
    v_exp_f32 v73, v73
    v_cvt_pk_bf16_f32 v163, v70, v71
    v_mfma_f32_32x32x16_bf16 v[112:127], v[196:199], v[172:175], v[112:127]
    s_waitcnt lgkmcnt(1)
    v_exp_f32 v74, v74
    v_exp_f32 v75, v75
    v_cvt_pk_bf16_f32 v164, v72, v73
    v_exp_f32 v76, v76
    v_exp_f32 v77, v77
    v_cvt_pk_bf16_f32 v165, v74, v75
    v_exp_f32 v78, v78
    v_exp_f32 v79, v79
    v_cvt_pk_bf16_f32 v166, v76, v77
    v_cvt_pk_bf16_f32 v167, v78, v79
    s_waitcnt lgkmcnt(0)
    v_exp_f32 v80, v80
    v_exp_f32 v81, v81
    v_exp_f32 v82, v82
    v_exp_f32 v83, v83
    v_cvt_pk_bf16_f32 v168, v80, v81
    v_exp_f32 v84, v84
    v_mfma_f32_32x32x16_bf16 v[96:111], v[200:203], v[160:163], v[96:111]
    v_exp_f32 v85, v85
    v_cvt_pk_bf16_f32 v169, v82, v83
    v_exp_f32 v86, v86
    v_exp_f32 v87, v87
    v_cvt_pk_bf16_f32 v170, v84, v85
    v_exp_f32 v88, v88
    v_exp_f32 v89, v89
    v_cvt_pk_bf16_f32 v171, v86, v87
    v_mfma_f32_32x32x16_bf16 v[96:111], v[204:207], v[164:167], v[96:111]
    v_exp_f32 v90, v90
    v_exp_f32 v91, v91
    v_cvt_pk_bf16_f32 v172, v88, v89
    v_exp_f32 v92, v92
    v_exp_f32 v93, v93
    v_cvt_pk_bf16_f32 v173, v90, v91
    v_exp_f32 v94, v94
    v_exp_f32 v95, v95
    v_cvt_pk_bf16_f32 v174, v92, v93
    v_cvt_pk_bf16_f32 v175, v94, v95
    s_nop 1
    v_mfma_f32_32x32x16_bf16 v[112:127], v[200:203], v[168:171], v[112:127]
    v_mfma_f32_32x32x16_bf16 v[112:127], v[204:207], v[172:175], v[112:127]
    s_nop 11
    v_add_f32 v10, v96, v104
    v_add_f32 v10, v10, v97
    v_add_f32 v10, v10, v98
    v_add_f32 v10, v10, v99
    v_add_f32 v10, v10, v100
    v_add_f32 v10, v10, v101
    v_add_f32 v10, v10, v102
    v_add_f32 v10, v10, v103
    v_add_f32 v11, v112, v120
    v_add_f32 v11, v11, v113
    v_add_f32 v11, v11, v114
    v_add_f32 v11, v11, v115
    v_add_f32 v11, v11, v116
    v_add_f32 v11, v11, v117
    v_add_f32 v11, v11, v118
    v_add_f32 v11, v11, v119
    v_add_f32 v10, v10, v11
    s_movk_i32 s33, 0x207
    v_cmp_class_f32 vcc, v10, s33
    s_nop 4
    s_cbranch_vccnz L_e2_fb
L_e2_fin:
    v_rcp_f32 v10, v104
    v_rcp_f32 v11, v120
    s_nop 0
    s_lshl_b32 s36, s26, 3
    s_lshl_b32 s37, s24, 1
    s_add_u32 s36, s36, s37
    s_lshl_b32 s36, s36, 5
    s_add_u32 s36, s36, s25
    s_lshl_b32 s36, s36, 10
    s_add_u32 s36, s36, 0xe00000
    v_mul_f32 v96, v96, v10
    v_mul_f32 v97, v97, v10
    v_mul_f32 v98, v98, v10
    v_mul_f32 v99, v99, v10
    v_mul_f32 v100, v100, v10
    v_mul_f32 v101, v101, v10
    v_mul_f32 v102, v102, v10
    v_mul_f32 v103, v103, v10
    v_cvt_pk_bf16_f32 v160, v96, v97
    v_cvt_pk_bf16_f32 v161, v98, v99
    v_cvt_pk_bf16_f32 v162, v100, v101
    v_cvt_pk_bf16_f32 v163, v102, v103
    buffer_store_dwordx4 v[160:163], v2, s[20:23], s36 offen sc1
    s_add_u32 s36, s36, 32768
    v_mul_f32 v112, v112, v11
    v_mul_f32 v113, v113, v11
    v_mul_f32 v114, v114, v11
    v_mul_f32 v115, v115, v11
    v_mul_f32 v116, v116, v11
    v_mul_f32 v117, v117, v11
    v_mul_f32 v118, v118, v11
    v_mul_f32 v119, v119, v11
    v_cvt_pk_bf16_f32 v168, v112, v113
    v_cvt_pk_bf16_f32 v169, v114, v115
    v_cvt_pk_bf16_f32 v170, v116, v117
    v_cvt_pk_bf16_f32 v171, v118, v119
    buffer_store_dwordx4 v[168:171], v2, s[20:23], s36 offen sc1
    s_lshl_b32 s36, s26, 2
    s_add_u32 s36, s36, s24
    s_lshl_b32 s36, s36, 8
    s_lshl_b32 s37, s25, 3
    s_add_u32 s36, s36, s37
    s_add_u32 s36, s36, 0x44000
    v_mov_b32 v12, s36
    v_mov_b32 v14, s58
    v_mov_b32 v15, s59
    s_mov_b64 exec, 1
    buffer_store_dwordx2 v[14:15], v12, s[20:23], 0 offen sc1
    s_mov_b64 exec, -1
    s_waitcnt vmcnt(0)
    s_waitcnt vmcnt(0)
    s_endpgm
L_f1_g:
    s_load_dwordx2 s[12:13], s[0:1], 32
    s_load_dwordx2 s[16:17], s[0:1], 40
    s_load_dwordx2 s[84:85], s[0:1], 48
    s_load_dwordx2 s[88:89], s[0:1], 16
    s_load_dwordx2 s[4:5], s[0:1], 56
    s_load_dwordx2 s[28:29], s[0:1], 8
    s_sub_u32 s3, s2, 256
    s_waitcnt lgkmcnt(0)
    s_mov_b32 s10, 0x200000
    s_mov_b32 s11, 0x00020000
    s_mov_b32 s22, 0x1300000
    s_mov_b32 s23, 0x00020000
    s_mov_b32 s14, 0x1c0000
    s_mov_b32 s15, 0x00020000
    s_mov_b32 s18, 0x1c0000
    s_mov_b32 s19, 0x00020000
    s_mov_b32 s86, 0x1c0000
    s_mov_b32 s87, 0x00020000
    s_mov_b32 s90, 0x80000
    s_mov_b32 s91, 0x00020000
    s_mov_b32 s6, 0x200000
    s_mov_b32 s7, 0x00020000
    s_cmp_ge_u32 s3, 64
    s_cbranch_scc1 L_f1_fused_ker_stc_12
    s_mov_b32 s98, s3
    v_and_b32 v1, 63, v0
    v_lshrrev_b32 v2, 6, v0
    s_lshl_b32 s40, s98, 15
    s_movk_i32 s41, 4096
    v_lshlrev_b32 v3, 13, v2
    v_lshl_add_u32 v3, v1, 4, v3
    v_add_u32 v3, s40, v3
    buffer_load_dwordx4 v[4:7], v3, s[8:11], 0 offen offset:0
    buffer_load_dwordx4 v[8:11], v3, s[8:11], 0 offen offset:1024
    buffer_load_dwordx4 v[12:15], v3, s[8:11], 0 offen offset:2048
    buffer_load_dwordx4 v[16:19], v3, s[8:11], 0 offen offset:3072
    buffer_load_dwordx4 v[80:83], v3, s[8:11], s41 offen offset:0
    buffer_load_dwordx4 v[84:87], v3, s[8:11], s41 offen offset:1024
    buffer_load_dwordx4 v[88:91], v3, s[8:11], s41 offen offset:2048
    buffer_load_dwordx4 v[92:95], v3, s[8:11], s41 offen offset:3072
    v_bfe_u32 v72, v1, 1, 2
    v_cmp_eq_u32 s[42:43], 1, v72
    v_cmp_eq_u32 s[44:45], 2, v72
    v_cmp_eq_u32 s[46:47], 3, v72
    s_lshl_b32 s40, s98, 10
    v_lshlrev_b32 v73, 8, v2
    v_lshl_add_u32 v73, v1, 4, v73
    v_add_u32 v73, s40, v73
    s_waitcnt vmcnt(4)
    v_mov_b32 v76, 0
    global_load_dwordx2 v[74:75], v76, s[56:57] sc1
    v_lshlrev_b32 v32, 16, v4
    v_and_b32 v33, 0xffff0000, v4
    v_lshlrev_b32 v34, 16, v5
    v_and_b32 v35, 0xffff0000, v5
    v_lshlrev_b32 v36, 16, v6
    v_and_b32 v37, 0xffff0000, v6
    v_lshlrev_b32 v38, 16, v7
    v_and_b32 v39, 0xffff0000, v7
    v_lshlrev_b32 v40, 16, v8
    v_and_b32 v41, 0xffff0000, v8
    v_lshlrev_b32 v42, 16, v9
    v_and_b32 v43, 0xffff0000, v9
    v_lshlrev_b32 v44, 16, v10
    v_and_b32 v45, 0xffff0000, v10
    v_lshlrev_b32 v46, 16, v11
    v_and_b32 v47, 0xffff0000, v11
    v_lshlrev_b32 v48, 16, v12
    v_and_b32 v49, 0xffff0000, v12
    v_lshlrev_b32 v50, 16, v13
    v_and_b32 v51, 0xffff0000, v13
    v_lshlrev_b32 v52, 16, v14
    v_and_b32 v53, 0xffff0000, v14
    v_lshlrev_b32 v54, 16, v15
    v_and_b32 v55, 0xffff0000, v15
    v_lshlrev_b32 v56, 16, v16
    v_and_b32 v57, 0xffff0000, v16
    v_lshlrev_b32 v58, 16, v17
    v_and_b32 v59, 0xffff0000, v17
    v_lshlrev_b32 v60, 16, v18
    v_and_b32 v61, 0xffff0000, v18
    v_lshlrev_b32 v62, 16, v19
    v_and_b32 v63, 0xffff0000, v19
    v_add_f32 v20, v32, v33
    v_add_f32 v21, v40, v41
    v_add_f32 v22, v48, v49
    v_add_f32 v23, v56, v57
    v_add_f32 v20, v20, v34
    v_add_f32 v21, v21, v42
    v_add_f32 v22, v22, v50
    v_add_f32 v23, v23, v58
    v_add_f32 v20, v20, v35
    v_add_f32 v21, v21, v43
    v_add_f32 v22, v22, v51
    v_add_f32 v23, v23, v59
    v_add_f32 v20, v20, v36
    v_add_f32 v21, v21, v44
    v_add_f32 v22, v22, v52
    v_add_f32 v23, v23, v60
    v_add_f32 v20, v20, v37
    v_add_f32 v21, v21, v45
    v_add_f32 v22, v22, v53
    v_add_f32 v23, v23, v61
    v_add_f32 v20, v20, v38
    v_add_f32 v21, v21, v46
    v_add_f32 v22, v22, v54
    v_add_f32 v23, v23, v62
    v_add_f32 v20, v20, v39
    v_add_f32 v21, v21, v47
    v_add_f32 v22, v22, v55
    v_add_f32 v23, v23, v63
    v_add_f32_dpp v20, v20, v20 quad_perm:[1,0,3,2] row_mask:0xf bank_mask:0xf
    v_add_f32_dpp v21, v21, v21 quad_perm:[1,0,3,2] row_mask:0xf bank_mask:0xf
    v_add_f32_dpp v22, v22, v22 quad_perm:[1,0,3,2] row_mask:0xf bank_mask:0xf
    v_add_f32_dpp v23, v23, v23 quad_perm:[1,0,3,2] row_mask:0xf bank_mask:0xf
    v_add_f32_dpp v20, v20, v20 quad_perm:[2,3,0,1] row_mask:0xf bank_mask:0xf
    v_add_f32_dpp v21, v21, v21 quad_perm:[2,3,0,1] row_mask:0xf bank_mask:0xf
    v_add_f32_dpp v22, v22, v22 quad_perm:[2,3,0,1] row_mask:0xf bank_mask:0xf
    v_add_f32_dpp v23, v23, v23 quad_perm:[2,3,0,1] row_mask:0xf bank_mask:0xf
    v_add_f32_dpp v20, v20, v20 row_half_mirror row_mask:0xf bank_mask:0xf
    v_add_f32_dpp v21, v21, v21 row_half_mirror row_mask:0xf bank_mask:0xf
    v_add_f32_dpp v22, v22, v22 row_half_mirror row_mask:0xf bank_mask:0xf
    v_add_f32_dpp v23, v23, v23 row_half_mirror row_mask:0xf bank_mask:0xf
    v_add_f32_dpp v20, v20, v20 row_mirror row_mask:0xf bank_mask:0xf
    v_add_f32_dpp v21, v21, v21 row_mirror row_mask:0xf bank_mask:0xf
    v_add_f32_dpp v22, v22, v22 row_mirror row_mask:0xf bank_mask:0xf
    v_add_f32_dpp v23, v23, v23 row_mirror row_mask:0xf bank_mask:0xf
    v_mov_b32 v24, v20
    v_mov_b32 v25, v21
    v_mov_b32 v26, v22
    v_mov_b32 v27, v23
    s_nop 1
    v_permlane16_swap_b32 v20, v24
    v_permlane16_swap_b32 v21, v25
    v_permlane16_swap_b32 v22, v26
    v_permlane16_swap_b32 v23, v27
    s_nop 1
    v_add_f32 v20, v20, v24
    v_add_f32 v21, v21, v25
    v_add_f32 v22, v22, v26
    v_add_f32 v23, v23, v27
    v_mov_b32 v24, v20
    v_mov_b32 v25, v21
    v_mov_b32 v26, v22
    v_mov_b32 v27, v23
    s_nop 1
    v_permlane32_swap_b32 v20, v24
    v_permlane32_swap_b32 v21, v25
    v_permlane32_swap_b32 v22, v26
    v_permlane32_swap_b32 v23, v27
    s_nop 1
    v_add_f32 v20, v20, v24
    v_add_f32 v21, v21, v25
    v_add_f32 v22, v22, v26
    v_add_f32 v23, v23, v27
    s_nop 1
    v_mul_f32 v20, 0x3b000000, v20
    v_mul_f32 v21, 0x3b000000, v21
    v_mul_f32 v22, 0x3b000000, v22
    v_mul_f32 v23, 0x3b000000, v23
    v_sub_f32 v32, v32, v20
    v_sub_f32 v40, v40, v21
    v_sub_f32 v48, v48, v22
    v_sub_f32 v56, v56, v23
    v_sub_f32 v33, v33, v20
    v_sub_f32 v41, v41, v21
    v_sub_f32 v49, v49, v22
    v_sub_f32 v57, v57, v23
    v_sub_f32 v34, v34, v20
    v_sub_f32 v42, v42, v21
    v_sub_f32 v50, v50, v22
    v_sub_f32 v58, v58, v23
    v_sub_f32 v35, v35, v20
    v_sub_f32 v43, v43, v21
    v_sub_f32 v51, v51, v22
    v_sub_f32 v59, v59, v23
    v_sub_f32 v36, v36, v20
    v_sub_f32 v44, v44, v21
    v_sub_f32 v52, v52, v22
    v_sub_f32 v60, v60, v23
    v_sub_f32 v37, v37, v20
    v_sub_f32 v45, v45, v21
    v_sub_f32 v53, v53, v22
    v_sub_f32 v61, v61, v23
    v_sub_f32 v38, v38, v20
    v_sub_f32 v46, v46, v21
    v_sub_f32 v54, v54, v22
    v_sub_f32 v62, v62, v23
    v_sub_f32 v39, v39, v20
    v_sub_f32 v47, v47, v21
    v_sub_f32 v55, v55, v22
    v_sub_f32 v63, v63, v23
    v_mul_f32 v28, v32, v32
    v_mul_f32 v29, v40, v40
    v_mul_f32 v30, v48, v48
    v_mul_f32 v31, v56, v56
    v_fmac_f32 v28, v33, v33
    v_fmac_f32 v29, v41, v41
    v_fmac_f32 v30, v49, v49
    v_fmac_f32 v31, v57, v57
    v_fmac_f32 v28, v34, v34
    v_fmac_f32 v29, v42, v42
    v_fmac_f32 v30, v50, v50
    v_fmac_f32 v31, v58, v58
    v_fmac_f32 v28, v35, v35
    v_fmac_f32 v29, v43, v43
    v_fmac_f32 v30, v51, v51
    v_fmac_f32 v31, v59, v59
    v_fmac_f32 v28, v36, v36
    v_fmac_f32 v29, v44, v44
    v_fmac_f32 v30, v52, v52
    v_fmac_f32 v31, v60, v60
    v_fmac_f32 v28, v37, v37
    v_fmac_f32 v29, v45, v45
    v_fmac_f32 v30, v53, v53
    v_fmac_f32 v31, v61, v61
    v_fmac_f32 v28, v38, v38
    v_fmac_f32 v29, v46, v46
    v_fmac_f32 v30, v54, v54
    v_fmac_f32 v31, v62, v62
    v_fmac_f32 v28, v39, v39
    v_fmac_f32 v29, v47, v47
    v_fmac_f32 v30, v55, v55
    v_fmac_f32 v31, v63, v63
    v_add_f32_dpp v28, v28, v28 quad_perm:[1,0,3,2] row_mask:0xf bank_mask:0xf
    v_add_f32_dpp v29, v29, v29 quad_perm:[1,0,3,2] row_mask:0xf bank_mask:0xf
    v_add_f32_dpp v30, v30, v30 quad_perm:[1,0,3,2] row_mask:0xf bank_mask:0xf
    v_add_f32_dpp v31, v31, v31 quad_perm:[1,0,3,2] row_mask:0xf bank_mask:0xf
    v_add_f32_dpp v28, v28, v28 quad_perm:[2,3,0,1] row_mask:0xf bank_mask:0xf
    v_add_f32_dpp v29, v29, v29 quad_perm:[2,3,0,1] row_mask:0xf bank_mask:0xf
    v_add_f32_dpp v30, v30, v30 quad_perm:[2,3,0,1] row_mask:0xf bank_mask:0xf
    v_add_f32_dpp v31, v31, v31 quad_perm:[2,3,0,1] row_mask:0xf bank_mask:0xf
    v_add_f32_dpp v28, v28, v28 row_half_mirror row_mask:0xf bank_mask:0xf
    v_add_f32_dpp v29, v29, v29 row_half_mirror row_mask:0xf bank_mask:0xf
    v_add_f32_dpp v30, v30, v30 row_half_mirror row_mask:0xf bank_mask:0xf
    v_add_f32_dpp v31, v31, v31 row_half_mirror row_mask:0xf bank_mask:0xf
    v_add_f32_dpp v28, v28, v28 row_mirror row_mask:0xf bank_mask:0xf
    v_add_f32_dpp v29, v29, v29 row_mirror row_mask:0xf bank_mask:0xf
    v_add_f32_dpp v30, v30, v30 row_mirror row_mask:0xf bank_mask:0xf
    v_add_f32_dpp v31, v31, v31 row_mirror row_mask:0xf bank_mask:0xf
    v_mov_b32 v24, v28
    v_mov_b32 v25, v29
    v_mov_b32 v26, v30
    v_mov_b32 v27, v31
    s_nop 1
    v_permlane16_swap_b32 v28, v24
    v_permlane16_swap_b32 v29, v25
    v_permlane16_swap_b32 v30, v26
    v_permlane16_swap_b32 v31, v27
    s_nop 1
    v_add_f32 v28, v28, v24
    v_add_f32 v29, v29, v25
    v_add_f32 v30, v30, v26
    v_add_f32 v31, v31, v27
    v_mov_b32 v24, v28
    v_mov_b32 v25, v29
    v_mov_b32 v26, v30
    v_mov_b32 v27, v31
    s_nop 1
    v_permlane32_swap_b32 v28, v24
    v_permlane32_swap_b32 v29, v25
    v_permlane32_swap_b32 v30, v26
    v_permlane32_swap_b32 v31, v27
    s_nop 1
    v_add_f32 v28, v28, v24
    v_add_f32 v29, v29, v25
    v_add_f32 v30, v30, v26
    v_add_f32 v31, v31, v27
    s_nop 1
    v_cndmask_b32 v64, v20, v21, s[42:43]
    v_cndmask_b32 v65, v28, v29, s[42:43]
    v_cndmask_b32 v64, v64, v22, s[44:45]
    v_cndmask_b32 v65, v65, v30, s[44:45]
    v_cndmask_b32 v64, v64, v23, s[46:47]
    v_cndmask_b32 v65, v65, v31, s[46:47]
    v_mov_b32 v66, 0x3727c5ac
    v_fmac_f32 v66, 0x3b000000, v65
    v_rsq_f32 v67, v66
    v_sub_f32 v64, 0, v64
    v_mul_f32 v68, v66, v67
    v_cvt_pk_bf16_f32 v69, v64, v64
    s_nop 0
    v_and_b32 v69, 0xffff0000, v69
    v_sub_f32 v70, v64, v69
    v_cvt_pk_bf16_f32 v69, v70, v70
    s_nop 0
    v_and_b32 v69, 0xffff0000, v69
    v_sub_f32 v71, v70, v69
    v_cvt_pk_bf16_f32 v96, v64, v70
    v_cvt_pk_bf16_f32 v98, v71, v64
    v_and_b32 v72, 1, v1
    v_cmp_eq_u32 vcc, 1, v72
    v_mov_b32 v97, v96
    s_waitcnt vmcnt(0)
    v_readfirstlane_b32 s58, v74
    v_readfirstlane_b32 s59, v75
    s_nop 3
    s_cmp_eq_u32 s58, 0
    s_cbranch_scc1 L_f1_fused_ker_eps_16
L_f1_fused_ker_epc_17:
    v_mov_b32 v99, s58
    v_and_b32 v72, 1, v1
    v_cmp_eq_u32 vcc, 1, v72
    s_nop 1
    v_cndmask_b32 v96, v96, v67, vcc
    v_cndmask_b32 v97, v97, v68, vcc
    v_cndmask_b32 v98, v98, v99, vcc
    v_cmp_gt_u32 vcc, 8, v1
    s_and_saveexec_b64 s[48:49], vcc
    buffer_store_dwordx4 v[96:99], v73, s[20:23], 0 offen offset:0 sc1
    s_mov_b64 exec, s[48:49]
    s_nop 1
    v_lshlrev_b32 v32, 16, v80
    v_and_b32 v33, 0xffff0000, v80
    v_lshlrev_b32 v34, 16, v81
    v_and_b32 v35, 0xffff0000, v81
    v_lshlrev_b32 v36, 16, v82
    v_and_b32 v37, 0xffff0000, v82
    v_lshlrev_b32 v38, 16, v83
    v_and_b32 v39, 0xffff0000, v83
    v_lshlrev_b32 v40, 16, v84
    v_and_b32 v41, 0xffff0000, v84
    v_lshlrev_b32 v42, 16, v85
    v_and_b32 v43, 0xffff0000, v85
    v_lshlrev_b32 v44, 16, v86
    v_and_b32 v45, 0xffff0000, v86
    v_lshlrev_b32 v46, 16, v87
    v_and_b32 v47, 0xffff0000, v87
    v_lshlrev_b32 v48, 16, v88
    v_and_b32 v49, 0xffff0000, v88
    v_lshlrev_b32 v50, 16, v89
    v_and_b32 v51, 0xffff0000, v89
    v_lshlrev_b32 v52, 16, v90
    v_and_b32 v53, 0xffff0000, v90
    v_lshlrev_b32 v54, 16, v91
    v_and_b32 v55, 0xffff0000, v91
    v_lshlrev_b32 v56, 16, v92
    v_and_b32 v57, 0xffff0000, v92
    v_lshlrev_b32 v58, 16, v93
    v_and_b32 v59, 0xffff0000, v93
    v_lshlrev_b32 v60, 16, v94
    v_and_b32 v61, 0xffff0000, v94
    v_lshlrev_b32 v62, 16, v95
    v_and_b32 v63, 0xffff0000, v95
    v_add_f32 v20, v32, v33
    v_add_f32 v21, v40, v41
    v_add_f32 v22, v48, v49
    v_add_f32 v23, v56, v57
    v_add_f32 v20, v20, v34
    v_add_f32 v21, v21, v42
    v_add_f32 v22, v22, v50
    v_add_f32 v23, v23, v58
    v_add_f32 v20, v20, v35
    v_add_f32 v21, v21, v43
    v_add_f32 v22, v22, v51
    v_add_f32 v23, v23, v59
    v_add_f32 v20, v20, v36
    v_add_f32 v21, v21, v44
    v_add_f32 v22, v22, v52
    v_add_f32 v23, v23, v60
    v_add_f32 v20, v20, v37
    v_add_f32 v21, v21, v45
    v_add_f32 v22, v22, v53
    v_add_f32 v23, v23, v61
    v_add_f32 v20, v20, v38
    v_add_f32 v21, v21, v46
    v_add_f32 v22, v22, v54
    v_add_f32 v23, v23, v62
    v_add_f32 v20, v20, v39
    v_add_f32 v21, v21, v47
    v_add_f32 v22, v22, v55
    v_add_f32 v23, v23, v63
    v_add_f32_dpp v20, v20, v20 quad_perm:[1,0,3,2] row_mask:0xf bank_mask:0xf
    v_add_f32_dpp v21, v21, v21 quad_perm:[1,0,3,2] row_mask:0xf bank_mask:0xf
    v_add_f32_dpp v22, v22, v22 quad_perm:[1,0,3,2] row_mask:0xf bank_mask:0xf
    v_add_f32_dpp v23, v23, v23 quad_perm:[1,0,3,2] row_mask:0xf bank_mask:0xf
    v_add_f32_dpp v20, v20, v20 quad_perm:[2,3,0,1] row_mask:0xf bank_mask:0xf
    v_add_f32_dpp v21, v21, v21 quad_perm:[2,3,0,1] row_mask:0xf bank_mask:0xf
    v_add_f32_dpp v22, v22, v22 quad_perm:[2,3,0,1] row_mask:0xf bank_mask:0xf
    v_add_f32_dpp v23, v23, v23 quad_perm:[2,3,0,1] row_mask:0xf bank_mask:0xf
    v_add_f32_dpp v20, v20, v20 row_half_mirror row_mask:0xf bank_mask:0xf
    v_add_f32_dpp v21, v21, v21 row_half_mirror row_mask:0xf bank_mask:0xf
    v_add_f32_dpp v22, v22, v22 row_half_mirror row_mask:0xf bank_mask:0xf
    v_add_f32_dpp v23, v23, v23 row_half_mirror row_mask:0xf bank_mask:0xf
    v_add_f32_dpp v20, v20, v20 row_mirror row_mask:0xf bank_mask:0xf
    v_add_f32_dpp v21, v21, v21 row_mirror row_mask:0xf bank_mask:0xf
    v_add_f32_dpp v22, v22, v22 row_mirror row_mask:0xf bank_mask:0xf
    v_add_f32_dpp v23, v23, v23 row_mirror row_mask:0xf bank_mask:0xf
    v_mov_b32 v24, v20
    v_mov_b32 v25, v21
    v_mov_b32 v26, v22
    v_mov_b32 v27, v23
    s_nop 1
    v_permlane16_swap_b32 v20, v24
    v_permlane16_swap_b32 v21, v25
    v_permlane16_swap_b32 v22, v26
    v_permlane16_swap_b32 v23, v27
    s_nop 1
    v_add_f32 v20, v20, v24
    v_add_f32 v21, v21, v25
    v_add_f32 v22, v22, v26
    v_add_f32 v23, v23, v27
    v_mov_b32 v24, v20
    v_mov_b32 v25, v21
    v_mov_b32 v26, v22
    v_mov_b32 v27, v23
    s_nop 1
    v_permlane32_swap_b32 v20, v24
    v_permlane32_swap_b32 v21, v25
    v_permlane32_swap_b32 v22, v26
    v_permlane32_swap_b32 v23, v27
    s_nop 1
    v_add_f32 v20, v20, v24
    v_add_f32 v21, v21, v25
    v_add_f32 v22, v22, v26
    v_add_f32 v23, v23, v27
    s_nop 1
    v_mul_f32 v20, 0x3b000000, v20
    v_mul_f32 v21, 0x3b000000, v21
    v_mul_f32 v22, 0x3b000000, v22
    v_mul_f32 v23, 0x3b000000, v23
    v_sub_f32 v32, v32, v20
    v_sub_f32 v40, v40, v21
    v_sub_f32 v48, v48, v22
    v_sub_f32 v56, v56, v23
    v_sub_f32 v33, v33, v20
    v_sub_f32 v41, v41, v21
    v_sub_f32 v49, v49, v22
    v_sub_f32 v57, v57, v23
    v_sub_f32 v34, v34, v20
    v_sub_f32 v42, v42, v21
    v_sub_f32 v50, v50, v22
    v_sub_f32 v58, v58, v23
    v_sub_f32 v35, v35, v20
    v_sub_f32 v43, v43, v21
    v_sub_f32 v51, v51, v22
    v_sub_f32 v59, v59, v23
    v_sub_f32 v36, v36, v20
    v_sub_f32 v44, v44, v21
    v_sub_f32 v52, v52, v22
    v_sub_f32 v60, v60, v23
    v_sub_f32 v37, v37, v20
    v_sub_f32 v45, v45, v21
    v_sub_f32 v53, v53, v22
    v_sub_f32 v61, v61, v23
    v_sub_f32 v38, v38, v20
    v_sub_f32 v46, v46, v21
    v_sub_f32 v54, v54, v22
    v_sub_f32 v62, v62, v23
    v_sub_f32 v39, v39, v20
    v_sub_f32 v47, v47, v21
    v_sub_f32 v55, v55, v22
    v_sub_f32 v63, v63, v23
    v_mul_f32 v28, v32, v32
    v_mul_f32 v29, v40, v40
    v_mul_f32 v30, v48, v48
    v_mul_f32 v31, v56, v56
    v_fmac_f32 v28, v33, v33
    v_fmac_f32 v29, v41, v41
    v_fmac_f32 v30, v49, v49
    v_fmac_f32 v31, v57, v57
    v_fmac_f32 v28, v34, v34
    v_fmac_f32 v29, v42, v42
    v_fmac_f32 v30, v50, v50
    v_fmac_f32 v31, v58, v58
    v_fmac_f32 v28, v35, v35
    v_fmac_f32 v29, v43, v43
    v_fmac_f32 v30, v51, v51
    v_fmac_f32 v31, v59, v59
    v_fmac_f32 v28, v36, v36
    v_fmac_f32 v29, v44, v44
    v_fmac_f32 v30, v52, v52
    v_fmac_f32 v31, v60, v60
    v_fmac_f32 v28, v37, v37
    v_fmac_f32 v29, v45, v45
    v_fmac_f32 v30, v53, v53
    v_fmac_f32 v31, v61, v61
    v_fmac_f32 v28, v38, v38
    v_fmac_f32 v29, v46, v46
    v_fmac_f32 v30, v54, v54
    v_fmac_f32 v31, v62, v62
    v_fmac_f32 v28, v39, v39
    v_fmac_f32 v29, v47, v47
    v_fmac_f32 v30, v55, v55
    v_fmac_f32 v31, v63, v63
    v_add_f32_dpp v28, v28, v28 quad_perm:[1,0,3,2] row_mask:0xf bank_mask:0xf
    v_add_f32_dpp v29, v29, v29 quad_perm:[1,0,3,2] row_mask:0xf bank_mask:0xf
    v_add_f32_dpp v30, v30, v30 quad_perm:[1,0,3,2] row_mask:0xf bank_mask:0xf
    v_add_f32_dpp v31, v31, v31 quad_perm:[1,0,3,2] row_mask:0xf bank_mask:0xf
    v_add_f32_dpp v28, v28, v28 quad_perm:[2,3,0,1] row_mask:0xf bank_mask:0xf
    v_add_f32_dpp v29, v29, v29 quad_perm:[2,3,0,1] row_mask:0xf bank_mask:0xf
    v_add_f32_dpp v30, v30, v30 quad_perm:[2,3,0,1] row_mask:0xf bank_mask:0xf
    v_add_f32_dpp v31, v31, v31 quad_perm:[2,3,0,1] row_mask:0xf bank_mask:0xf
    v_add_f32_dpp v28, v28, v28 row_half_mirror row_mask:0xf bank_mask:0xf
    v_add_f32_dpp v29, v29, v29 row_half_mirror row_mask:0xf bank_mask:0xf
    v_add_f32_dpp v30, v30, v30 row_half_mirror row_mask:0xf bank_mask:0xf
    v_add_f32_dpp v31, v31, v31 row_half_mirror row_mask:0xf bank_mask:0xf
    v_add_f32_dpp v28, v28, v28 row_mirror row_mask:0xf bank_mask:0xf
    v_add_f32_dpp v29, v29, v29 row_mirror row_mask:0xf bank_mask:0xf
    v_add_f32_dpp v30, v30, v30 row_mirror row_mask:0xf bank_mask:0xf
    v_add_f32_dpp v31, v31, v31 row_mirror row_mask:0xf bank_mask:0xf
    v_mov_b32 v24, v28
    v_mov_b32 v25, v29
    v_mov_b32 v26, v30
    v_mov_b32 v27, v31
    s_nop 1
    v_permlane16_swap_b32 v28, v24
    v_permlane16_swap_b32 v29, v25
    v_permlane16_swap_b32 v30, v26
    v_permlane16_swap_b32 v31, v27
    s_nop 1
    v_add_f32 v28, v28, v24
    v_add_f32 v29, v29, v25
    v_add_f32 v30, v30, v26
    v_add_f32 v31, v31, v27
    v_mov_b32 v24, v28
    v_mov_b32 v25, v29
    v_mov_b32 v26, v30
    v_mov_b32 v27, v31
    s_nop 1
    v_permlane32_swap_b32 v28, v24
    v_permlane32_swap_b32 v29, v25
    v_permlane32_swap_b32 v30, v26
    v_permlane32_swap_b32 v31, v27
    s_nop 1
    v_add_f32 v28, v28, v24
    v_add_f32 v29, v29, v25
    v_add_f32 v30, v30, v26
    v_add_f32 v31, v31, v27
    s_nop 1
    v_cndmask_b32 v64, v20, v21, s[42:43]
    v_cndmask_b32 v65, v28, v29, s[42:43]
    v_cndmask_b32 v64, v64, v22, s[44:45]
    v_cndmask_b32 v65, v65, v30, s[44:45]
    v_cndmask_b32 v64, v64, v23, s[46:47]
    v_cndmask_b32 v65, v65, v31, s[46:47]
    v_mov_b32 v66, 0x3727c5ac
    v_fmac_f32 v66, 0x3b000000, v65
    v_rsq_f32 v67, v66
    v_sub_f32 v64, 0, v64
    v_mul_f32 v68, v66, v67
    v_cvt_pk_bf16_f32 v69, v64, v64
    s_nop 0
    v_and_b32 v69, 0xffff0000, v69
    v_sub_f32 v70, v64, v69
    v_cvt_pk_bf16_f32 v69, v70, v70
    s_nop 0
    v_and_b32 v69, 0xffff0000, v69
    v_sub_f32 v71, v70, v69
    v_cvt_pk_bf16_f32 v96, v64, v70
    v_cvt_pk_bf16_f32 v98, v71, v64
    v_and_b32 v72, 1, v1
    v_cmp_eq_u32 vcc, 1, v72
    v_mov_b32 v97, v96
    v_mov_b32 v99, s58
    v_and_b32 v72, 1, v1
    v_cmp_eq_u32 vcc, 1, v72
    s_nop 1
    v_cndmask_b32 v96, v96, v67, vcc
    v_cndmask_b32 v97, v97, v68, vcc
    v_cndmask_b32 v98, v98, v99, vcc
    v_cmp_gt_u32 vcc, 8, v1
    s_and_saveexec_b64 s[48:49], vcc
    buffer_store_dwordx4 v[96:99], v73, s[20:23], 0 offen offset:128 sc1
    s_mov_b64 exec, s[48:49]
    s_nop 1
    s_branch L_f1_fused_ker_std_13
L_f1_fused_ker_stc_12:
    s_sub_u32 s98, s3, 64
    s_cmp_lt_u32 s3, 112
    s_cbranch_scc1 L_f1_fused_ker_stq_15
    s_cmp_lt_u32 s3, 144
    s_cbranch_scc1 L_f1_fused_ker_std_13
    s_sub_u32 s98, s3, 96
L_f1_fused_ker_stq_15:
    s_and_b32 s99, s98, 1
    s_lshr_b32 s98, s98, 1
    s_mov_b32 s92, s28
    s_mov_b32 s93, s29
    s_mov_b32 s94, 1572864
    s_mov_b32 s95, 0x00020000
    s_movk_i32 s96, 3072
    s_lshl_b32 s97, s98, 7
    s_cmp_lt_u32 s98, 24
    s_cbranch_scc1 L_f1_fused_ker_stg_14
    s_mov_b32 s92, s12
    s_mov_b32 s93, s13
    s_mov_b32 s94, 1835008
    s_movk_i32 s96, 3584
    s_sub_u32 s97, s98, 24
    s_lshl_b32 s97, s97, 7
    s_cmp_lt_u32 s98, 52
    s_cbranch_scc1 L_f1_fused_ker_stg_14
    s_mov_b32 s92, s16
    s_mov_b32 s93, s17
    s_sub_u32 s97, s98, 52
    s_lshl_b32 s97, s97, 7
L_f1_fused_ker_stg_14:
    v_and_b32 v1, 63, v0
    v_lshrrev_b32 v2, 6, v0
    v_lshrrev_b32 v3, 3, v1
    v_lshl_add_u32 v3, v2, 6, v3
    s_lshl_b32 s40, s99, 8
    v_add_u32 v3, s40, v3
    v_mul_lo_u32 v3, v3, s96
    v_and_b32 v4, 7, v1
    v_lshl_add_u32 v3, v4, 4, v3
    v_add_u32 v3, s97, v3
    s_lshl_b32 s41, s96, 3
    s_mov_b32 s40, 0
    buffer_load_dwordx4 v[8:11], v3, s[92:95], s40 offen
    s_add_u32 s40, s40, s41
    buffer_load_dwordx4 v[12:15], v3, s[92:95], s40 offen
    s_add_u32 s40, s40, s41
    buffer_load_dwordx4 v[16:19], v3, s[92:95], s40 offen
    s_add_u32 s40, s40, s41
    buffer_load_dwordx4 v[20:23], v3, s[92:95], s40 offen
    s_add_u32 s40, s40, s41
    buffer_load_dwordx4 v[24:27], v3, s[92:95], s40 offen
    s_add_u32 s40, s40, s41
    buffer_load_dwordx4 v[28:31], v3, s[92:95], s40 offen
    s_add_u32 s40, s40, s41
    buffer_load_dwordx4 v[32:35], v3, s[92:95], s40 offen
    s_add_u32 s40, s40, s41
    buffer_load_dwordx4 v[36:39], v3, s[92:95], s40 offen
    s_mov_b32 s42, 0x00003f80
    s_mov_b32 s43, 0x3f800000
    v_mov_b32 v80, 0
    v_mov_b32 v81, 0
    v_mov_b32 v82, 0
    v_mov_b32 v83, 0
    v_mov_b32 v84, 0
    v_mov_b32 v85, 0
    v_mov_b32 v86, 0
    v_mov_b32 v87, 0
    s_waitcnt vmcnt(7)
    v_mov_b32 v76, 0
    global_load_dwordx2 v[74:75], v76, s[56:57] sc1
    v_dot2_f32_bf16 v80, v8, s42, v80
    v_dot2_f32_bf16 v81, v8, s43, v81
    v_dot2_f32_bf16 v82, v9, s42, v82
    v_dot2_f32_bf16 v83, v9, s43, v83
    v_dot2_f32_bf16 v84, v10, s42, v84
    v_dot2_f32_bf16 v85, v10, s43, v85
    v_dot2_f32_bf16 v86, v11, s42, v86
    v_dot2_f32_bf16 v87, v11, s43, v87
    s_waitcnt vmcnt(7)
    v_dot2_f32_bf16 v80, v12, s42, v80
    v_dot2_f32_bf16 v81, v12, s43, v81
    v_dot2_f32_bf16 v82, v13, s42, v82
    v_dot2_f32_bf16 v83, v13, s43, v83
    v_dot2_f32_bf16 v84, v14, s42, v84
    v_dot2_f32_bf16 v85, v14, s43, v85
    v_dot2_f32_bf16 v86, v15, s42, v86
    v_dot2_f32_bf16 v87, v15, s43, v87
    s_waitcnt vmcnt(6)
    v_dot2_f32_bf16 v80, v16, s42, v80
    v_dot2_f32_bf16 v81, v16, s43, v81
    v_dot2_f32_bf16 v82, v17, s42, v82
    v_dot2_f32_bf16 v83, v17, s43, v83
    v_dot2_f32_bf16 v84, v18, s42, v84
    v_dot2_f32_bf16 v85, v18, s43, v85
    v_dot2_f32_bf16 v86, v19, s42, v86
    v_dot2_f32_bf16 v87, v19, s43, v87
    s_waitcnt vmcnt(5)
    v_dot2_f32_bf16 v80, v20, s42, v80
    v_dot2_f32_bf16 v81, v20, s43, v81
    v_dot2_f32_bf16 v82, v21, s42, v82
    v_dot2_f32_bf16 v83, v21, s43, v83
    v_dot2_f32_bf16 v84, v22, s42, v84
    v_dot2_f32_bf16 v85, v22, s43, v85
    v_dot2_f32_bf16 v86, v23, s42, v86
    v_dot2_f32_bf16 v87, v23, s43, v87
    s_waitcnt vmcnt(4)
    v_dot2_f32_bf16 v80, v24, s42, v80
    v_dot2_f32_bf16 v81, v24, s43, v81
    v_dot2_f32_bf16 v82, v25, s42, v82
    v_dot2_f32_bf16 v83, v25, s43, v83
    v_dot2_f32_bf16 v84, v26, s42, v84
    v_dot2_f32_bf16 v85, v26, s43, v85
    v_dot2_f32_bf16 v86, v27, s42, v86
    v_dot2_f32_bf16 v87, v27, s43, v87
    s_waitcnt vmcnt(3)
    v_dot2_f32_bf16 v80, v28, s42, v80
    v_dot2_f32_bf16 v81, v28, s43, v81
    v_dot2_f32_bf16 v82, v29, s42, v82
    v_dot2_f32_bf16 v83, v29, s43, v83
    v_dot2_f32_bf16 v84, v30, s42, v84
    v_dot2_f32_bf16 v85, v30, s43, v85
    v_dot2_f32_bf16 v86, v31, s42, v86
    v_dot2_f32_bf16 v87, v31, s43, v87
    s_waitcnt vmcnt(2)
    v_dot2_f32_bf16 v80, v32, s42, v80
    v_dot2_f32_bf16 v81, v32, s43, v81
    v_dot2_f32_bf16 v82, v33, s42, v82
    v_dot2_f32_bf16 v83, v33, s43, v83
    v_dot2_f32_bf16 v84, v34, s42, v84
    v_dot2_f32_bf16 v85, v34, s43, v85
    v_dot2_f32_bf16 v86, v35, s42, v86
    v_dot2_f32_bf16 v87, v35, s43, v87
    s_waitcnt vmcnt(1)
    v_dot2_f32_bf16 v80, v36, s42, v80
    v_dot2_f32_bf16 v81, v36, s43, v81
    v_dot2_f32_bf16 v82, v37, s42, v82
    v_dot2_f32_bf16 v83, v37, s43, v83
    v_dot2_f32_bf16 v84, v38, s42, v84
    v_dot2_f32_bf16 v85, v38, s43, v85
    v_dot2_f32_bf16 v86, v39, s42, v86
    v_dot2_f32_bf16 v87, v39, s43, v87
    s_nop 2
    v_add_f32_dpp v80, v80, v80 row_ror:8 row_mask:0xf bank_mask:0xf
    v_add_f32_dpp v81, v81, v81 row_ror:8 row_mask:0xf bank_mask:0xf
    v_add_f32_dpp v82, v82, v82 row_ror:8 row_mask:0xf bank_mask:0xf
    v_add_f32_dpp v83, v83, v83 row_ror:8 row_mask:0xf bank_mask:0xf
    v_add_f32_dpp v84, v84, v84 row_ror:8 row_mask:0xf bank_mask:0xf
    v_add_f32_dpp v85, v85, v85 row_ror:8 row_mask:0xf bank_mask:0xf
    v_add_f32_dpp v86, v86, v86 row_ror:8 row_mask:0xf bank_mask:0xf
    v_add_f32_dpp v87, v87, v87 row_ror:8 row_mask:0xf bank_mask:0xf
    v_lshrrev_b32 v5, 4, v1
    v_lshl_add_u32 v5, v2, 2, v5
    v_lshlrev_b32 v5, 8, v5
    v_lshl_add_u32 v5, v4, 5, v5
    v_and_b32 v6, 15, v1
    v_cmp_gt_u32 vcc, 8, v6
    s_and_saveexec_b64 s[44:45], vcc
    ds_write_b128 v5, v[80:83] offset:0
    ds_write_b128 v5, v[84:87] offset:16
    s_mov_b64 exec, s[44:45]
    s_waitcnt lgkmcnt(0)
    s_barrier
    v_lshlrev_b32 v5, 2, v1
    ds_read_b32 v8, v5 offset:0
    ds_read_b32 v9, v5 offset:256
    ds_read_b32 v10, v5 offset:512
    ds_read_b32 v11, v5 offset:768
    ds_read_b32 v12, v5 offset:1024
    ds_read_b32 v13, v5 offset:1280
    ds_read_b32 v14, v5 offset:1536
    ds_read_b32 v15, v5 offset:1792
    ds_read_b32 v16, v5 offset:2048
    ds_read_b32 v17, v5 offset:2304
    ds_read_b32 v18, v5 offset:2560
    ds_read_b32 v19, v5 offset:2816
    ds_read_b32 v20, v5 offset:3072
    ds_read_b32 v21, v5 offset:3328
    ds_read_b32 v22, v5 offset:3584
    ds_read_b32 v23, v5 offset:3840
    s_waitcnt lgkmcnt(0)
    v_add_f32 v8, v8, v16
    v_add_f32 v9, v9, v17
    v_add_f32 v10, v10, v18
    v_add_f32 v11, v11, v19
    v_add_f32 v12, v12, v20
    v_add_f32 v13, v13, v21
    v_add_f32 v14, v14, v22
    v_add_f32 v15, v15, v23
    v_add_f32 v8, v8, v12
    v_add_f32 v9, v9, v13
    v_add_f32 v10, v10, v14
    v_add_f32 v11, v11, v15
    v_add_f32 v8, v8, v10
    v_add_f32 v9, v9, v11
    v_add_f32 v8, v8, v9
    s_nop 0
    v_cvt_pk_bf16_f32 v12, v8, v8
    s_nop 0
    v_and_b32 v9, 0xffff0000, v12
    v_sub_f32 v9, v8, v9
    v_cvt_pk_bf16_f32 v13, v9, v9
    s_nop 0
    v_and_b32 v10, 0xffff0000, v13
    v_sub_f32 v10, v9, v10
    v_cvt_pk_bf16_f32 v14, v8, v10
    s_lshl_b32 s40, s98, 10
    v_lshlrev_b32 v5, 4, v1
    v_add_u32 v5, s40, v5
    s_mov_b32 s40, 65536
    s_mul_i32 s41, s99, 81920
    s_add_u32 s40, s40, s41
    s_waitcnt vmcnt(0)
    v_readfirstlane_b32 s58, v74
    v_readfirstlane_b32 s59, v75
    s_nop 3
    s_cmp_eq_u32 s58, 0
    s_cbranch_scc1 L_f1_fused_ker_eps_19
L_f1_fused_ker_epc_20:
    v_mov_b32 v15, s58
    v_cmp_gt_u32 vcc, 64, v0
    s_and_saveexec_b64 s[44:45], vcc
    s_cbranch_execz L_f1_fused_ker_cjx_21
    buffer_store_dwordx4 v[12:15], v5, s[20:23], s40 offen sc1
L_f1_fused_ker_cjx_21:
    s_mov_b64 exec, s[44:45]
    s_barrier
L_f1_fused_ker_std_13:
    s_and_b32 s92, s3, 7
    s_lshr_b32 s93, s3, 3
    s_and_b32 s47, s93, 3
    s_lshl_b32 s94, s92, 2
    s_add_u32 s47, s47, s94
    s_lshr_b32 s46, s93, 2
    s_cmp_ge_u32 s2, 480
    s_cbranch_scc1 L_f1_pf
    s_and_b32 s26, s92, 1
    s_mul_i32 s26, s26, 7
    s_lshr_b32 s94, s93, 2
    s_add_u32 s26, s26, s94
    s_lshr_b32 s25, s92, 1
    s_lshl_b32 s25, s25, 2
    s_and_b32 s95, s93, 3
    s_add_u32 s25, s25, s95
    s_lshl_b32 s53, s95, 1
    s_add_u32 s53, s53, s94
    s_and_b32 s53, s53, 7
    v_and_b32 v1, 63, v0
    v_and_b32 v11, 31, v1
    v_lshrrev_b32 v12, 5, v1
    s_and_b32 s27, s24, 1
    s_lshr_b32 s28, s24, 1
    v_lshrrev_b32 v13, 3, v1
    v_lshrrev_b32 v14, 4, v1
    v_and_b32 v15, 7, v1
    v_xor_b32 v7, v15, v14
    v_lshlrev_b32 v7, 4, v7
    v_lshl_add_u32 v7, v13, 10, v7
    s_lshl_b32 s29, s25, 17
    s_lshl_b32 s30, s24, 15
    s_add_u32 s29, s29, s30
    v_add_u32 v7, s29, v7
    v_xor_b32 v8, 64, v7
    v_add_u32 v8, 8192, v8
    v_lshlrev_b32 v13, 2, v14
    v_and_b32 v15, 15, v1
    v_xor_b32 v9, v15, v13
    v_lshlrev_b32 v9, 4, v9
    s_lshl_b32 s30, s24, 3
    v_add_u32 v13, s30, v14
    v_mul_u32_u24 v13, 3584, v13
    v_add_u32 v9, v9, v13
    s_lshl_b32 s30, s26, 8
    v_add_u32 v9, s30, v9
    s_lshl_b32 s31, s24, 12
    s_add_u32 s31, s31, 49152
    s_lshl_b32 s32, s24, 11
    s_lshl_b32 s51, s53, 7
    s_mul_i32 s50, s53, 229376
    s_add_u32 m0, s31, 0
    s_add_u32 s33, s51, 0x0
    buffer_load_dwordx4 v7, s[8:11], s33 offen lds
    s_add_u32 m0, s31, 1024
    s_add_u32 s33, s51, 0x0
    buffer_load_dwordx4 v8, s[8:11], s33 offen lds
    s_add_u32 m0, s31, 2048
    s_add_u32 s33, s51, 0x4000
    buffer_load_dwordx4 v7, s[8:11], s33 offen lds
    s_add_u32 m0, s31, 3072
    s_add_u32 s33, s51, 0x4000
    buffer_load_dwordx4 v8, s[8:11], s33 offen lds
    s_add_u32 s51, s51, 128
    s_and_b32 s51, s51, 1023
    s_add_u32 m0, s32, 0
    s_add_u32 s33, s50, 0x0
    buffer_load_dwordx4 v9, s[12:15], s33 offen lds
    s_add_u32 m0, s32, 8192
    s_add_u32 s33, s50, 0x0
    buffer_load_dwordx4 v9, s[16:19], s33 offen lds
    s_add_u32 m0, s32, 1024
    s_add_u32 s33, s50, 0x3800
    buffer_load_dwordx4 v9, s[12:15], s33 offen lds
    s_add_u32 m0, s32, 9216
    s_add_u32 s33, s50, 0x3800
    buffer_load_dwordx4 v9, s[16:19], s33 offen lds
    s_add_u32 s50, s50, 114688
    s_cmp_ge_u32 s50, 1835008
    s_cselect_b32 s52, 1835008, 0
    s_sub_u32 s50, s50, s52
    s_add_u32 m0, s32, 16384
    s_add_u32 s33, s50, 0x0
    buffer_load_dwordx4 v9, s[12:15], s33 offen lds
    s_add_u32 m0, s32, 24576
    s_add_u32 s33, s50, 0x0
    buffer_load_dwordx4 v9, s[16:19], s33 offen lds
    s_add_u32 m0, s32, 17408
    s_add_u32 s33, s50, 0x3800
    buffer_load_dwordx4 v9, s[12:15], s33 offen lds
    s_add_u32 m0, s32, 25600
    s_add_u32 s33, s50, 0x3800
    buffer_load_dwordx4 v9, s[16:19], s33 offen lds
    s_add_u32 s50, s50, 114688
    s_cmp_ge_u32 s50, 1835008
    s_cselect_b32 s52, 1835008, 0
    s_sub_u32 s50, s50, s52
    s_lshl_b32 s36, s27, 6
    v_add_u32 v13, s36, v11
    v_bfe_u32 v14, v13, 1, 3
    v_xor_b32 v14, v14, v12
    v_lshlrev_b32 v14, 4, v14
    v_lshl_add_u32 v2, v13, 7, v14
    v_add_u32 v2, 49152, v2
    v_xor_b32 v3, 32, v2
    v_xor_b32 v4, 64, v2
    v_xor_b32 v5, 96, v2
    v_bfe_u32 v15, v1, 2, 2
    v_lshl_add_u32 v13, v12, 3, v15
    v_lshlrev_b32 v6, 8, v13
    v_bfe_u32 v13, v1, 4, 1
    v_lshlrev_b32 v13, 1, v13
    v_bfe_u32 v14, v1, 1, 1
    v_add_u32 v13, v13, v14
    s_lshl_b32 s36, s28, 3
    v_add_u32 v13, s36, v13
    v_lshlrev_b32 v15, 2, v15
    v_xor_b32 v13, v13, v15
    v_lshl_add_u32 v6, v13, 4, v6
    v_and_b32 v14, 1, v1
    v_lshl_add_u32 v6, v14, 3, v6
    v_xor_b32 v10, 64, v6
    v_xor_b32 v72, 4096, v6
    v_xor_b32 v73, 4096, v10
    s_lshl_b32 s34, s25, 7
    s_lshl_b32 s35, s27, 6
    s_add_u32 s34, s34, s35
    v_add_u32 v108, s34, v11
    v_lshlrev_b32 v108, 5, v108
    s_lshl_b32 s35, s26, 7
    s_lshl_b32 s36, s28, 6
    s_add_u32 s35, s35, s36
    v_add_u32 v109, s35, v11
    v_lshlrev_b32 v109, 4, v109
    v_mul_u32_u24 v13, 0x14000, v12
    v_add_u32 v109, v109, v13
    s_waitcnt vmcnt(4)
    s_barrier
    ds_read_b128 v[16:19], v2 offset:0
    ds_read_b64_tr_b16 v[24:25], v6 offset:0
    ds_read_b64_tr_b16 v[26:27], v6 offset:1024
    ds_read_b128 v[20:23], v2 offset:4096
    ds_read_b64_tr_b16 v[28:29], v10 offset:0
    ds_read_b64_tr_b16 v[30:31], v10 offset:1024
    ds_read_b64_tr_b16 v[32:33], v6 offset:8192
    ds_read_b64_tr_b16 v[34:35], v6 offset:9216
    ds_read_b64_tr_b16 v[36:37], v10 offset:8192
    ds_read_b64_tr_b16 v[38:39], v10 offset:9216
    ds_read_b128 v[40:43], v3 offset:0
    ds_read_b64_tr_b16 v[48:49], v72 offset:0
    ds_read_b64_tr_b16 v[50:51], v72 offset:1024
    ds_read_b128 v[44:47], v3 offset:4096
    ds_read_b64_tr_b16 v[52:53], v73 offset:0
    ds_read_b64_tr_b16 v[54:55], v73 offset:1024
    ds_read_b64_tr_b16 v[56:57], v72 offset:8192
    ds_read_b64_tr_b16 v[58:59], v72 offset:9216
    ds_read_b64_tr_b16 v[60:61], v73 offset:8192
    ds_read_b64_tr_b16 v[62:63], v73 offset:9216
    s_waitcnt lgkmcnt(15)
    v_mfma_f32_32x32x16_bf16 v[128:143], v[24:27], v[16:19], 0
    s_add_u32 m0, s32, 32768
    s_add_u32 s33, s50, 0x0
    buffer_load_dwordx4 v9, s[12:15], s33 offen lds
    v_mfma_f32_32x32x16_bf16 v[144:159], v[24:27], v[20:23], 0
    s_add_u32 m0, s32, 40960
    s_add_u32 s33, s50, 0x0
    buffer_load_dwordx4 v9, s[16:19], s33 offen lds
    s_waitcnt lgkmcnt(14)
    v_mfma_f32_32x32x16_bf16 v[160:175], v[28:31], v[16:19], 0
    s_add_u32 m0, s32, 33792
    s_add_u32 s33, s50, 0x3800
    buffer_load_dwordx4 v9, s[12:15], s33 offen lds
    v_mfma_f32_32x32x16_bf16 v[176:191], v[28:31], v[20:23], 0
    s_add_u32 m0, s32, 41984
    s_add_u32 s33, s50, 0x3800
    buffer_load_dwordx4 v9, s[16:19], s33 offen lds
    s_add_u32 s50, s50, 114688
    s_cmp_ge_u32 s50, 1835008
    s_cselect_b32 s52, 1835008, 0
    s_sub_u32 s50, s50, s52
    s_waitcnt lgkmcnt(12)
    v_mfma_f32_32x32x16_bf16 v[192:207], v[32:35], v[16:19], 0
    s_add_u32 m0, s31, 16384
    s_add_u32 s33, s51, 0x0
    buffer_load_dwordx4 v7, s[8:11], s33 offen lds
    v_mfma_f32_32x32x16_bf16 v[208:223], v[32:35], v[20:23], 0
    s_add_u32 m0, s31, 17408
    s_add_u32 s33, s51, 0x0
    buffer_load_dwordx4 v8, s[8:11], s33 offen lds
    s_waitcnt lgkmcnt(10)
    v_mfma_f32_32x32x16_bf16 v[224:239], v[36:39], v[16:19], 0
    s_add_u32 m0, s31, 18432
    s_add_u32 s33, s51, 0x4000
    buffer_load_dwordx4 v7, s[8:11], s33 offen lds
    v_mfma_f32_32x32x16_bf16 v[240:255], v[36:39], v[20:23], 0
    s_add_u32 m0, s31, 19456
    s_add_u32 s33, s51, 0x4000
    buffer_load_dwordx4 v8, s[8:11], s33 offen lds
    s_add_u32 s51, s51, 128
    s_and_b32 s51, s51, 1023
    s_waitcnt vmcnt(8)
    s_waitcnt lgkmcnt(0)
    s_barrier
    v_mfma_f32_32x32x16_bf16 v[128:143], v[48:51], v[40:43], v[128:143]
    ds_read_b128 v[16:19], v4 offset:0
    ds_read_b64_tr_b16 v[24:25], v6 offset:16384
    ds_read_b64_tr_b16 v[26:27], v6 offset:17408
    ds_read_b128 v[20:23], v4 offset:4096
    s_add_u32 m0, s32, 0
    s_add_u32 s33, s50, 0x0
    buffer_load_dwordx4 v9, s[12:15], s33 offen lds
    v_mfma_f32_32x32x16_bf16 v[144:159], v[48:51], v[44:47], v[144:159]
    ds_read_b64_tr_b16 v[28:29], v10 offset:16384
    ds_read_b64_tr_b16 v[30:31], v10 offset:17408
    ds_read_b64_tr_b16 v[32:33], v6 offset:24576
    ds_read_b64_tr_b16 v[34:35], v6 offset:25600
    s_add_u32 m0, s32, 8192
    s_add_u32 s33, s50, 0x0
    buffer_load_dwordx4 v9, s[16:19], s33 offen lds
    v_mfma_f32_32x32x16_bf16 v[160:175], v[52:55], v[40:43], v[160:175]
    ds_read_b64_tr_b16 v[36:37], v10 offset:24576
    ds_read_b64_tr_b16 v[38:39], v10 offset:25600
    ds_read_b64_tr_b16 v[48:49], v72 offset:16384
    ds_read_b64_tr_b16 v[50:51], v72 offset:17408
    s_add_u32 m0, s32, 1024
    s_add_u32 s33, s50, 0x3800
    buffer_load_dwordx4 v9, s[12:15], s33 offen lds
    v_mfma_f32_32x32x16_bf16 v[176:191], v[52:55], v[44:47], v[176:191]
    ds_read_b64_tr_b16 v[52:53], v73 offset:16384
    ds_read_b64_tr_b16 v[54:55], v73 offset:17408
    s_add_u32 m0, s32, 9216
    s_add_u32 s33, s50, 0x3800
    buffer_load_dwordx4 v9, s[16:19], s33 offen lds
    s_add_u32 s50, s50, 114688
    s_cmp_ge_u32 s50, 1835008
    s_cselect_b32 s52, 1835008, 0
    s_sub_u32 s50, s50, s52
    v_mfma_f32_32x32x16_bf16 v[192:207], v[56:59], v[40:43], v[192:207]
    v_mfma_f32_32x32x16_bf16 v[208:223], v[56:59], v[44:47], v[208:223]
    ds_read_b64_tr_b16 v[56:57], v72 offset:24576
    ds_read_b64_tr_b16 v[58:59], v72 offset:25600
    v_mfma_f32_32x32x16_bf16 v[224:239], v[60:63], v[40:43], v[224:239]
    ds_read_b128 v[40:43], v5 offset:0
    v_mfma_f32_32x32x16_bf16 v[240:255], v[60:63], v[44:47], v[240:255]
    ds_read_b128 v[44:47], v5 offset:4096
    ds_read_b64_tr_b16 v[60:61], v73 offset:24576
    ds_read_b64_tr_b16 v[62:63], v73 offset:25600
    s_waitcnt lgkmcnt(15)
    v_mfma_f32_32x32x16_bf16 v[128:143], v[24:27], v[16:19], v[128:143]
    v_mfma_f32_32x32x16_bf16 v[144:159], v[24:27], v[20:23], v[144:159]
    s_waitcnt lgkmcnt(14)
    v_mfma_f32_32x32x16_bf16 v[160:175], v[28:31], v[16:19], v[160:175]
    v_mfma_f32_32x32x16_bf16 v[176:191], v[28:31], v[20:23], v[176:191]
    s_waitcnt lgkmcnt(12)
    v_mfma_f32_32x32x16_bf16 v[192:207], v[32:35], v[16:19], v[192:207]
    v_mfma_f32_32x32x16_bf16 v[208:223], v[32:35], v[20:23], v[208:223]
    s_waitcnt lgkmcnt(10)
    v_mfma_f32_32x32x16_bf16 v[224:239], v[36:39], v[16:19], v[224:239]
    v_mfma_f32_32x32x16_bf16 v[240:255], v[36:39], v[20:23], v[240:255]
    s_waitcnt vmcnt(4)
    s_waitcnt lgkmcnt(0)
    s_barrier
    v_mfma_f32_32x32x16_bf16 v[128:143], v[48:51], v[40:43], v[128:143]
    ds_read_b128 v[16:19], v2 offset:16384
    ds_read_b64_tr_b16 v[24:25], v6 offset:32768
    ds_read_b64_tr_b16 v[26:27], v6 offset:33792
    ds_read_b128 v[20:23], v2 offset:20480
    s_add_u32 m0, s32, 16384
    s_add_u32 s33, s50, 0x0
    buffer_load_dwordx4 v9, s[12:15], s33 offen lds
    v_mfma_f32_32x32x16_bf16 v[144:159], v[48:51], v[44:47], v[144:159]
    ds_read_b64_tr_b16 v[28:29], v10 offset:32768
    ds_read_b64_tr_b16 v[30:31], v10 offset:33792
    ds_read_b64_tr_b16 v[32:33], v6 offset:40960
    ds_read_b64_tr_b16 v[34:35], v6 offset:41984
    s_add_u32 m0, s32, 24576
    s_add_u32 s33, s50, 0x0
    buffer_load_dwordx4 v9, s[16:19], s33 offen lds
    v_mfma_f32_32x32x16_bf16 v[160:175], v[52:55], v[40:43], v[160:175]
    ds_read_b64_tr_b16 v[36:37], v10 offset:40960
    ds_read_b64_tr_b16 v[38:39], v10 offset:41984
    ds_read_b64_tr_b16 v[48:49], v72 offset:32768
    ds_read_b64_tr_b16 v[50:51], v72 offset:33792
    s_add_u32 m0, s32, 17408
    s_add_u32 s33, s50, 0x3800
    buffer_load_dwordx4 v9, s[12:15], s33 offen lds
    v_mfma_f32_32x32x16_bf16 v[176:191], v[52:55], v[44:47], v[176:191]
    ds_read_b64_tr_b16 v[52:53], v73 offset:32768
    ds_read_b64_tr_b16 v[54:55], v73 offset:33792
    s_add_u32 m0, s32, 25600
    s_add_u32 s33, s50, 0x3800
    buffer_load_dwordx4 v9, s[16:19], s33 offen lds
    s_add_u32 s50, s50, 114688
    s_cmp_ge_u32 s50, 1835008
    s_cselect_b32 s52, 1835008, 0
    s_sub_u32 s50, s50, s52
    v_mfma_f32_32x32x16_bf16 v[192:207], v[56:59], v[40:43], v[192:207]
    s_add_u32 m0, s31, 0
    s_add_u32 s33, s51, 0x0
    buffer_load_dwordx4 v7, s[8:11], s33 offen lds
    v_mfma_f32_32x32x16_bf16 v[208:223], v[56:59], v[44:47], v[208:223]
    ds_read_b64_tr_b16 v[56:57], v72 offset:40960
    ds_read_b64_tr_b16 v[58:59], v72 offset:41984
    s_add_u32 m0, s31, 1024
    s_add_u32 s33, s51, 0x0
    buffer_load_dwordx4 v8, s[8:11], s33 offen lds
    v_mfma_f32_32x32x16_bf16 v[224:239], v[60:63], v[40:43], v[224:239]
    ds_read_b128 v[40:43], v3 offset:16384
    s_add_u32 m0, s31, 2048
    s_add_u32 s33, s51, 0x4000
    buffer_load_dwordx4 v7, s[8:11], s33 offen lds
    v_mfma_f32_32x32x16_bf16 v[240:255], v[60:63], v[44:47], v[240:255]
    ds_read_b128 v[44:47], v3 offset:20480
    ds_read_b64_tr_b16 v[60:61], v73 offset:40960
    ds_read_b64_tr_b16 v[62:63], v73 offset:41984
    s_add_u32 m0, s31, 3072
    s_add_u32 s33, s51, 0x4000
    buffer_load_dwordx4 v8, s[8:11], s33 offen lds
    s_add_u32 s51, s51, 128
    s_and_b32 s51, s51, 1023
    s_waitcnt lgkmcnt(15)
    v_mfma_f32_32x32x16_bf16 v[128:143], v[24:27], v[16:19], v[128:143]
    v_mfma_f32_32x32x16_bf16 v[144:159], v[24:27], v[20:23], v[144:159]
    s_waitcnt lgkmcnt(14)
    v_mfma_f32_32x32x16_bf16 v[160:175], v[28:31], v[16:19], v[160:175]
    v_mfma_f32_32x32x16_bf16 v[176:191], v[28:31], v[20:23], v[176:191]
    s_waitcnt lgkmcnt(12)
    v_mfma_f32_32x32x16_bf16 v[192:207], v[32:35], v[16:19], v[192:207]
    v_mfma_f32_32x32x16_bf16 v[208:223], v[32:35], v[20:23], v[208:223]
    s_waitcnt lgkmcnt(10)
    v_mfma_f32_32x32x16_bf16 v[224:239], v[36:39], v[16:19], v[224:239]
    v_mfma_f32_32x32x16_bf16 v[240:255], v[36:39], v[20:23], v[240:255]
    s_waitcnt vmcnt(8)
    s_waitcnt lgkmcnt(0)
    s_barrier
    v_mfma_f32_32x32x16_bf16 v[128:143], v[48:51], v[40:43], v[128:143]
    ds_read_b128 v[16:19], v4 offset:16384
    ds_read_b64_tr_b16 v[24:25], v6 offset:0
    ds_read_b64_tr_b16 v[26:27], v6 offset:1024
    ds_read_b128 v[20:23], v4 offset:20480
    s_add_u32 m0, s32, 32768
    s_add_u32 s33, s50, 0x0
    buffer_load_dwordx4 v9, s[12:15], s33 offen lds
    v_mfma_f32_32x32x16_bf16 v[144:159], v[48:51], v[44:47], v[144:159]
    ds_read_b64_tr_b16 v[28:29], v10 offset:0
    ds_read_b64_tr_b16 v[30:31], v10 offset:1024
    ds_read_b64_tr_b16 v[32:33], v6 offset:8192
    ds_read_b64_tr_b16 v[34:35], v6 offset:9216
    s_add_u32 m0, s32, 40960
    s_add_u32 s33, s50, 0x0
    buffer_load_dwordx4 v9, s[16:19], s33 offen lds
    v_mfma_f32_32x32x16_bf16 v[160:175], v[52:55], v[40:43], v[160:175]
    ds_read_b64_tr_b16 v[36:37], v10 offset:8192
    ds_read_b64_tr_b16 v[38:39], v10 offset:9216
    ds_read_b64_tr_b16 v[48:49], v72 offset:0
    ds_read_b64_tr_b16 v[50:51], v72 offset:1024
    s_add_u32 m0, s32, 33792
    s_add_u32 s33, s50, 0x3800
    buffer_load_dwordx4 v9, s[12:15], s33 offen lds
    v_mfma_f32_32x32x16_bf16 v[176:191], v[52:55], v[44:47], v[176:191]
    ds_read_b64_tr_b16 v[52:53], v73 offset:0
    ds_read_b64_tr_b16 v[54:55], v73 offset:1024
    s_add_u32 m0, s32, 41984
    s_add_u32 s33, s50, 0x3800
    buffer_load_dwordx4 v9, s[16:19], s33 offen lds
    s_add_u32 s50, s50, 114688
    s_cmp_ge_u32 s50, 1835008
    s_cselect_b32 s52, 1835008, 0
    s_sub_u32 s50, s50, s52
    v_mfma_f32_32x32x16_bf16 v[192:207], v[56:59], v[40:43], v[192:207]
    v_mfma_f32_32x32x16_bf16 v[208:223], v[56:59], v[44:47], v[208:223]
    ds_read_b64_tr_b16 v[56:57], v72 offset:8192
    ds_read_b64_tr_b16 v[58:59], v72 offset:9216
    v_mfma_f32_32x32x16_bf16 v[224:239], v[60:63], v[40:43], v[224:239]
    ds_read_b128 v[40:43], v5 offset:16384
    v_mfma_f32_32x32x16_bf16 v[240:255], v[60:63], v[44:47], v[240:255]
    ds_read_b128 v[44:47], v5 offset:20480
    ds_read_b64_tr_b16 v[60:61], v73 offset:8192
    ds_read_b64_tr_b16 v[62:63], v73 offset:9216
    s_waitcnt lgkmcnt(15)
    v_mfma_f32_32x32x16_bf16 v[128:143], v[24:27], v[16:19], v[128:143]
    v_mfma_f32_32x32x16_bf16 v[144:159], v[24:27], v[20:23], v[144:159]
    s_waitcnt lgkmcnt(14)
    v_mfma_f32_32x32x16_bf16 v[160:175], v[28:31], v[16:19], v[160:175]
    v_mfma_f32_32x32x16_bf16 v[176:191], v[28:31], v[20:23], v[176:191]
    s_waitcnt lgkmcnt(12)
    v_mfma_f32_32x32x16_bf16 v[192:207], v[32:35], v[16:19], v[192:207]
    v_mfma_f32_32x32x16_bf16 v[208:223], v[32:35], v[20:23], v[208:223]
    s_waitcnt lgkmcnt(10)
    v_mfma_f32_32x32x16_bf16 v[224:239], v[36:39], v[16:19], v[224:239]
    v_mfma_f32_32x32x16_bf16 v[240:255], v[36:39], v[20:23], v[240:255]
    s_waitcnt vmcnt(4)
    s_waitcnt lgkmcnt(0)
    s_barrier
    v_mfma_f32_32x32x16_bf16 v[128:143], v[48:51], v[40:43], v[128:143]
    ds_read_b128 v[16:19], v2 offset:0
    ds_read_b64_tr_b16 v[24:25], v6 offset:16384
    ds_read_b64_tr_b16 v[26:27], v6 offset:17408
    ds_read_b128 v[20:23], v2 offset:4096
    s_add_u32 m0, s32, 0
    s_add_u32 s33, s50, 0x0
    buffer_load_dwordx4 v9, s[12:15], s33 offen lds
    v_mfma_f32_32x32x16_bf16 v[144:159], v[48:51], v[44:47], v[144:159]
    ds_read_b64_tr_b16 v[28:29], v10 offset:16384
    ds_read_b64_tr_b16 v[30:31], v10 offset:17408
    ds_read_b64_tr_b16 v[32:33], v6 offset:24576
    ds_read_b64_tr_b16 v[34:35], v6 offset:25600
    s_add_u32 m0, s32, 8192
    s_add_u32 s33, s50, 0x0
    buffer_load_dwordx4 v9, s[16:19], s33 offen lds
    v_mfma_f32_32x32x16_bf16 v[160:175], v[52:55], v[40:43], v[160:175]
    ds_read_b64_tr_b16 v[36:37], v10 offset:24576
    ds_read_b64_tr_b16 v[38:39], v10 offset:25600
    ds_read_b64_tr_b16 v[48:49], v72 offset:16384
    ds_read_b64_tr_b16 v[50:51], v72 offset:17408
    s_add_u32 m0, s32, 1024
    s_add_u32 s33, s50, 0x3800
    buffer_load_dwordx4 v9, s[12:15], s33 offen lds
    v_mfma_f32_32x32x16_bf16 v[176:191], v[52:55], v[44:47], v[176:191]
    ds_read_b64_tr_b16 v[52:53], v73 offset:16384
    ds_read_b64_tr_b16 v[54:55], v73 offset:17408
    s_add_u32 m0, s32, 9216
    s_add_u32 s33, s50, 0x3800
    buffer_load_dwordx4 v9, s[16:19], s33 offen lds
    s_add_u32 s50, s50, 114688
    s_cmp_ge_u32 s50, 1835008
    s_cselect_b32 s52, 1835008, 0
    s_sub_u32 s50, s50, s52
    v_mfma_f32_32x32x16_bf16 v[192:207], v[56:59], v[40:43], v[192:207]
    s_add_u32 m0, s31, 16384
    s_add_u32 s33, s51, 0x0
    buffer_load_dwordx4 v7, s[8:11], s33 offen lds
    v_mfma_f32_32x32x16_bf16 v[208:223], v[56:59], v[44:47], v[208:223]
    ds_read_b64_tr_b16 v[56:57], v72 offset:24576
    ds_read_b64_tr_b16 v[58:59], v72 offset:25600
    s_add_u32 m0, s31, 17408
    s_add_u32 s33, s51, 0x0
    buffer_load_dwordx4 v8, s[8:11], s33 offen lds
    v_mfma_f32_32x32x16_bf16 v[224:239], v[60:63], v[40:43], v[224:239]
    ds_read_b128 v[40:43], v3 offset:0
    s_add_u32 m0, s31, 18432
    s_add_u32 s33, s51, 0x4000
    buffer_load_dwordx4 v7, s[8:11], s33 offen lds
    v_mfma_f32_32x32x16_bf16 v[240:255], v[60:63], v[44:47], v[240:255]
    ds_read_b128 v[44:47], v3 offset:4096
    ds_read_b64_tr_b16 v[60:61], v73 offset:24576
    ds_read_b64_tr_b16 v[62:63], v73 offset:25600
    s_add_u32 m0, s31, 19456
    s_add_u32 s33, s51, 0x4000
    buffer_load_dwordx4 v8, s[8:11], s33 offen lds
    s_add_u32 s51, s51, 128
    s_and_b32 s51, s51, 1023
    s_waitcnt lgkmcnt(15)
    v_mfma_f32_32x32x16_bf16 v[128:143], v[24:27], v[16:19], v[128:143]
    v_mfma_f32_32x32x16_bf16 v[144:159], v[24:27], v[20:23], v[144:159]
    s_waitcnt lgkmcnt(14)
    v_mfma_f32_32x32x16_bf16 v[160:175], v[28:31], v[16:19], v[160:175]
    v_mfma_f32_32x32x16_bf16 v[176:191], v[28:31], v[20:23], v[176:191]
    s_waitcnt lgkmcnt(12)
    v_mfma_f32_32x32x16_bf16 v[192:207], v[32:35], v[16:19], v[192:207]
    v_mfma_f32_32x32x16_bf16 v[208:223], v[32:35], v[20:23], v[208:223]
    s_waitcnt lgkmcnt(10)
    v_mfma_f32_32x32x16_bf16 v[224:239], v[36:39], v[16:19], v[224:239]
    v_mfma_f32_32x32x16_bf16 v[240:255], v[36:39], v[20:23], v[240:255]
    s_waitcnt vmcnt(8)
    s_waitcnt lgkmcnt(0)
    s_barrier
    v_mfma_f32_32x32x16_bf16 v[128:143], v[48:51], v[40:43], v[128:143]
    ds_read_b128 v[16:19], v4 offset:0
    ds_read_b64_tr_b16 v[24:25], v6 offset:32768
    ds_read_b64_tr_b16 v[26:27], v6 offset:33792
    ds_read_b128 v[20:23], v4 offset:4096
    s_add_u32 m0, s32, 16384
    s_add_u32 s33, s50, 0x0
    buffer_load_dwordx4 v9, s[12:15], s33 offen lds
    v_mfma_f32_32x32x16_bf16 v[144:159], v[48:51], v[44:47], v[144:159]
    ds_read_b64_tr_b16 v[28:29], v10 offset:32768
    ds_read_b64_tr_b16 v[30:31], v10 offset:33792
    ds_read_b64_tr_b16 v[32:33], v6 offset:40960
    ds_read_b64_tr_b16 v[34:35], v6 offset:41984
    s_add_u32 m0, s32, 24576
    s_add_u32 s33, s50, 0x0
    buffer_load_dwordx4 v9, s[16:19], s33 offen lds
    v_mfma_f32_32x32x16_bf16 v[160:175], v[52:55], v[40:43], v[160:175]
    ds_read_b64_tr_b16 v[36:37], v10 offset:40960
    ds_read_b64_tr_b16 v[38:39], v10 offset:41984
    ds_read_b64_tr_b16 v[48:49], v72 offset:32768
    ds_read_b64_tr_b16 v[50:51], v72 offset:33792
    s_add_u32 m0, s32, 17408
    s_add_u32 s33, s50, 0x3800
    buffer_load_dwordx4 v9, s[12:15], s33 offen lds
    v_mfma_f32_32x32x16_bf16 v[176:191], v[52:55], v[44:47], v[176:191]
    ds_read_b64_tr_b16 v[52:53], v73 offset:32768
    ds_read_b64_tr_b16 v[54:55], v73 offset:33792
    s_add_u32 m0, s32, 25600
    s_add_u32 s33, s50, 0x3800
    buffer_load_dwordx4 v9, s[16:19], s33 offen lds
    s_add_u32 s50, s50, 114688
    s_cmp_ge_u32 s50, 1835008
    s_cselect_b32 s52, 1835008, 0
    s_sub_u32 s50, s50, s52
    v_mfma_f32_32x32x16_bf16 v[192:207], v[56:59], v[40:43], v[192:207]
    v_mfma_f32_32x32x16_bf16 v[208:223], v[56:59], v[44:47], v[208:223]
    ds_read_b64_tr_b16 v[56:57], v72 offset:40960
    ds_read_b64_tr_b16 v[58:59], v72 offset:41984
    v_mfma_f32_32x32x16_bf16 v[224:239], v[60:63], v[40:43], v[224:239]
    ds_read_b128 v[40:43], v5 offset:0
    v_mfma_f32_32x32x16_bf16 v[240:255], v[60:63], v[44:47], v[240:255]
    ds_read_b128 v[44:47], v5 offset:4096
    ds_read_b64_tr_b16 v[60:61], v73 offset:40960
    ds_read_b64_tr_b16 v[62:63], v73 offset:41984
    s_waitcnt lgkmcnt(15)
    v_mfma_f32_32x32x16_bf16 v[128:143], v[24:27], v[16:19], v[128:143]
    v_mfma_f32_32x32x16_bf16 v[144:159], v[24:27], v[20:23], v[144:159]
    s_waitcnt lgkmcnt(14)
    v_mfma_f32_32x32x16_bf16 v[160:175], v[28:31], v[16:19], v[160:175]
    v_mfma_f32_32x32x16_bf16 v[176:191], v[28:31], v[20:23], v[176:191]
    s_waitcnt lgkmcnt(12)
    v_mfma_f32_32x32x16_bf16 v[192:207], v[32:35], v[16:19], v[192:207]
    v_mfma_f32_32x32x16_bf16 v[208:223], v[32:35], v[20:23], v[208:223]
    s_waitcnt lgkmcnt(10)
    v_mfma_f32_32x32x16_bf16 v[224:239], v[36:39], v[16:19], v[224:239]
    v_mfma_f32_32x32x16_bf16 v[240:255], v[36:39], v[20:23], v[240:255]
    s_waitcnt vmcnt(4)
    s_waitcnt lgkmcnt(0)
    s_barrier
    v_mfma_f32_32x32x16_bf16 v[128:143], v[48:51], v[40:43], v[128:143]
    ds_read_b128 v[16:19], v2 offset:16384
    ds_read_b64_tr_b16 v[24:25], v6 offset:0
    ds_read_b64_tr_b16 v[26:27], v6 offset:1024
    ds_read_b128 v[20:23], v2 offset:20480
    s_add_u32 m0, s32, 32768
    s_add_u32 s33, s50, 0x0
    buffer_load_dwordx4 v9, s[12:15], s33 offen lds
    v_mfma_f32_32x32x16_bf16 v[144:159], v[48:51], v[44:47], v[144:159]
    ds_read_b64_tr_b16 v[28:29], v10 offset:0
    ds_read_b64_tr_b16 v[30:31], v10 offset:1024
    ds_read_b64_tr_b16 v[32:33], v6 offset:8192
    ds_read_b64_tr_b16 v[34:35], v6 offset:9216
    s_add_u32 m0, s32, 40960
    s_add_u32 s33, s50, 0x0
    buffer_load_dwordx4 v9, s[16:19], s33 offen lds
    v_mfma_f32_32x32x16_bf16 v[160:175], v[52:55], v[40:43], v[160:175]
    ds_read_b64_tr_b16 v[36:37], v10 offset:8192
    ds_read_b64_tr_b16 v[38:39], v10 offset:9216
    ds_read_b64_tr_b16 v[48:49], v72 offset:0
    ds_read_b64_tr_b16 v[50:51], v72 offset:1024
    s_add_u32 m0, s32, 33792
    s_add_u32 s33, s50, 0x3800
    buffer_load_dwordx4 v9, s[12:15], s33 offen lds
    v_mfma_f32_32x32x16_bf16 v[176:191], v[52:55], v[44:47], v[176:191]
    ds_read_b64_tr_b16 v[52:53], v73 offset:0
    ds_read_b64_tr_b16 v[54:55], v73 offset:1024
    s_add_u32 m0, s32, 41984
    s_add_u32 s33, s50, 0x3800
    buffer_load_dwordx4 v9, s[16:19], s33 offen lds
    s_add_u32 s50, s50, 114688
    s_cmp_ge_u32 s50, 1835008
    s_cselect_b32 s52, 1835008, 0
    s_sub_u32 s50, s50, s52
    v_mfma_f32_32x32x16_bf16 v[192:207], v[56:59], v[40:43], v[192:207]
    s_add_u32 m0, s31, 0
    s_add_u32 s33, s51, 0x0
    buffer_load_dwordx4 v7, s[8:11], s33 offen lds
    v_mfma_f32_32x32x16_bf16 v[208:223], v[56:59], v[44:47], v[208:223]
    ds_read_b64_tr_b16 v[56:57], v72 offset:8192
    ds_read_b64_tr_b16 v[58:59], v72 offset:9216
    s_add_u32 m0, s31, 1024
    s_add_u32 s33, s51, 0x0
    buffer_load_dwordx4 v8, s[8:11], s33 offen lds
    v_mfma_f32_32x32x16_bf16 v[224:239], v[60:63], v[40:43], v[224:239]
    ds_read_b128 v[40:43], v3 offset:16384
    s_add_u32 m0, s31, 2048
    s_add_u32 s33, s51, 0x4000
    buffer_load_dwordx4 v7, s[8:11], s33 offen lds
    v_mfma_f32_32x32x16_bf16 v[240:255], v[60:63], v[44:47], v[240:255]
    ds_read_b128 v[44:47], v3 offset:20480
    ds_read_b64_tr_b16 v[60:61], v73 offset:8192
    ds_read_b64_tr_b16 v[62:63], v73 offset:9216
    s_add_u32 m0, s31, 3072
    s_add_u32 s33, s51, 0x4000
    buffer_load_dwordx4 v8, s[8:11], s33 offen lds
    s_add_u32 s51, s51, 128
    s_and_b32 s51, s51, 1023
    s_waitcnt lgkmcnt(15)
    v_mfma_f32_32x32x16_bf16 v[128:143], v[24:27], v[16:19], v[128:143]
    v_mfma_f32_32x32x16_bf16 v[144:159], v[24:27], v[20:23], v[144:159]
    s_waitcnt lgkmcnt(14)
    v_mfma_f32_32x32x16_bf16 v[160:175], v[28:31], v[16:19], v[160:175]
    v_mfma_f32_32x32x16_bf16 v[176:191], v[28:31], v[20:23], v[176:191]
    s_waitcnt lgkmcnt(12)
    v_mfma_f32_32x32x16_bf16 v[192:207], v[32:35], v[16:19], v[192:207]
    v_mfma_f32_32x32x16_bf16 v[208:223], v[32:35], v[20:23], v[208:223]
    s_waitcnt lgkmcnt(10)
    v_mfma_f32_32x32x16_bf16 v[224:239], v[36:39], v[16:19], v[224:239]
    v_mfma_f32_32x32x16_bf16 v[240:255], v[36:39], v[20:23], v[240:255]
    s_waitcnt vmcnt(8)
    s_waitcnt lgkmcnt(0)
    s_barrier
    v_mfma_f32_32x32x16_bf16 v[128:143], v[48:51], v[40:43], v[128:143]
    ds_read_b128 v[16:19], v4 offset:16384
    ds_read_b64_tr_b16 v[24:25], v6 offset:16384
    ds_read_b64_tr_b16 v[26:27], v6 offset:17408
    ds_read_b128 v[20:23], v4 offset:20480
    s_add_u32 m0, s32, 0
    s_add_u32 s33, s50, 0x0
    buffer_load_dwordx4 v9, s[12:15], s33 offen lds
    v_mfma_f32_32x32x16_bf16 v[144:159], v[48:51], v[44:47], v[144:159]
    ds_read_b64_tr_b16 v[28:29], v10 offset:16384
    ds_read_b64_tr_b16 v[30:31], v10 offset:17408
    ds_read_b64_tr_b16 v[32:33], v6 offset:24576
    ds_read_b64_tr_b16 v[34:35], v6 offset:25600
    s_add_u32 m0, s32, 8192
    s_add_u32 s33, s50, 0x0
    buffer_load_dwordx4 v9, s[16:19], s33 offen lds
    v_mfma_f32_32x32x16_bf16 v[160:175], v[52:55], v[40:43], v[160:175]
    ds_read_b64_tr_b16 v[36:37], v10 offset:24576
    ds_read_b64_tr_b16 v[38:39], v10 offset:25600
    ds_read_b64_tr_b16 v[48:49], v72 offset:16384
    ds_read_b64_tr_b16 v[50:51], v72 offset:17408
    s_add_u32 m0, s32, 1024
    s_add_u32 s33, s50, 0x3800
    buffer_load_dwordx4 v9, s[12:15], s33 offen lds
    v_mfma_f32_32x32x16_bf16 v[176:191], v[52:55], v[44:47], v[176:191]
    ds_read_b64_tr_b16 v[52:53], v73 offset:16384
    ds_read_b64_tr_b16 v[54:55], v73 offset:17408
    s_add_u32 m0, s32, 9216
    s_add_u32 s33, s50, 0x3800
    buffer_load_dwordx4 v9, s[16:19], s33 offen lds
    s_add_u32 s50, s50, 114688
    s_cmp_ge_u32 s50, 1835008
    s_cselect_b32 s52, 1835008, 0
    s_sub_u32 s50, s50, s52
    v_mfma_f32_32x32x16_bf16 v[192:207], v[56:59], v[40:43], v[192:207]
    v_mfma_f32_32x32x16_bf16 v[208:223], v[56:59], v[44:47], v[208:223]
    ds_read_b64_tr_b16 v[56:57], v72 offset:24576
    ds_read_b64_tr_b16 v[58:59], v72 offset:25600
    v_mfma_f32_32x32x16_bf16 v[224:239], v[60:63], v[40:43], v[224:239]
    ds_read_b128 v[40:43], v5 offset:16384
    v_mfma_f32_32x32x16_bf16 v[240:255], v[60:63], v[44:47], v[240:255]
    ds_read_b128 v[44:47], v5 offset:20480
    ds_read_b64_tr_b16 v[60:61], v73 offset:24576
    ds_read_b64_tr_b16 v[62:63], v73 offset:25600
    s_waitcnt lgkmcnt(15)
    v_mfma_f32_32x32x16_bf16 v[128:143], v[24:27], v[16:19], v[128:143]
    v_mfma_f32_32x32x16_bf16 v[144:159], v[24:27], v[20:23], v[144:159]
    s_waitcnt lgkmcnt(14)
    v_mfma_f32_32x32x16_bf16 v[160:175], v[28:31], v[16:19], v[160:175]
    v_mfma_f32_32x32x16_bf16 v[176:191], v[28:31], v[20:23], v[176:191]
    s_waitcnt lgkmcnt(12)
    v_mfma_f32_32x32x16_bf16 v[192:207], v[32:35], v[16:19], v[192:207]
    v_mfma_f32_32x32x16_bf16 v[208:223], v[32:35], v[20:23], v[208:223]
    s_waitcnt lgkmcnt(10)
    v_mfma_f32_32x32x16_bf16 v[224:239], v[36:39], v[16:19], v[224:239]
    v_mfma_f32_32x32x16_bf16 v[240:255], v[36:39], v[20:23], v[240:255]
    s_waitcnt vmcnt(4)
    s_waitcnt lgkmcnt(0)
    s_barrier
    v_mfma_f32_32x32x16_bf16 v[128:143], v[48:51], v[40:43], v[128:143]
    ds_read_b128 v[16:19], v2 offset:0
    ds_read_b64_tr_b16 v[24:25], v6 offset:32768
    ds_read_b64_tr_b16 v[26:27], v6 offset:33792
    ds_read_b128 v[20:23], v2 offset:4096
    s_add_u32 m0, s32, 16384
    s_add_u32 s33, s50, 0x0
    buffer_load_dwordx4 v9, s[12:15], s33 offen lds
    v_mfma_f32_32x32x16_bf16 v[144:159], v[48:51], v[44:47], v[144:159]
    ds_read_b64_tr_b16 v[28:29], v10 offset:32768
    ds_read_b64_tr_b16 v[30:31], v10 offset:33792
    ds_read_b64_tr_b16 v[32:33], v6 offset:40960
    ds_read_b64_tr_b16 v[34:35], v6 offset:41984
    s_add_u32 m0, s32, 24576
    s_add_u32 s33, s50, 0x0
    buffer_load_dwordx4 v9, s[16:19], s33 offen lds
    v_mfma_f32_32x32x16_bf16 v[160:175], v[52:55], v[40:43], v[160:175]
    ds_read_b64_tr_b16 v[36:37], v10 offset:40960
    ds_read_b64_tr_b16 v[38:39], v10 offset:41984
    ds_read_b64_tr_b16 v[48:49], v72 offset:32768
    ds_read_b64_tr_b16 v[50:51], v72 offset:33792
    s_add_u32 m0, s32, 17408
    s_add_u32 s33, s50, 0x3800
    buffer_load_dwordx4 v9, s[12:15], s33 offen lds
    v_mfma_f32_32x32x16_bf16 v[176:191], v[52:55], v[44:47], v[176:191]
    ds_read_b64_tr_b16 v[52:53], v73 offset:32768
    ds_read_b64_tr_b16 v[54:55], v73 offset:33792
    s_add_u32 m0, s32, 25600
    s_add_u32 s33, s50, 0x3800
    buffer_load_dwordx4 v9, s[16:19], s33 offen lds
    s_add_u32 s50, s50, 114688
    s_cmp_ge_u32 s50, 1835008
    s_cselect_b32 s52, 1835008, 0
    s_sub_u32 s50, s50, s52
    v_mfma_f32_32x32x16_bf16 v[192:207], v[56:59], v[40:43], v[192:207]
    s_add_u32 m0, s31, 16384
    s_add_u32 s33, s51, 0x0
    buffer_load_dwordx4 v7, s[8:11], s33 offen lds
    v_mfma_f32_32x32x16_bf16 v[208:223], v[56:59], v[44:47], v[208:223]
    ds_read_b64_tr_b16 v[56:57], v72 offset:40960
    ds_read_b64_tr_b16 v[58:59], v72 offset:41984
    s_add_u32 m0, s31, 17408
    s_add_u32 s33, s51, 0x0
    buffer_load_dwordx4 v8, s[8:11], s33 offen lds
    v_mfma_f32_32x32x16_bf16 v[224:239], v[60:63], v[40:43], v[224:239]
    ds_read_b128 v[40:43], v3 offset:0
    s_add_u32 m0, s31, 18432
    s_add_u32 s33, s51, 0x4000
    buffer_load_dwordx4 v7, s[8:11], s33 offen lds
    v_mfma_f32_32x32x16_bf16 v[240:255], v[60:63], v[44:47], v[240:255]
    ds_read_b128 v[44:47], v3 offset:4096
    ds_read_b64_tr_b16 v[60:61], v73 offset:40960
    ds_read_b64_tr_b16 v[62:63], v73 offset:41984
    s_add_u32 m0, s31, 19456
    s_add_u32 s33, s51, 0x4000
    buffer_load_dwordx4 v8, s[8:11], s33 offen lds
    s_add_u32 s51, s51, 128
    s_and_b32 s51, s51, 1023
    s_waitcnt lgkmcnt(15)
    v_mfma_f32_32x32x16_bf16 v[128:143], v[24:27], v[16:19], v[128:143]
    v_mfma_f32_32x32x16_bf16 v[144:159], v[24:27], v[20:23], v[144:159]
    s_waitcnt lgkmcnt(14)
    v_mfma_f32_32x32x16_bf16 v[160:175], v[28:31], v[16:19], v[160:175]
    v_mfma_f32_32x32x16_bf16 v[176:191], v[28:31], v[20:23], v[176:191]
    s_waitcnt lgkmcnt(12)
    v_mfma_f32_32x32x16_bf16 v[192:207], v[32:35], v[16:19], v[192:207]
    v_mfma_f32_32x32x16_bf16 v[208:223], v[32:35], v[20:23], v[208:223]
    s_waitcnt lgkmcnt(10)
    v_mfma_f32_32x32x16_bf16 v[224:239], v[36:39], v[16:19], v[224:239]
    v_mfma_f32_32x32x16_bf16 v[240:255], v[36:39], v[20:23], v[240:255]
    s_waitcnt vmcnt(8)
    s_waitcnt lgkmcnt(0)
    s_barrier
    v_mfma_f32_32x32x16_bf16 v[128:143], v[48:51], v[40:43], v[128:143]
    ds_read_b128 v[16:19], v4 offset:0
    ds_read_b64_tr_b16 v[24:25], v6 offset:0
    ds_read_b64_tr_b16 v[26:27], v6 offset:1024
    ds_read_b128 v[20:23], v4 offset:4096
    s_add_u32 m0, s32, 32768
    s_add_u32 s33, s50, 0x0
    buffer_load_dwordx4 v9, s[12:15], s33 offen lds
    v_mfma_f32_32x32x16_bf16 v[144:159], v[48:51], v[44:47], v[144:159]
    ds_read_b64_tr_b16 v[28:29], v10 offset:0
    ds_read_b64_tr_b16 v[30:31], v10 offset:1024
    ds_read_b64_tr_b16 v[32:33], v6 offset:8192
    ds_read_b64_tr_b16 v[34:35], v6 offset:9216
    s_add_u32 m0, s32, 40960
    s_add_u32 s33, s50, 0x0
    buffer_load_dwordx4 v9, s[16:19], s33 offen lds
    v_mfma_f32_32x32x16_bf16 v[160:175], v[52:55], v[40:43], v[160:175]
    ds_read_b64_tr_b16 v[36:37], v10 offset:8192
    ds_read_b64_tr_b16 v[38:39], v10 offset:9216
    ds_read_b64_tr_b16 v[48:49], v72 offset:0
    ds_read_b64_tr_b16 v[50:51], v72 offset:1024
    s_add_u32 m0, s32, 33792
    s_add_u32 s33, s50, 0x3800
    buffer_load_dwordx4 v9, s[12:15], s33 offen lds
    v_mfma_f32_32x32x16_bf16 v[176:191], v[52:55], v[44:47], v[176:191]
    ds_read_b64_tr_b16 v[52:53], v73 offset:0
    ds_read_b64_tr_b16 v[54:55], v73 offset:1024
    s_add_u32 m0, s32, 41984
    s_add_u32 s33, s50, 0x3800
    buffer_load_dwordx4 v9, s[16:19], s33 offen lds
    s_add_u32 s50, s50, 114688
    s_cmp_ge_u32 s50, 1835008
    s_cselect_b32 s52, 1835008, 0
    s_sub_u32 s50, s50, s52
    v_mfma_f32_32x32x16_bf16 v[192:207], v[56:59], v[40:43], v[192:207]
    v_mfma_f32_32x32x16_bf16 v[208:223], v[56:59], v[44:47], v[208:223]
    ds_read_b64_tr_b16 v[56:57], v72 offset:8192
    ds_read_b64_tr_b16 v[58:59], v72 offset:9216
    v_mfma_f32_32x32x16_bf16 v[224:239], v[60:63], v[40:43], v[224:239]
    ds_read_b128 v[40:43], v5 offset:0
    v_mfma_f32_32x32x16_bf16 v[240:255], v[60:63], v[44:47], v[240:255]
    ds_read_b128 v[44:47], v5 offset:4096
    ds_read_b64_tr_b16 v[60:61], v73 offset:8192
    ds_read_b64_tr_b16 v[62:63], v73 offset:9216
    s_waitcnt lgkmcnt(15)
    v_mfma_f32_32x32x16_bf16 v[128:143], v[24:27], v[16:19], v[128:143]
    v_mfma_f32_32x32x16_bf16 v[144:159], v[24:27], v[20:23], v[144:159]
    s_waitcnt lgkmcnt(14)
    v_mfma_f32_32x32x16_bf16 v[160:175], v[28:31], v[16:19], v[160:175]
    v_mfma_f32_32x32x16_bf16 v[176:191], v[28:31], v[20:23], v[176:191]
    s_waitcnt lgkmcnt(12)
    v_mfma_f32_32x32x16_bf16 v[192:207], v[32:35], v[16:19], v[192:207]
    v_mfma_f32_32x32x16_bf16 v[208:223], v[32:35], v[20:23], v[208:223]
    s_waitcnt lgkmcnt(10)
    v_mfma_f32_32x32x16_bf16 v[224:239], v[36:39], v[16:19], v[224:239]
    v_mfma_f32_32x32x16_bf16 v[240:255], v[36:39], v[20:23], v[240:255]
    s_waitcnt vmcnt(4)
    s_waitcnt lgkmcnt(0)
    s_barrier
    v_mfma_f32_32x32x16_bf16 v[128:143], v[48:51], v[40:43], v[128:143]
    ds_read_b128 v[16:19], v2 offset:16384
    ds_read_b64_tr_b16 v[24:25], v6 offset:16384
    ds_read_b64_tr_b16 v[26:27], v6 offset:17408
    ds_read_b128 v[20:23], v2 offset:20480
    s_add_u32 m0, s32, 0
    s_add_u32 s33, s50, 0x0
    buffer_load_dwordx4 v9, s[12:15], s33 offen lds
    v_mfma_f32_32x32x16_bf16 v[144:159], v[48:51], v[44:47], v[144:159]
    ds_read_b64_tr_b16 v[28:29], v10 offset:16384
    ds_read_b64_tr_b16 v[30:31], v10 offset:17408
    ds_read_b64_tr_b16 v[32:33], v6 offset:24576
    ds_read_b64_tr_b16 v[34:35], v6 offset:25600
    s_add_u32 m0, s32, 8192
    s_add_u32 s33, s50, 0x0
    buffer_load_dwordx4 v9, s[16:19], s33 offen lds
    v_mfma_f32_32x32x16_bf16 v[160:175], v[52:55], v[40:43], v[160:175]
    ds_read_b64_tr_b16 v[36:37], v10 offset:24576
    ds_read_b64_tr_b16 v[38:39], v10 offset:25600
    ds_read_b64_tr_b16 v[48:49], v72 offset:16384
    ds_read_b64_tr_b16 v[50:51], v72 offset:17408
    s_add_u32 m0, s32, 1024
    s_add_u32 s33, s50, 0x3800
    buffer_load_dwordx4 v9, s[12:15], s33 offen lds
    v_mfma_f32_32x32x16_bf16 v[176:191], v[52:55], v[44:47], v[176:191]
    ds_read_b64_tr_b16 v[52:53], v73 offset:16384
    ds_read_b64_tr_b16 v[54:55], v73 offset:17408
    s_add_u32 m0, s32, 9216
    s_add_u32 s33, s50, 0x3800
    buffer_load_dwordx4 v9, s[16:19], s33 offen lds
    s_add_u32 s50, s50, 114688
    s_cmp_ge_u32 s50, 1835008
    s_cselect_b32 s52, 1835008, 0
    s_sub_u32 s50, s50, s52
    v_mfma_f32_32x32x16_bf16 v[192:207], v[56:59], v[40:43], v[192:207]
    s_add_u32 m0, s31, 0
    s_add_u32 s33, s51, 0x0
    buffer_load_dwordx4 v7, s[8:11], s33 offen lds
    v_mfma_f32_32x32x16_bf16 v[208:223], v[56:59], v[44:47], v[208:223]
    ds_read_b64_tr_b16 v[56:57], v72 offset:24576
    ds_read_b64_tr_b16 v[58:59], v72 offset:25600
    s_add_u32 m0, s31, 1024
    s_add_u32 s33, s51, 0x0
    buffer_load_dwordx4 v8, s[8:11], s33 offen lds
    v_mfma_f32_32x32x16_bf16 v[224:239], v[60:63], v[40:43], v[224:239]
    ds_read_b128 v[40:43], v3 offset:16384
    s_add_u32 m0, s31, 2048
    s_add_u32 s33, s51, 0x4000
    buffer_load_dwordx4 v7, s[8:11], s33 offen lds
    v_mfma_f32_32x32x16_bf16 v[240:255], v[60:63], v[44:47], v[240:255]
    ds_read_b128 v[44:47], v3 offset:20480
    ds_read_b64_tr_b16 v[60:61], v73 offset:24576
    ds_read_b64_tr_b16 v[62:63], v73 offset:25600
    s_add_u32 m0, s31, 3072
    s_add_u32 s33, s51, 0x4000
    buffer_load_dwordx4 v8, s[8:11], s33 offen lds
    s_add_u32 s51, s51, 128
    s_and_b32 s51, s51, 1023
    s_waitcnt lgkmcnt(15)
    v_mfma_f32_32x32x16_bf16 v[128:143], v[24:27], v[16:19], v[128:143]
    v_mfma_f32_32x32x16_bf16 v[144:159], v[24:27], v[20:23], v[144:159]
    s_waitcnt lgkmcnt(14)
    v_mfma_f32_32x32x16_bf16 v[160:175], v[28:31], v[16:19], v[160:175]
    v_mfma_f32_32x32x16_bf16 v[176:191], v[28:31], v[20:23], v[176:191]
    s_waitcnt lgkmcnt(12)
    v_mfma_f32_32x32x16_bf16 v[192:207], v[32:35], v[16:19], v[192:207]
    v_mfma_f32_32x32x16_bf16 v[208:223], v[32:35], v[20:23], v[208:223]
    s_waitcnt lgkmcnt(10)
    v_mfma_f32_32x32x16_bf16 v[224:239], v[36:39], v[16:19], v[224:239]
    v_mfma_f32_32x32x16_bf16 v[240:255], v[36:39], v[20:23], v[240:255]
    s_waitcnt vmcnt(8)
    s_waitcnt lgkmcnt(0)
    s_barrier
    v_mfma_f32_32x32x16_bf16 v[128:143], v[48:51], v[40:43], v[128:143]
    ds_read_b128 v[16:19], v4 offset:16384
    ds_read_b64_tr_b16 v[24:25], v6 offset:32768
    ds_read_b64_tr_b16 v[26:27], v6 offset:33792
    ds_read_b128 v[20:23], v4 offset:20480
    s_add_u32 m0, s32, 16384
    s_add_u32 s33, s50, 0x0
    buffer_load_dwordx4 v9, s[12:15], s33 offen lds
    v_mfma_f32_32x32x16_bf16 v[144:159], v[48:51], v[44:47], v[144:159]
    ds_read_b64_tr_b16 v[28:29], v10 offset:32768
    ds_read_b64_tr_b16 v[30:31], v10 offset:33792
    ds_read_b64_tr_b16 v[32:33], v6 offset:40960
    ds_read_b64_tr_b16 v[34:35], v6 offset:41984
    s_add_u32 m0, s32, 24576
    s_add_u32 s33, s50, 0x0
    buffer_load_dwordx4 v9, s[16:19], s33 offen lds
    v_mfma_f32_32x32x16_bf16 v[160:175], v[52:55], v[40:43], v[160:175]
    ds_read_b64_tr_b16 v[36:37], v10 offset:40960
    ds_read_b64_tr_b16 v[38:39], v10 offset:41984
    ds_read_b64_tr_b16 v[48:49], v72 offset:32768
    ds_read_b64_tr_b16 v[50:51], v72 offset:33792
    s_add_u32 m0, s32, 17408
    s_add_u32 s33, s50, 0x3800
    buffer_load_dwordx4 v9, s[12:15], s33 offen lds
    v_mfma_f32_32x32x16_bf16 v[176:191], v[52:55], v[44:47], v[176:191]
    ds_read_b64_tr_b16 v[52:53], v73 offset:32768
    ds_read_b64_tr_b16 v[54:55], v73 offset:33792
    s_add_u32 m0, s32, 25600
    s_add_u32 s33, s50, 0x3800
    buffer_load_dwordx4 v9, s[16:19], s33 offen lds
    s_add_u32 s50, s50, 114688
    s_cmp_ge_u32 s50, 1835008
    s_cselect_b32 s52, 1835008, 0
    s_sub_u32 s50, s50, s52
    v_mfma_f32_32x32x16_bf16 v[192:207], v[56:59], v[40:43], v[192:207]
    v_mfma_f32_32x32x16_bf16 v[208:223], v[56:59], v[44:47], v[208:223]
    ds_read_b64_tr_b16 v[56:57], v72 offset:40960
    ds_read_b64_tr_b16 v[58:59], v72 offset:41984
    v_mfma_f32_32x32x16_bf16 v[224:239], v[60:63], v[40:43], v[224:239]
    ds_read_b128 v[40:43], v5 offset:16384
    v_mfma_f32_32x32x16_bf16 v[240:255], v[60:63], v[44:47], v[240:255]
    ds_read_b128 v[44:47], v5 offset:20480
    ds_read_b64_tr_b16 v[60:61], v73 offset:40960
    ds_read_b64_tr_b16 v[62:63], v73 offset:41984
    s_waitcnt lgkmcnt(15)
    v_mfma_f32_32x32x16_bf16 v[128:143], v[24:27], v[16:19], v[128:143]
    v_mfma_f32_32x32x16_bf16 v[144:159], v[24:27], v[20:23], v[144:159]
    s_waitcnt lgkmcnt(14)
    v_mfma_f32_32x32x16_bf16 v[160:175], v[28:31], v[16:19], v[160:175]
    v_mfma_f32_32x32x16_bf16 v[176:191], v[28:31], v[20:23], v[176:191]
    s_waitcnt lgkmcnt(12)
    v_mfma_f32_32x32x16_bf16 v[192:207], v[32:35], v[16:19], v[192:207]
    v_mfma_f32_32x32x16_bf16 v[208:223], v[32:35], v[20:23], v[208:223]
    s_waitcnt lgkmcnt(10)
    v_mfma_f32_32x32x16_bf16 v[224:239], v[36:39], v[16:19], v[224:239]
    v_mfma_f32_32x32x16_bf16 v[240:255], v[36:39], v[20:23], v[240:255]
    s_waitcnt vmcnt(4)
    s_waitcnt lgkmcnt(0)
    s_barrier
    v_mfma_f32_32x32x16_bf16 v[128:143], v[48:51], v[40:43], v[128:143]
    ds_read_b128 v[16:19], v2 offset:0
    ds_read_b64_tr_b16 v[24:25], v6 offset:0
    ds_read_b64_tr_b16 v[26:27], v6 offset:1024
    ds_read_b128 v[20:23], v2 offset:4096
    s_add_u32 m0, s32, 32768
    s_add_u32 s33, s50, 0x0
    buffer_load_dwordx4 v9, s[12:15], s33 offen lds
    v_mfma_f32_32x32x16_bf16 v[144:159], v[48:51], v[44:47], v[144:159]
    ds_read_b64_tr_b16 v[28:29], v10 offset:0
    ds_read_b64_tr_b16 v[30:31], v10 offset:1024
    ds_read_b64_tr_b16 v[32:33], v6 offset:8192
    ds_read_b64_tr_b16 v[34:35], v6 offset:9216
    s_add_u32 m0, s32, 40960
    s_add_u32 s33, s50, 0x0
    buffer_load_dwordx4 v9, s[16:19], s33 offen lds
    v_mfma_f32_32x32x16_bf16 v[160:175], v[52:55], v[40:43], v[160:175]
    ds_read_b64_tr_b16 v[36:37], v10 offset:8192
    ds_read_b64_tr_b16 v[38:39], v10 offset:9216
    ds_read_b64_tr_b16 v[48:49], v72 offset:0
    ds_read_b64_tr_b16 v[50:51], v72 offset:1024
    s_add_u32 m0, s32, 33792
    s_add_u32 s33, s50, 0x3800
    buffer_load_dwordx4 v9, s[12:15], s33 offen lds
    v_mfma_f32_32x32x16_bf16 v[176:191], v[52:55], v[44:47], v[176:191]
    ds_read_b64_tr_b16 v[52:53], v73 offset:0
    ds_read_b64_tr_b16 v[54:55], v73 offset:1024
    s_add_u32 m0, s32, 41984
    s_add_u32 s33, s50, 0x3800
    buffer_load_dwordx4 v9, s[16:19], s33 offen lds
    s_add_u32 s50, s50, 114688
    s_cmp_ge_u32 s50, 1835008
    s_cselect_b32 s52, 1835008, 0
    s_sub_u32 s50, s50, s52
    v_mfma_f32_32x32x16_bf16 v[192:207], v[56:59], v[40:43], v[192:207]
    s_add_u32 m0, s31, 16384
    s_add_u32 s33, s51, 0x0
    buffer_load_dwordx4 v7, s[8:11], s33 offen lds
    v_mfma_f32_32x32x16_bf16 v[208:223], v[56:59], v[44:47], v[208:223]
    ds_read_b64_tr_b16 v[56:57], v72 offset:8192
    ds_read_b64_tr_b16 v[58:59], v72 offset:9216
    s_add_u32 m0, s31, 17408
    s_add_u32 s33, s51, 0x0
    buffer_load_dwordx4 v8, s[8:11], s33 offen lds
    v_mfma_f32_32x32x16_bf16 v[224:239], v[60:63], v[40:43], v[224:239]
    ds_read_b128 v[40:43], v3 offset:0
    s_add_u32 m0, s31, 18432
    s_add_u32 s33, s51, 0x4000
    buffer_load_dwordx4 v7, s[8:11], s33 offen lds
    v_mfma_f32_32x32x16_bf16 v[240:255], v[60:63], v[44:47], v[240:255]
    ds_read_b128 v[44:47], v3 offset:4096
    ds_read_b64_tr_b16 v[60:61], v73 offset:8192
    ds_read_b64_tr_b16 v[62:63], v73 offset:9216
    s_add_u32 m0, s31, 19456
    s_add_u32 s33, s51, 0x4000
    buffer_load_dwordx4 v8, s[8:11], s33 offen lds
    s_add_u32 s51, s51, 128
    s_and_b32 s51, s51, 1023
    s_waitcnt lgkmcnt(15)
    v_mfma_f32_32x32x16_bf16 v[128:143], v[24:27], v[16:19], v[128:143]
    v_mfma_f32_32x32x16_bf16 v[144:159], v[24:27], v[20:23], v[144:159]
    s_waitcnt lgkmcnt(14)
    v_mfma_f32_32x32x16_bf16 v[160:175], v[28:31], v[16:19], v[160:175]
    v_mfma_f32_32x32x16_bf16 v[176:191], v[28:31], v[20:23], v[176:191]
    s_waitcnt lgkmcnt(12)
    v_mfma_f32_32x32x16_bf16 v[192:207], v[32:35], v[16:19], v[192:207]
    v_mfma_f32_32x32x16_bf16 v[208:223], v[32:35], v[20:23], v[208:223]
    s_waitcnt lgkmcnt(10)
    v_mfma_f32_32x32x16_bf16 v[224:239], v[36:39], v[16:19], v[224:239]
    v_mfma_f32_32x32x16_bf16 v[240:255], v[36:39], v[20:23], v[240:255]
    s_waitcnt vmcnt(8)
    s_waitcnt lgkmcnt(0)
    s_barrier
    v_mfma_f32_32x32x16_bf16 v[128:143], v[48:51], v[40:43], v[128:143]
    ds_read_b128 v[16:19], v4 offset:0
    ds_read_b64_tr_b16 v[24:25], v6 offset:16384
    ds_read_b64_tr_b16 v[26:27], v6 offset:17408
    ds_read_b128 v[20:23], v4 offset:4096
    s_add_u32 m0, s32, 0
    s_add_u32 s33, s50, 0x0
    buffer_load_dwordx4 v9, s[12:15], s33 offen lds
    v_mfma_f32_32x32x16_bf16 v[144:159], v[48:51], v[44:47], v[144:159]
    ds_read_b64_tr_b16 v[28:29], v10 offset:16384
    ds_read_b64_tr_b16 v[30:31], v10 offset:17408
    ds_read_b64_tr_b16 v[32:33], v6 offset:24576
    ds_read_b64_tr_b16 v[34:35], v6 offset:25600
    s_add_u32 m0, s32, 8192
    s_add_u32 s33, s50, 0x0
    buffer_load_dwordx4 v9, s[16:19], s33 offen lds
    v_mfma_f32_32x32x16_bf16 v[160:175], v[52:55], v[40:43], v[160:175]
    ds_read_b64_tr_b16 v[36:37], v10 offset:24576
    ds_read_b64_tr_b16 v[38:39], v10 offset:25600
    ds_read_b64_tr_b16 v[48:49], v72 offset:16384
    ds_read_b64_tr_b16 v[50:51], v72 offset:17408
    s_add_u32 m0, s32, 1024
    s_add_u32 s33, s50, 0x3800
    buffer_load_dwordx4 v9, s[12:15], s33 offen lds
    v_mfma_f32_32x32x16_bf16 v[176:191], v[52:55], v[44:47], v[176:191]
    ds_read_b64_tr_b16 v[52:53], v73 offset:16384
    ds_read_b64_tr_b16 v[54:55], v73 offset:17408
    s_add_u32 m0, s32, 9216
    s_add_u32 s33, s50, 0x3800
    buffer_load_dwordx4 v9, s[16:19], s33 offen lds
    s_add_u32 s50, s50, 114688
    s_cmp_ge_u32 s50, 1835008
    s_cselect_b32 s52, 1835008, 0
    s_sub_u32 s50, s50, s52
    v_mfma_f32_32x32x16_bf16 v[192:207], v[56:59], v[40:43], v[192:207]
    v_mfma_f32_32x32x16_bf16 v[208:223], v[56:59], v[44:47], v[208:223]
    ds_read_b64_tr_b16 v[56:57], v72 offset:24576
    ds_read_b64_tr_b16 v[58:59], v72 offset:25600
    v_mfma_f32_32x32x16_bf16 v[224:239], v[60:63], v[40:43], v[224:239]
    ds_read_b128 v[40:43], v5 offset:0
    v_mfma_f32_32x32x16_bf16 v[240:255], v[60:63], v[44:47], v[240:255]
    ds_read_b128 v[44:47], v5 offset:4096
    ds_read_b64_tr_b16 v[60:61], v73 offset:24576
    ds_read_b64_tr_b16 v[62:63], v73 offset:25600
    s_waitcnt lgkmcnt(15)
    v_mfma_f32_32x32x16_bf16 v[128:143], v[24:27], v[16:19], v[128:143]
    v_mfma_f32_32x32x16_bf16 v[144:159], v[24:27], v[20:23], v[144:159]
    s_waitcnt lgkmcnt(14)
    v_mfma_f32_32x32x16_bf16 v[160:175], v[28:31], v[16:19], v[160:175]
    v_mfma_f32_32x32x16_bf16 v[176:191], v[28:31], v[20:23], v[176:191]
    s_waitcnt lgkmcnt(12)
    v_mfma_f32_32x32x16_bf16 v[192:207], v[32:35], v[16:19], v[192:207]
    v_mfma_f32_32x32x16_bf16 v[208:223], v[32:35], v[20:23], v[208:223]
    s_waitcnt lgkmcnt(10)
    v_mfma_f32_32x32x16_bf16 v[224:239], v[36:39], v[16:19], v[224:239]
    v_mfma_f32_32x32x16_bf16 v[240:255], v[36:39], v[20:23], v[240:255]
    v_mov_b32 v114, 0
    global_load_dwordx2 v[112:113], v114, s[56:57] sc1
    s_waitcnt vmcnt(5)
    s_waitcnt lgkmcnt(0)
    s_barrier
    v_mfma_f32_32x32x16_bf16 v[128:143], v[48:51], v[40:43], v[128:143]
    ds_read_b128 v[16:19], v2 offset:16384
    ds_read_b64_tr_b16 v[24:25], v6 offset:32768
    ds_read_b64_tr_b16 v[26:27], v6 offset:33792
    ds_read_b128 v[20:23], v2 offset:20480
    v_mfma_f32_32x32x16_bf16 v[144:159], v[48:51], v[44:47], v[144:159]
    ds_read_b64_tr_b16 v[28:29], v10 offset:32768
    ds_read_b64_tr_b16 v[30:31], v10 offset:33792
    ds_read_b64_tr_b16 v[32:33], v6 offset:40960
    ds_read_b64_tr_b16 v[34:35], v6 offset:41984
    v_mfma_f32_32x32x16_bf16 v[160:175], v[52:55], v[40:43], v[160:175]
    ds_read_b64_tr_b16 v[36:37], v10 offset:40960
    ds_read_b64_tr_b16 v[38:39], v10 offset:41984
    ds_read_b64_tr_b16 v[48:49], v72 offset:32768
    ds_read_b64_tr_b16 v[50:51], v72 offset:33792
    v_mfma_f32_32x32x16_bf16 v[176:191], v[52:55], v[44:47], v[176:191]
    ds_read_b64_tr_b16 v[52:53], v73 offset:32768
    ds_read_b64_tr_b16 v[54:55], v73 offset:33792
    v_mfma_f32_32x32x16_bf16 v[192:207], v[56:59], v[40:43], v[192:207]
    v_mfma_f32_32x32x16_bf16 v[208:223], v[56:59], v[44:47], v[208:223]
    ds_read_b64_tr_b16 v[56:57], v72 offset:40960
    ds_read_b64_tr_b16 v[58:59], v72 offset:41984
    v_mfma_f32_32x32x16_bf16 v[224:239], v[60:63], v[40:43], v[224:239]
    ds_read_b128 v[40:43], v3 offset:16384
    v_mfma_f32_32x32x16_bf16 v[240:255], v[60:63], v[44:47], v[240:255]
    ds_read_b128 v[44:47], v3 offset:20480
    ds_read_b64_tr_b16 v[60:61], v73 offset:40960
    ds_read_b64_tr_b16 v[62:63], v73 offset:41984
    s_waitcnt lgkmcnt(15)
    v_mfma_f32_32x32x16_bf16 v[128:143], v[24:27], v[16:19], v[128:143]
    v_mfma_f32_32x32x16_bf16 v[144:159], v[24:27], v[20:23], v[144:159]
    s_waitcnt lgkmcnt(14)
    v_mfma_f32_32x32x16_bf16 v[160:175], v[28:31], v[16:19], v[160:175]
    v_mfma_f32_32x32x16_bf16 v[176:191], v[28:31], v[20:23], v[176:191]
    s_waitcnt lgkmcnt(12)
    v_mfma_f32_32x32x16_bf16 v[192:207], v[32:35], v[16:19], v[192:207]
    v_mfma_f32_32x32x16_bf16 v[208:223], v[32:35], v[20:23], v[208:223]
    s_waitcnt lgkmcnt(10)
    v_mfma_f32_32x32x16_bf16 v[224:239], v[36:39], v[16:19], v[224:239]
    v_mfma_f32_32x32x16_bf16 v[240:255], v[36:39], v[20:23], v[240:255]
    buffer_load_dwordx4 v[76:79], v108, s[20:23], 0 offen offset:0 sc1
    buffer_load_dwordx4 v[100:103], v108, s[20:23], 0 offen offset:16 sc1
    buffer_load_dwordx4 v[80:83], v108, s[20:23], 0 offen offset:1024 sc1
    buffer_load_dwordx4 v[104:107], v108, s[20:23], 0 offen offset:1040 sc1
    s_mov_b32 s36, 90112
    buffer_load_dwordx4 v[84:87], v109, s[20:23], s36 offen offset:0 sc1
    buffer_load_dwordx4 v[88:91], v109, s[20:23], s36 offen offset:512 sc1
    s_mov_b32 s36, 118784
    buffer_load_dwordx4 v[92:95], v109, s[20:23], s36 offen offset:0 sc1
    buffer_load_dwordx4 v[96:99], v109, s[20:23], s36 offen offset:512 sc1
    s_waitcnt vmcnt(9)
    s_waitcnt lgkmcnt(0)
    s_barrier
    v_mfma_f32_32x32x16_bf16 v[128:143], v[48:51], v[40:43], v[128:143]
    ds_read_b128 v[16:19], v4 offset:16384
    ds_read_b64_tr_b16 v[24:25], v6 offset:0
    ds_read_b64_tr_b16 v[26:27], v6 offset:1024
    ds_read_b128 v[20:23], v4 offset:20480
    v_mfma_f32_32x32x16_bf16 v[144:159], v[48:51], v[44:47], v[144:159]
    ds_read_b64_tr_b16 v[28:29], v10 offset:0
    ds_read_b64_tr_b16 v[30:31], v10 offset:1024
    ds_read_b64_tr_b16 v[32:33], v6 offset:8192
    ds_read_b64_tr_b16 v[34:35], v6 offset:9216
    v_mfma_f32_32x32x16_bf16 v[160:175], v[52:55], v[40:43], v[160:175]
    ds_read_b64_tr_b16 v[36:37], v10 offset:8192
    ds_read_b64_tr_b16 v[38:39], v10 offset:9216
    ds_read_b64_tr_b16 v[48:49], v72 offset:0
    ds_read_b64_tr_b16 v[50:51], v72 offset:1024
    v_mfma_f32_32x32x16_bf16 v[176:191], v[52:55], v[44:47], v[176:191]
    ds_read_b64_tr_b16 v[52:53], v73 offset:0
    ds_read_b64_tr_b16 v[54:55], v73 offset:1024
    v_mfma_f32_32x32x16_bf16 v[192:207], v[56:59], v[40:43], v[192:207]
    v_mfma_f32_32x32x16_bf16 v[208:223], v[56:59], v[44:47], v[208:223]
    ds_read_b64_tr_b16 v[56:57], v72 offset:8192
    ds_read_b64_tr_b16 v[58:59], v72 offset:9216
    v_mfma_f32_32x32x16_bf16 v[224:239], v[60:63], v[40:43], v[224:239]
    ds_read_b128 v[40:43], v5 offset:16384
    v_mfma_f32_32x32x16_bf16 v[240:255], v[60:63], v[44:47], v[240:255]
    ds_read_b128 v[44:47], v5 offset:20480
    ds_read_b64_tr_b16 v[60:61], v73 offset:8192
    ds_read_b64_tr_b16 v[62:63], v73 offset:9216
    s_waitcnt lgkmcnt(15)
    v_mfma_f32_32x32x16_bf16 v[128:143], v[24:27], v[16:19], v[128:143]
    v_mfma_f32_32x32x16_bf16 v[144:159], v[24:27], v[20:23], v[144:159]
    s_waitcnt lgkmcnt(14)
    v_mfma_f32_32x32x16_bf16 v[160:175], v[28:31], v[16:19], v[160:175]
    v_mfma_f32_32x32x16_bf16 v[176:191], v[28:31], v[20:23], v[176:191]
    s_waitcnt lgkmcnt(12)
    v_mfma_f32_32x32x16_bf16 v[192:207], v[32:35], v[16:19], v[192:207]
    v_mfma_f32_32x32x16_bf16 v[208:223], v[32:35], v[20:23], v[208:223]
    s_waitcnt lgkmcnt(10)
    v_mfma_f32_32x32x16_bf16 v[224:239], v[36:39], v[16:19], v[224:239]
    v_mfma_f32_32x32x16_bf16 v[240:255], v[36:39], v[20:23], v[240:255]
    s_waitcnt lgkmcnt(0)
    v_mfma_f32_32x32x16_bf16 v[128:143], v[48:51], v[40:43], v[128:143]
    v_mfma_f32_32x32x16_bf16 v[144:159], v[48:51], v[44:47], v[144:159]
    v_mfma_f32_32x32x16_bf16 v[160:175], v[52:55], v[40:43], v[160:175]
    v_mfma_f32_32x32x16_bf16 v[176:191], v[52:55], v[44:47], v[176:191]
    v_mfma_f32_32x32x16_bf16 v[192:207], v[56:59], v[40:43], v[192:207]
    v_mfma_f32_32x32x16_bf16 v[208:223], v[56:59], v[44:47], v[208:223]
    v_mfma_f32_32x32x16_bf16 v[224:239], v[60:63], v[40:43], v[224:239]
    v_mfma_f32_32x32x16_bf16 v[240:255], v[60:63], v[44:47], v[240:255]
    s_setprio 1
    s_waitcnt vmcnt(8)
    v_readfirstlane_b32 s58, v112
    v_readfirstlane_b32 s59, v113
    s_nop 3
    s_cmp_eq_u32 s58, 0
    s_cbranch_scc1 L_f1_fused_ker_eps_22
L_f1_fused_ker_epc_23:
    s_waitcnt vmcnt(0)
    v_cmp_eq_u32 vcc, s58, v79
    v_cmp_eq_u32 s[36:37], s58, v83
    s_nop 1
    s_and_b64 vcc, vcc, s[36:37]
    v_cmp_eq_u32 s[36:37], s58, v87
    s_nop 1
    s_and_b64 vcc, vcc, s[36:37]
    v_cmp_eq_u32 s[36:37], s58, v91
    s_nop 1
    s_and_b64 vcc, vcc, s[36:37]
    v_cmp_eq_u32 s[36:37], s58, v95
    s_nop 1
    s_and_b64 vcc, vcc, s[36:37]
    v_cmp_eq_u32 s[36:37], s58, v99
    s_nop 1
    s_and_b64 vcc, vcc, s[36:37]
    v_cmp_eq_u32 s[36:37], s58, v102
    s_nop 1
    s_and_b64 vcc, vcc, s[36:37]
    v_cmp_eq_u32 s[36:37], s58, v106
    s_nop 1
    s_and_b64 vcc, vcc, s[36:37]
    s_cmp_eq_u64 vcc, -1
    s_cbranch_scc0 L_f1_fused_ker_x3s_24
L_f1_fused_ker_x3c_25:
    v_mov_b32 v79, 0
    v_mov_b32 v83, 0
    v_mov_b32 v87, 0
    v_mov_b32 v91, 0
    v_mov_b32 v95, 0
    v_mov_b32 v99, 0
    s_nop 1
    v_mfma_f32_32x32x16_bf16 v[128:143], v[84:87], v[76:79], v[128:143]
    v_mfma_f32_32x32x16_bf16 v[144:159], v[84:87], v[80:83], v[144:159]
    v_mfma_f32_32x32x16_bf16 v[160:175], v[88:91], v[76:79], v[160:175]
    v_mfma_f32_32x32x16_bf16 v[176:191], v[88:91], v[80:83], v[176:191]
    v_mfma_f32_32x32x16_bf16 v[192:207], v[92:95], v[76:79], v[192:207]
    v_mfma_f32_32x32x16_bf16 v[208:223], v[92:95], v[80:83], v[208:223]
    v_mfma_f32_32x32x16_bf16 v[224:239], v[96:99], v[76:79], v[224:239]
    v_mfma_f32_32x32x16_bf16 v[240:255], v[96:99], v[80:83], v[240:255]
    s_barrier
    v_lshlrev_b32 v48, 4, v1
    s_lshl_b32 s45, s46, 7
    v_lshrrev_b32 v49, 3, v1
    v_lshlrev_b32 v49, 10, v49
    v_bfe_u32 v56, v1, 4, 1
    v_lshlrev_b32 v56, 2, v56
    v_and_b32 v57, 7, v1
    v_xor_b32 v56, v56, v57
    v_lshl_add_u32 v49, v56, 4, v49
    v_add_u32 v49, s45, v49
    v_lshrrev_b32 v56, 5, v1
    v_bfe_u32 v57, v1, 2, 2
    v_lshl_add_u32 v56, v56, 2, v57
    v_lshlrev_b32 v50, 7, v56
    v_bfe_u32 v56, v1, 4, 1
    v_lshlrev_b32 v56, 1, v56
    v_bfe_u32 v57, v1, 1, 1
    v_add_u32 v56, v56, v57
    v_bfe_u32 v57, v1, 3, 1
    v_lshlrev_b32 v57, 2, v57
    v_xor_b32 v56, v56, v57
    v_lshl_add_u32 v50, v56, 4, v50
    v_and_b32 v57, 1, v1
    v_lshl_add_u32 v50, v57, 3, v50
    s_lshl_b32 s40, s24, 14
    v_add_u32 v50, s40, v50
    v_xor_b32 v51, 64, v50
    s_mul_i32 s41, s24, 458752
    s_mul_i32 s42, s47, 224
    s_mul_i32 s48, s24, 28
    s_add_u32 s42, s42, s48
    s_lshl_b32 s42, s42, 10
    s_add_u32 s42, s42, 0x700000
    s_lshl_b32 s43, s24, 17
    s_lshl_b32 s44, s47, 6
    s_lshl_b32 s48, s24, 3
    s_add_u32 s44, s44, s48
    s_lshl_b32 s44, s44, 10
    s_add_u32 s44, s44, 0xe00000
    v_lshrrev_b32 v52, 3, v0
    s_lshl_b32 s48, s47, 6
    v_add_u32 v52, s48, v52
    v_lshlrev_b32 v52, 10, v52
    v_and_b32 v56, 7, v0
    v_lshl_add_u32 v52, v56, 4, v52
    v_add_u32 v52, s45, v52
    v_min_u32 v53, 6, v1
    s_mul_i32 s48, s24, 7
    v_add_u32 v53, s48, v53
    v_lshlrev_b32 v53, 3, v53
    s_lshl_b32 s48, s47, 8
    s_add_u32 s48, s48, 0x42000
    v_add_u32 v53, s48, v53
    v_and_b32 v56, 7, v1
    v_lshlrev_b32 v54, 3, v56
    s_lshl_b32 s48, s47, 8
    s_lshl_b32 s49, s24, 6
    s_add_u32 s48, s48, s49
    s_add_u32 s48, s48, 0x44000
    v_add_u32 v54, s48, v54
    s_add_u32 m0, s40, 0
    s_add_u32 s45, s41, 0
    buffer_load_dwordx4 v49, s[84:87], s45 offen lds
    s_add_u32 m0, s40, 1024
    s_add_u32 s45, s41, 8192
    buffer_load_dwordx4 v49, s[84:87], s45 offen lds
    s_add_u32 m0, s40, 2048
    s_add_u32 s45, s41, 16384
    buffer_load_dwordx4 v49, s[84:87], s45 offen lds
    s_add_u32 m0, s40, 3072
    s_add_u32 s45, s41, 24576
    buffer_load_dwordx4 v49, s[84:87], s45 offen lds
    s_add_u32 m0, s40, 4096
    s_add_u32 s45, s41, 32768
    buffer_load_dwordx4 v49, s[84:87], s45 offen lds
    s_add_u32 m0, s40, 5120
    s_add_u32 s45, s41, 40960
    buffer_load_dwordx4 v49, s[84:87], s45 offen lds
    s_add_u32 m0, s40, 6144
    s_add_u32 s45, s41, 49152
    buffer_load_dwordx4 v49, s[84:87], s45 offen lds
    s_add_u32 m0, s40, 7168
    s_add_u32 s45, s41, 57344
    buffer_load_dwordx4 v49, s[84:87], s45 offen lds
    s_add_u32 m0, s40, 8192
    s_add_u32 s45, s41, 65536
    buffer_load_dwordx4 v49, s[84:87], s45 offen lds
    s_add_u32 m0, s40, 9216
    s_add_u32 s45, s41, 73728
    buffer_load_dwordx4 v49, s[84:87], s45 offen lds
    s_add_u32 m0, s40, 10240
    s_add_u32 s45, s41, 81920
    buffer_load_dwordx4 v49, s[84:87], s45 offen lds
    s_add_u32 m0, s40, 11264
    s_add_u32 s45, s41, 90112
    buffer_load_dwordx4 v49, s[84:87], s45 offen lds
    s_add_u32 m0, s40, 12288
    s_add_u32 s45, s41, 98304
    buffer_load_dwordx4 v49, s[84:87], s45 offen lds
    s_add_u32 m0, s40, 13312
    s_add_u32 s45, s41, 106496
    buffer_load_dwordx4 v49, s[84:87], s45 offen lds
    s_add_u32 m0, s40, 14336
    s_add_u32 s45, s41, 114688
    buffer_load_dwordx4 v49, s[84:87], s45 offen lds
    s_add_u32 m0, s40, 15360
    s_add_u32 s45, s41, 122880
    buffer_load_dwordx4 v49, s[84:87], s45 offen lds
    v_mul_f32 v110, 0xbfb8aa3b, v100
    v_mul_f32 v111, 0xbfb8aa3b, v104
    v_lshlrev_b32 v10, 4, v1
    s_lshl_b32 s36, s25, 2
    s_lshl_b32 s37, s27, 1
    s_add_u32 s36, s36, s37
    s_mul_i32 s36, s36, 112
    s_lshl_b32 s37, s26, 3
    s_add_u32 s36, s36, s37
    s_lshl_b32 s37, s28, 2
    s_add_u32 s36, s36, s37
    s_lshl_b32 s36, s36, 10
    s_add_u32 s36, s36, 0x700000
    s_nop 7
    v_mul_f32 v128, v128, v110
    v_mul_f32 v129, v129, v110
    v_mul_f32 v130, v130, v110
    v_mul_f32 v131, v131, v110
    v_mul_f32 v132, v132, v110
    v_mul_f32 v133, v133, v110
    v_mul_f32 v134, v134, v110
    v_mul_f32 v135, v135, v110
    v_mul_f32 v136, v136, v110
    v_mul_f32 v137, v137, v110
    v_mul_f32 v138, v138, v110
    v_mul_f32 v139, v139, v110
    v_mul_f32 v140, v140, v110
    v_mul_f32 v141, v141, v110
    v_mul_f32 v142, v142, v110
    v_mul_f32 v143, v143, v110
    v_exp_f32 v128, v128
    v_exp_f32 v129, v129
    v_exp_f32 v130, v130
    v_exp_f32 v131, v131
    v_exp_f32 v132, v132
    v_exp_f32 v133, v133
    v_exp_f32 v134, v134
    v_exp_f32 v135, v135
    v_exp_f32 v136, v136
    v_exp_f32 v137, v137
    v_exp_f32 v138, v138
    v_exp_f32 v139, v139
    v_exp_f32 v140, v140
    v_exp_f32 v141, v141
    v_exp_f32 v142, v142
    v_exp_f32 v143, v143
    v_fma_f32 v128, v128, v101, v101
    v_fma_f32 v129, v129, v101, v101
    v_fma_f32 v130, v130, v101, v101
    v_fma_f32 v131, v131, v101, v101
    v_fma_f32 v132, v132, v101, v101
    v_fma_f32 v133, v133, v101, v101
    v_fma_f32 v134, v134, v101, v101
    v_fma_f32 v135, v135, v101, v101
    v_fma_f32 v136, v136, v101, v101
    v_fma_f32 v137, v137, v101, v101
    v_fma_f32 v138, v138, v101, v101
    v_fma_f32 v139, v139, v101, v101
    v_fma_f32 v140, v140, v101, v101
    v_fma_f32 v141, v141, v101, v101
    v_fma_f32 v142, v142, v101, v101
    v_fma_f32 v143, v143, v101, v101
    v_rcp_f32 v128, v128
    v_rcp_f32 v129, v129
    v_rcp_f32 v130, v130
    v_rcp_f32 v131, v131
    v_rcp_f32 v132, v132
    v_rcp_f32 v133, v133
    v_rcp_f32 v134, v134
    v_rcp_f32 v135, v135
    v_rcp_f32 v136, v136
    v_rcp_f32 v137, v137
    v_rcp_f32 v138, v138
    v_rcp_f32 v139, v139
    v_rcp_f32 v140, v140
    v_rcp_f32 v141, v141
    v_rcp_f32 v142, v142
    v_rcp_f32 v143, v143
    s_nop 0
    v_mul_f32 v128, v128, v192
    v_mul_f32 v129, v129, v193
    v_mul_f32 v130, v130, v194
    v_mul_f32 v131, v131, v195
    v_mul_f32 v132, v132, v196
    v_mul_f32 v133, v133, v197
    v_mul_f32 v134, v134, v198
    v_mul_f32 v135, v135, v199
    v_mul_f32 v136, v136, v200
    v_mul_f32 v137, v137, v201
    v_mul_f32 v138, v138, v202
    v_mul_f32 v139, v139, v203
    v_mul_f32 v140, v140, v204
    v_mul_f32 v141, v141, v205
    v_mul_f32 v142, v142, v206
    v_mul_f32 v143, v143, v207
    v_cvt_pk_bf16_f32 v16, v128, v129
    v_cvt_pk_bf16_f32 v17, v130, v131
    v_cvt_pk_bf16_f32 v18, v132, v133
    v_cvt_pk_bf16_f32 v19, v134, v135
    s_add_u32 s37, s36, 0
    buffer_store_dwordx4 v[16:19], v10, s[20:23], s37 offen sc1
    v_cvt_pk_bf16_f32 v20, v136, v137
    v_cvt_pk_bf16_f32 v21, v138, v139
    v_cvt_pk_bf16_f32 v22, v140, v141
    v_cvt_pk_bf16_f32 v23, v142, v143
    s_add_u32 s37, s36, 1024
    buffer_store_dwordx4 v[20:23], v10, s[20:23], s37 offen sc1
    v_mul_f32 v144, v144, v111
    v_mul_f32 v145, v145, v111
    v_mul_f32 v146, v146, v111
    v_mul_f32 v147, v147, v111
    v_mul_f32 v148, v148, v111
    v_mul_f32 v149, v149, v111
    v_mul_f32 v150, v150, v111
    v_mul_f32 v151, v151, v111
    v_mul_f32 v152, v152, v111
    v_mul_f32 v153, v153, v111
    v_mul_f32 v154, v154, v111
    v_mul_f32 v155, v155, v111
    v_mul_f32 v156, v156, v111
    v_mul_f32 v157, v157, v111
    v_mul_f32 v158, v158, v111
    v_mul_f32 v159, v159, v111
    v_exp_f32 v144, v144
    v_exp_f32 v145, v145
    v_exp_f32 v146, v146
    v_exp_f32 v147, v147
    v_exp_f32 v148, v148
    v_exp_f32 v149, v149
    v_exp_f32 v150, v150
    v_exp_f32 v151, v151
    v_exp_f32 v152, v152
    v_exp_f32 v153, v153
    v_exp_f32 v154, v154
    v_exp_f32 v155, v155
    v_exp_f32 v156, v156
    v_exp_f32 v157, v157
    v_exp_f32 v158, v158
    v_exp_f32 v159, v159
    v_fma_f32 v144, v144, v105, v105
    v_fma_f32 v145, v145, v105, v105
    v_fma_f32 v146, v146, v105, v105
    v_fma_f32 v147, v147, v105, v105
    v_fma_f32 v148, v148, v105, v105
    v_fma_f32 v149, v149, v105, v105
    v_fma_f32 v150, v150, v105, v105
    v_fma_f32 v151, v151, v105, v105
    v_fma_f32 v152, v152, v105, v105
    v_fma_f32 v153, v153, v105, v105
    v_fma_f32 v154, v154, v105, v105
    v_fma_f32 v155, v155, v105, v105
    v_fma_f32 v156, v156, v105, v105
    v_fma_f32 v157, v157, v105, v105
    v_fma_f32 v158, v158, v105, v105
    v_fma_f32 v159, v159, v105, v105
    v_rcp_f32 v144, v144
    v_rcp_f32 v145, v145
    v_rcp_f32 v146, v146
    v_rcp_f32 v147, v147
    v_rcp_f32 v148, v148
    v_rcp_f32 v149, v149
    v_rcp_f32 v150, v150
    v_rcp_f32 v151, v151
    v_rcp_f32 v152, v152
    v_rcp_f32 v153, v153
    v_rcp_f32 v154, v154
    v_rcp_f32 v155, v155
    v_rcp_f32 v156, v156
    v_rcp_f32 v157, v157
    v_rcp_f32 v158, v158
    v_rcp_f32 v159, v159
    s_nop 0
    v_mul_f32 v144, v144, v208
    v_mul_f32 v145, v145, v209
    v_mul_f32 v146, v146, v210
    v_mul_f32 v147, v147, v211
    v_mul_f32 v148, v148, v212
    v_mul_f32 v149, v149, v213
    v_mul_f32 v150, v150, v214
    v_mul_f32 v151, v151, v215
    v_mul_f32 v152, v152, v216
    v_mul_f32 v153, v153, v217
    v_mul_f32 v154, v154, v218
    v_mul_f32 v155, v155, v219
    v_mul_f32 v156, v156, v220
    v_mul_f32 v157, v157, v221
    v_mul_f32 v158, v158, v222
    v_mul_f32 v159, v159, v223
    v_cvt_pk_bf16_f32 v24, v144, v145
    v_cvt_pk_bf16_f32 v25, v146, v147
    v_cvt_pk_bf16_f32 v26, v148, v149
    v_cvt_pk_bf16_f32 v27, v150, v151
    s_add_u32 s37, s36, 114688
    buffer_store_dwordx4 v[24:27], v10, s[20:23], s37 offen sc1
    v_cvt_pk_bf16_f32 v28, v152, v153
    v_cvt_pk_bf16_f32 v29, v154, v155
    v_cvt_pk_bf16_f32 v30, v156, v157
    v_cvt_pk_bf16_f32 v31, v158, v159
    s_add_u32 s37, s36, 115712
    buffer_store_dwordx4 v[28:31], v10, s[20:23], s37 offen sc1
    v_mul_f32 v160, v160, v110
    v_mul_f32 v161, v161, v110
    v_mul_f32 v162, v162, v110
    v_mul_f32 v163, v163, v110
    v_mul_f32 v164, v164, v110
    v_mul_f32 v165, v165, v110
    v_mul_f32 v166, v166, v110
    v_mul_f32 v167, v167, v110
    v_mul_f32 v168, v168, v110
    v_mul_f32 v169, v169, v110
    v_mul_f32 v170, v170, v110
    v_mul_f32 v171, v171, v110
    v_mul_f32 v172, v172, v110
    v_mul_f32 v173, v173, v110
    v_mul_f32 v174, v174, v110
    v_mul_f32 v175, v175, v110
    v_exp_f32 v160, v160
    v_exp_f32 v161, v161
    v_exp_f32 v162, v162
    v_exp_f32 v163, v163
    v_exp_f32 v164, v164
    v_exp_f32 v165, v165
    v_exp_f32 v166, v166
    v_exp_f32 v167, v167
    v_exp_f32 v168, v168
    v_exp_f32 v169, v169
    v_exp_f32 v170, v170
    v_exp_f32 v171, v171
    v_exp_f32 v172, v172
    v_exp_f32 v173, v173
    v_exp_f32 v174, v174
    v_exp_f32 v175, v175
    v_fma_f32 v160, v160, v101, v101
    v_fma_f32 v161, v161, v101, v101
    v_fma_f32 v162, v162, v101, v101
    v_fma_f32 v163, v163, v101, v101
    v_fma_f32 v164, v164, v101, v101
    v_fma_f32 v165, v165, v101, v101
    v_fma_f32 v166, v166, v101, v101
    v_fma_f32 v167, v167, v101, v101
    v_fma_f32 v168, v168, v101, v101
    v_fma_f32 v169, v169, v101, v101
    v_fma_f32 v170, v170, v101, v101
    v_fma_f32 v171, v171, v101, v101
    v_fma_f32 v172, v172, v101, v101
    v_fma_f32 v173, v173, v101, v101
    v_fma_f32 v174, v174, v101, v101
    v_fma_f32 v175, v175, v101, v101
    v_rcp_f32 v160, v160
    v_rcp_f32 v161, v161
    v_rcp_f32 v162, v162
    v_rcp_f32 v163, v163
    v_rcp_f32 v164, v164
    v_rcp_f32 v165, v165
    v_rcp_f32 v166, v166
    v_rcp_f32 v167, v167
    v_rcp_f32 v168, v168
    v_rcp_f32 v169, v169
    v_rcp_f32 v170, v170
    v_rcp_f32 v171, v171
    v_rcp_f32 v172, v172
    v_rcp_f32 v173, v173
    v_rcp_f32 v174, v174
    v_rcp_f32 v175, v175
    s_nop 0
    v_mul_f32 v160, v160, v224
    v_mul_f32 v161, v161, v225
    v_mul_f32 v162, v162, v226
    v_mul_f32 v163, v163, v227
    v_mul_f32 v164, v164, v228
    v_mul_f32 v165, v165, v229
    v_mul_f32 v166, v166, v230
    v_mul_f32 v167, v167, v231
    v_mul_f32 v168, v168, v232
    v_mul_f32 v169, v169, v233
    v_mul_f32 v170, v170, v234
    v_mul_f32 v171, v171, v235
    v_mul_f32 v172, v172, v236
    v_mul_f32 v173, v173, v237
    v_mul_f32 v174, v174, v238
    v_mul_f32 v175, v175, v239
    v_cvt_pk_bf16_f32 v32, v160, v161
    v_cvt_pk_bf16_f32 v33, v162, v163
    v_cvt_pk_bf16_f32 v34, v164, v165
    v_cvt_pk_bf16_f32 v35, v166, v167
    s_add_u32 s37, s36, 2048
    buffer_store_dwordx4 v[32:35], v10, s[20:23], s37 offen sc1
    v_cvt_pk_bf16_f32 v36, v168, v169
    v_cvt_pk_bf16_f32 v37, v170, v171
    v_cvt_pk_bf16_f32 v38, v172, v173
    v_cvt_pk_bf16_f32 v39, v174, v175
    s_add_u32 s37, s36, 3072
    buffer_store_dwordx4 v[36:39], v10, s[20:23], s37 offen sc1
    v_mul_f32 v176, v176, v111
    v_mul_f32 v177, v177, v111
    v_mul_f32 v178, v178, v111
    v_mul_f32 v179, v179, v111
    v_mul_f32 v180, v180, v111
    v_mul_f32 v181, v181, v111
    v_mul_f32 v182, v182, v111
    v_mul_f32 v183, v183, v111
    v_mul_f32 v184, v184, v111
    v_mul_f32 v185, v185, v111
    v_mul_f32 v186, v186, v111
    v_mul_f32 v187, v187, v111
    v_mul_f32 v188, v188, v111
    v_mul_f32 v189, v189, v111
    v_mul_f32 v190, v190, v111
    v_mul_f32 v191, v191, v111
    v_exp_f32 v176, v176
    v_exp_f32 v177, v177
    v_exp_f32 v178, v178
    v_exp_f32 v179, v179
    v_exp_f32 v180, v180
    v_exp_f32 v181, v181
    v_exp_f32 v182, v182
    v_exp_f32 v183, v183
    v_exp_f32 v184, v184
    v_exp_f32 v185, v185
    v_exp_f32 v186, v186
    v_exp_f32 v187, v187
    v_exp_f32 v188, v188
    v_exp_f32 v189, v189
    v_exp_f32 v190, v190
    v_exp_f32 v191, v191
    v_fma_f32 v176, v176, v105, v105
    v_fma_f32 v177, v177, v105, v105
    v_fma_f32 v178, v178, v105, v105
    v_fma_f32 v179, v179, v105, v105
    v_fma_f32 v180, v180, v105, v105
    v_fma_f32 v181, v181, v105, v105
    v_fma_f32 v182, v182, v105, v105
    v_fma_f32 v183, v183, v105, v105
    v_fma_f32 v184, v184, v105, v105
    v_fma_f32 v185, v185, v105, v105
    v_fma_f32 v186, v186, v105, v105
    v_fma_f32 v187, v187, v105, v105
    v_fma_f32 v188, v188, v105, v105
    v_fma_f32 v189, v189, v105, v105
    v_fma_f32 v190, v190, v105, v105
    v_fma_f32 v191, v191, v105, v105
    v_rcp_f32 v176, v176
    v_rcp_f32 v177, v177
    v_rcp_f32 v178, v178
    v_rcp_f32 v179, v179
    v_rcp_f32 v180, v180
    v_rcp_f32 v181, v181
    v_rcp_f32 v182, v182
    v_rcp_f32 v183, v183
    v_rcp_f32 v184, v184
    v_rcp_f32 v185, v185
    v_rcp_f32 v186, v186
    v_rcp_f32 v187, v187
    v_rcp_f32 v188, v188
    v_rcp_f32 v189, v189
    v_rcp_f32 v190, v190
    v_rcp_f32 v191, v191
    s_nop 0
    v_mul_f32 v176, v176, v240
    v_mul_f32 v177, v177, v241
    v_mul_f32 v178, v178, v242
    v_mul_f32 v179, v179, v243
    v_mul_f32 v180, v180, v244
    v_mul_f32 v181, v181, v245
    v_mul_f32 v182, v182, v246
    v_mul_f32 v183, v183, v247
    v_mul_f32 v184, v184, v248
    v_mul_f32 v185, v185, v249
    v_mul_f32 v186, v186, v250
    v_mul_f32 v187, v187, v251
    v_mul_f32 v188, v188, v252
    v_mul_f32 v189, v189, v253
    v_mul_f32 v190, v190, v254
    v_mul_f32 v191, v191, v255
    v_cvt_pk_bf16_f32 v40, v176, v177
    v_cvt_pk_bf16_f32 v41, v178, v179
    v_cvt_pk_bf16_f32 v42, v180, v181
    v_cvt_pk_bf16_f32 v43, v182, v183
    s_add_u32 s37, s36, 116736
    buffer_store_dwordx4 v[40:43], v10, s[20:23], s37 offen sc1
    v_cvt_pk_bf16_f32 v44, v184, v185
    v_cvt_pk_bf16_f32 v45, v186, v187
    v_cvt_pk_bf16_f32 v46, v188, v189
    v_cvt_pk_bf16_f32 v47, v190, v191
    s_add_u32 s37, s36, 117760
    buffer_store_dwordx4 v[44:47], v10, s[20:23], s37 offen sc1
    s_lshl_b32 s36, s25, 1
    s_add_u32 s36, s36, s27
    s_lshl_b32 s36, s36, 8
    s_lshl_b32 s37, s26, 1
    s_add_u32 s37, s37, s28
    s_lshl_b32 s37, s37, 3
    s_add_u32 s36, s36, s37
    s_add_u32 s36, s36, 0x42000
    v_mov_b32 v56, s36
    v_mov_b32 v58, s58
    v_mov_b32 v59, s59
    s_waitcnt vmcnt(0)
    s_mov_b64 exec, 1
    buffer_store_dwordx2 v[58:59], v56, s[20:23], 0 offen sc1
    s_mov_b64 exec, -1
    s_setprio 0
    s_branch L_f1_e4
L_f1_pf:
    v_and_b32 v1, 63, v0
    v_mov_b32 v114, 0
    global_load_dwordx2 v[112:113], v114, s[56:57] sc1
    v_lshlrev_b32 v48, 4, v1
    s_lshl_b32 s45, s46, 7
    v_lshrrev_b32 v49, 3, v1
    v_lshlrev_b32 v49, 10, v49
    v_bfe_u32 v56, v1, 4, 1
    v_lshlrev_b32 v56, 2, v56
    v_and_b32 v57, 7, v1
    v_xor_b32 v56, v56, v57
    v_lshl_add_u32 v49, v56, 4, v49
    v_add_u32 v49, s45, v49
    v_lshrrev_b32 v56, 5, v1
    v_bfe_u32 v57, v1, 2, 2
    v_lshl_add_u32 v56, v56, 2, v57
    v_lshlrev_b32 v50, 7, v56
    v_bfe_u32 v56, v1, 4, 1
    v_lshlrev_b32 v56, 1, v56
    v_bfe_u32 v57, v1, 1, 1
    v_add_u32 v56, v56, v57
    v_bfe_u32 v57, v1, 3, 1
    v_lshlrev_b32 v57, 2, v57
    v_xor_b32 v56, v56, v57
    v_lshl_add_u32 v50, v56, 4, v50
    v_and_b32 v57, 1, v1
    v_lshl_add_u32 v50, v57, 3, v50
    s_lshl_b32 s40, s24, 14
    v_add_u32 v50, s40, v50
    v_xor_b32 v51, 64, v50
    s_mul_i32 s41, s24, 458752
    s_mul_i32 s42, s47, 224
    s_mul_i32 s48, s24, 28
    s_add_u32 s42, s42, s48
    s_lshl_b32 s42, s42, 10
    s_add_u32 s42, s42, 0x700000
    s_lshl_b32 s43, s24, 17
    s_lshl_b32 s44, s47, 6
    s_lshl_b32 s48, s24, 3
    s_add_u32 s44, s44, s48
    s_lshl_b32 s44, s44, 10
    s_add_u32 s44, s44, 0xe00000
    v_lshrrev_b32 v52, 3, v0
    s_lshl_b32 s48, s47, 6
    v_add_u32 v52, s48, v52
    v_lshlrev_b32 v52, 10, v52
    v_and_b32 v56, 7, v0
    v_lshl_add_u32 v52, v56, 4, v52
    v_add_u32 v52, s45, v52
    v_min_u32 v53, 6, v1
    s_mul_i32 s48, s24, 7
    v_add_u32 v53, s48, v53
    v_lshlrev_b32 v53, 3, v53
    s_lshl_b32 s48, s47, 8
    s_add_u32 s48, s48, 0x42000
    v_add_u32 v53, s48, v53
    v_and_b32 v56, 7, v1
    v_lshlrev_b32 v54, 3, v56
    s_lshl_b32 s48, s47, 8
    s_lshl_b32 s49, s24, 6
    s_add_u32 s48, s48, s49
    s_add_u32 s48, s48, 0x44000
    v_add_u32 v54, s48, v54
    s_waitcnt vmcnt(0)
    v_readfirstlane_b32 s58, v112
    v_readfirstlane_b32 s59, v113
    s_nop 3
    s_cmp_eq_u32 s58, 0
    s_cbranch_scc1 L_f1_fused_ker_eps_26
L_f1_fused_ker_epc_27:
    s_add_u32 m0, s40, 0
    s_add_u32 s45, s41, 0
    buffer_load_dwordx4 v49, s[84:87], s45 offen lds
    s_add_u32 m0, s40, 1024
    s_add_u32 s45, s41, 8192
    buffer_load_dwordx4 v49, s[84:87], s45 offen lds
    s_add_u32 m0, s40, 2048
    s_add_u32 s45, s41, 16384
    buffer_load_dwordx4 v49, s[84:87], s45 offen lds
    s_add_u32 m0, s40, 3072
    s_add_u32 s45, s41, 24576
    buffer_load_dwordx4 v49, s[84:87], s45 offen lds
    s_add_u32 m0, s40, 4096
    s_add_u32 s45, s41, 32768
    buffer_load_dwordx4 v49, s[84:87], s45 offen lds
    s_add_u32 m0, s40, 5120
    s_add_u32 s45, s41, 40960
    buffer_load_dwordx4 v49, s[84:87], s45 offen lds
    s_add_u32 m0, s40, 6144
    s_add_u32 s45, s41, 49152
    buffer_load_dwordx4 v49, s[84:87], s45 offen lds
    s_add_u32 m0, s40, 7168
    s_add_u32 s45, s41, 57344
    buffer_load_dwordx4 v49, s[84:87], s45 offen lds
    s_add_u32 m0, s40, 8192
    s_add_u32 s45, s41, 65536
    buffer_load_dwordx4 v49, s[84:87], s45 offen lds
    s_add_u32 m0, s40, 9216
    s_add_u32 s45, s41, 73728
    buffer_load_dwordx4 v49, s[84:87], s45 offen lds
    s_add_u32 m0, s40, 10240
    s_add_u32 s45, s41, 81920
    buffer_load_dwordx4 v49, s[84:87], s45 offen lds
    s_add_u32 m0, s40, 11264
    s_add_u32 s45, s41, 90112
    buffer_load_dwordx4 v49, s[84:87], s45 offen lds
    s_add_u32 m0, s40, 12288
    s_add_u32 s45, s41, 98304
    buffer_load_dwordx4 v49, s[84:87], s45 offen lds
    s_add_u32 m0, s40, 13312
    s_add_u32 s45, s41, 106496
    buffer_load_dwordx4 v49, s[84:87], s45 offen lds
    s_add_u32 m0, s40, 14336
    s_add_u32 s45, s41, 114688
    buffer_load_dwordx4 v49, s[84:87], s45 offen lds
    s_add_u32 m0, s40, 15360
    s_add_u32 s45, s41, 122880
    buffer_load_dwordx4 v49, s[84:87], s45 offen lds
    s_setprio 0
L_f1_e4:
    buffer_load_dwordx4 v[40:43], v52, s[8:11], 0 offen
    s_mov_b32 s45, 32768
    buffer_load_dwordx4 v[44:47], v52, s[8:11], s45 offen
    s_mov_b32 s49, 0
L_f1_fused_ker_hsp_28:
    buffer_load_dwordx2 v[58:59], v53, s[20:23], 0 offen sc1
    s_add_u32 s49, s49, 1
    s_waitcnt vmcnt(0)
    v_cmp_eq_u64 vcc, s[58:59], v[58:59]
    s_nop 3
    s_cmp_eq_u64 vcc, -1
    s_cbranch_scc1 L_f1_fused_ker_hspc_29
    s_and_b32 s48, vcc_lo, 0x7f
    s_bcnt1_i32_b32 s48, s48
    s_cmp_lt_u32 s48, 4
    s_cbranch_scc1 L_f1_fused_ker_hspa_30
    s_cmp_lt_u32 s48, 7
    s_cbranch_scc1 L_f1_fused_ker_hspb_31
    s_sleep 2
    s_branch L_f1_fused_ker_hspd_32
L_f1_fused_ker_hspa_30:
    s_sleep 32
    s_branch L_f1_fused_ker_hspd_32
L_f1_fused_ker_hspb_31:
    s_sleep 8
L_f1_fused_ker_hspd_32:
    s_cmp_lt_u32 s49, 0x4000
    s_cbranch_scc1 L_f1_fused_ker_hsp_28
L_f1_fused_ker_hspc_29:
    s_add_u32 s45, s42, 0
    buffer_load_dwordx4 v[128:131], v48, s[20:23], s45 offen sc1
    s_add_u32 s45, s42, 114688
    buffer_load_dwordx4 v[132:135], v48, s[20:23], s45 offen sc1
    s_add_u32 s45, s42, 1024
    buffer_load_dwordx4 v[136:139], v48, s[20:23], s45 offen sc1
    s_add_u32 s45, s42, 115712
    buffer_load_dwordx4 v[140:143], v48, s[20:23], s45 offen sc1
    s_add_u32 s45, s42, 2048
    buffer_load_dwordx4 v[144:147], v48, s[20:23], s45 offen sc1
    s_add_u32 s45, s42, 116736
    buffer_load_dwordx4 v[148:151], v48, s[20:23], s45 offen sc1
    s_add_u32 s45, s42, 3072
    buffer_load_dwordx4 v[152:155], v48, s[20:23], s45 offen sc1
    s_add_u32 s45, s42, 117760
    buffer_load_dwordx4 v[156:159], v48, s[20:23], s45 offen sc1
    s_add_u32 s45, s42, 4096
    buffer_load_dwordx4 v[160:163], v48, s[20:23], s45 offen sc1
    s_add_u32 s45, s42, 118784
    buffer_load_dwordx4 v[164:167], v48, s[20:23], s45 offen sc1
    s_add_u32 s45, s42, 5120
    buffer_load_dwordx4 v[168:171], v48, s[20:23], s45 offen sc1
    s_add_u32 s45, s42, 119808
    buffer_load_dwordx4 v[172:175], v48, s[20:23], s45 offen sc1
    s_add_u32 s45, s42, 6144
    buffer_load_dwordx4 v[176:179], v48, s[20:23], s45 offen sc1
    s_add_u32 s45, s42, 120832
    buffer_load_dwordx4 v[180:183], v48, s[20:23], s45 offen sc1
    s_add_u32 s45, s42, 7168
    buffer_load_dwordx4 v[184:187], v48, s[20:23], s45 offen sc1
    s_add_u32 s45, s42, 121856
    buffer_load_dwordx4 v[188:191], v48, s[20:23], s45 offen sc1
    ds_read_b64_tr_b16 v[16:17], v50 offset:0
    ds_read_b64_tr_b16 v[18:19], v50 offset:1024
    ds_read_b64_tr_b16 v[20:21], v51 offset:0
    ds_read_b64_tr_b16 v[22:23], v51 offset:1024
    ds_read_b64_tr_b16 v[24:25], v50 offset:2048
    ds_read_b64_tr_b16 v[26:27], v50 offset:3072
    ds_read_b64_tr_b16 v[28:29], v51 offset:2048
    ds_read_b64_tr_b16 v[30:31], v51 offset:3072
    s_waitcnt vmcnt(14)
    s_waitcnt lgkmcnt(4)
    v_mfma_f32_32x32x16_bf16 v[64:79], v[16:19], v[128:131], 0
    v_mfma_f32_32x32x16_bf16 v[80:95], v[16:19], v[132:135], 0
    v_mfma_f32_32x32x16_bf16 v[96:111], v[20:23], v[128:131], 0
    v_mfma_f32_32x32x16_bf16 v[112:127], v[20:23], v[132:135], 0
    s_add_u32 m0, s40, 0
    s_add_u32 s45, s41, 131072
    buffer_load_dwordx4 v49, s[84:87], s45 offen lds
    s_add_u32 m0, s40, 1024
    s_add_u32 s45, s41, 139264
    buffer_load_dwordx4 v49, s[84:87], s45 offen lds
    s_add_u32 s45, s42, 8192
    buffer_load_dwordx4 v[128:131], v48, s[20:23], s45 offen sc1
    s_add_u32 s45, s42, 122880
    buffer_load_dwordx4 v[132:135], v48, s[20:23], s45 offen sc1
    ds_read_b64_tr_b16 v[16:17], v50 offset:4096
    ds_read_b64_tr_b16 v[18:19], v50 offset:5120
    ds_read_b64_tr_b16 v[20:21], v51 offset:4096
    ds_read_b64_tr_b16 v[22:23], v51 offset:5120
    s_waitcnt vmcnt(16)
    s_waitcnt lgkmcnt(4)
    v_mfma_f32_32x32x16_bf16 v[64:79], v[24:27], v[136:139], v[64:79]
    v_mfma_f32_32x32x16_bf16 v[80:95], v[24:27], v[140:143], v[80:95]
    v_mfma_f32_32x32x16_bf16 v[96:111], v[28:31], v[136:139], v[96:111]
    v_mfma_f32_32x32x16_bf16 v[112:127], v[28:31], v[140:143], v[112:127]
    s_add_u32 m0, s40, 2048
    s_add_u32 s45, s41, 147456
    buffer_load_dwordx4 v49, s[84:87], s45 offen lds
    s_add_u32 m0, s40, 3072
    s_add_u32 s45, s41, 155648
    buffer_load_dwordx4 v49, s[84:87], s45 offen lds
    s_add_u32 s45, s42, 9216
    buffer_load_dwordx4 v[136:139], v48, s[20:23], s45 offen sc1
    s_add_u32 s45, s42, 123904
    buffer_load_dwordx4 v[140:143], v48, s[20:23], s45 offen sc1
    ds_read_b64_tr_b16 v[24:25], v50 offset:6144
    ds_read_b64_tr_b16 v[26:27], v50 offset:7168
    ds_read_b64_tr_b16 v[28:29], v51 offset:6144
    ds_read_b64_tr_b16 v[30:31], v51 offset:7168
    s_waitcnt vmcnt(18)
    s_waitcnt lgkmcnt(4)
    v_mfma_f32_32x32x16_bf16 v[64:79], v[16:19], v[144:147], v[64:79]
    v_mfma_f32_32x32x16_bf16 v[80:95], v[16:19], v[148:151], v[80:95]
    v_mfma_f32_32x32x16_bf16 v[96:111], v[20:23], v[144:147], v[96:111]
    v_mfma_f32_32x32x16_bf16 v[112:127], v[20:23], v[148:151], v[112:127]
    s_add_u32 m0, s40, 4096
    s_add_u32 s45, s41, 163840
    buffer_load_dwordx4 v49, s[84:87], s45 offen lds
    s_add_u32 m0, s40, 5120
    s_add_u32 s45, s41, 172032
    buffer_load_dwordx4 v49, s[84:87], s45 offen lds
    s_add_u32 s45, s42, 10240
    buffer_load_dwordx4 v[144:147], v48, s[20:23], s45 offen sc1
    s_add_u32 s45, s42, 124928
    buffer_load_dwordx4 v[148:151], v48, s[20:23], s45 offen sc1
    ds_read_b64_tr_b16 v[16:17], v50 offset:8192
    ds_read_b64_tr_b16 v[18:19], v50 offset:9216
    ds_read_b64_tr_b16 v[20:21], v51 offset:8192
    ds_read_b64_tr_b16 v[22:23], v51 offset:9216
    s_waitcnt vmcnt(20)
    s_waitcnt lgkmcnt(4)
    v_mfma_f32_32x32x16_bf16 v[64:79], v[24:27], v[152:155], v[64:79]
    v_mfma_f32_32x32x16_bf16 v[80:95], v[24:27], v[156:159], v[80:95]
    v_mfma_f32_32x32x16_bf16 v[96:111], v[28:31], v[152:155], v[96:111]
    v_mfma_f32_32x32x16_bf16 v[112:127], v[28:31], v[156:159], v[112:127]
    s_add_u32 m0, s40, 6144
    s_add_u32 s45, s41, 180224
    buffer_load_dwordx4 v49, s[84:87], s45 offen lds
    s_add_u32 m0, s40, 7168
    s_add_u32 s45, s41, 188416
    buffer_load_dwordx4 v49, s[84:87], s45 offen lds
    s_add_u32 s45, s42, 11264
    buffer_load_dwordx4 v[152:155], v48, s[20:23], s45 offen sc1
    s_add_u32 s45, s42, 125952
    buffer_load_dwordx4 v[156:159], v48, s[20:23], s45 offen sc1
    ds_read_b64_tr_b16 v[24:25], v50 offset:10240
    ds_read_b64_tr_b16 v[26:27], v50 offset:11264
    ds_read_b64_tr_b16 v[28:29], v51 offset:10240
    ds_read_b64_tr_b16 v[30:31], v51 offset:11264
    s_waitcnt vmcnt(22)
    s_waitcnt lgkmcnt(4)
    v_mfma_f32_32x32x16_bf16 v[64:79], v[16:19], v[160:163], v[64:79]
    v_mfma_f32_32x32x16_bf16 v[80:95], v[16:19], v[164:167], v[80:95]
    v_mfma_f32_32x32x16_bf16 v[96:111], v[20:23], v[160:163], v[96:111]
    v_mfma_f32_32x32x16_bf16 v[112:127], v[20:23], v[164:167], v[112:127]
    s_add_u32 m0, s40, 8192
    s_add_u32 s45, s41, 196608
    buffer_load_dwordx4 v49, s[84:87], s45 offen lds
    s_add_u32 m0, s40, 9216
    s_add_u32 s45, s41, 204800
    buffer_load_dwordx4 v49, s[84:87], s45 offen lds
    s_add_u32 s45, s42, 12288
    buffer_load_dwordx4 v[160:163], v48, s[20:23], s45 offen sc1
    s_add_u32 s45, s42, 126976
    buffer_load_dwordx4 v[164:167], v48, s[20:23], s45 offen sc1
    ds_read_b64_tr_b16 v[16:17], v50 offset:12288
    ds_read_b64_tr_b16 v[18:19], v50 offset:13312
    ds_read_b64_tr_b16 v[20:21], v51 offset:12288
    ds_read_b64_tr_b16 v[22:23], v51 offset:13312
    s_waitcnt vmcnt(24)
    s_waitcnt lgkmcnt(4)
    v_mfma_f32_32x32x16_bf16 v[64:79], v[24:27], v[168:171], v[64:79]
    v_mfma_f32_32x32x16_bf16 v[80:95], v[24:27], v[172:175], v[80:95]
    v_mfma_f32_32x32x16_bf16 v[96:111], v[28:31], v[168:171], v[96:111]
    v_mfma_f32_32x32x16_bf16 v[112:127], v[28:31], v[172:175], v[112:127]
    s_add_u32 m0, s40, 10240
    s_add_u32 s45, s41, 212992
    buffer_load_dwordx4 v49, s[84:87], s45 offen lds
    s_add_u32 m0, s40, 11264
    s_add_u32 s45, s41, 221184
    buffer_load_dwordx4 v49, s[84:87], s45 offen lds
    s_add_u32 s45, s42, 13312
    buffer_load_dwordx4 v[168:171], v48, s[20:23], s45 offen sc1
    s_add_u32 s45, s42, 128000
    buffer_load_dwordx4 v[172:175], v48, s[20:23], s45 offen sc1
    ds_read_b64_tr_b16 v[24:25], v50 offset:14336
    ds_read_b64_tr_b16 v[26:27], v50 offset:15360
    ds_read_b64_tr_b16 v[28:29], v51 offset:14336
    ds_read_b64_tr_b16 v[30:31], v51 offset:15360
    s_waitcnt vmcnt(26)
    s_waitcnt lgkmcnt(4)
    v_mfma_f32_32x32x16_bf16 v[64:79], v[16:19], v[176:179], v[64:79]
    v_mfma_f32_32x32x16_bf16 v[80:95], v[16:19], v[180:183], v[80:95]
    v_mfma_f32_32x32x16_bf16 v[96:111], v[20:23], v[176:179], v[96:111]
    v_mfma_f32_32x32x16_bf16 v[112:127], v[20:23], v[180:183], v[112:127]
    s_add_u32 m0, s40, 12288
    s_add_u32 s45, s41, 229376
    buffer_load_dwordx4 v49, s[84:87], s45 offen lds
    s_add_u32 m0, s40, 13312
    s_add_u32 s45, s41, 237568
    buffer_load_dwordx4 v49, s[84:87], s45 offen lds
    s_add_u32 s45, s42, 14336
    buffer_load_dwordx4 v[176:179], v48, s[20:23], s45 offen sc1
    s_add_u32 s45, s42, 129024
    buffer_load_dwordx4 v[180:183], v48, s[20:23], s45 offen sc1
    s_waitcnt vmcnt(26)
    ds_read_b64_tr_b16 v[16:17], v50 offset:0
    ds_read_b64_tr_b16 v[18:19], v50 offset:1024
    ds_read_b64_tr_b16 v[20:21], v51 offset:0
    ds_read_b64_tr_b16 v[22:23], v51 offset:1024
    s_waitcnt lgkmcnt(4)
    v_mfma_f32_32x32x16_bf16 v[64:79], v[24:27], v[184:187], v[64:79]
    v_mfma_f32_32x32x16_bf16 v[80:95], v[24:27], v[188:191], v[80:95]
    v_mfma_f32_32x32x16_bf16 v[96:111], v[28:31], v[184:187], v[96:111]
    v_mfma_f32_32x32x16_bf16 v[112:127], v[28:31], v[188:191], v[112:127]
    s_add_u32 m0, s40, 14336
    s_add_u32 s45, s41, 245760
    buffer_load_dwordx4 v49, s[84:87], s45 offen lds
    s_add_u32 m0, s40, 15360
    s_add_u32 s45, s41, 253952
    buffer_load_dwordx4 v49, s[84:87], s45 offen lds
    s_add_u32 s45, s42, 15360
    buffer_load_dwordx4 v[184:187], v48, s[20:23], s45 offen sc1
    s_add_u32 s45, s42, 130048
    buffer_load_dwordx4 v[188:191], v48, s[20:23], s45 offen sc1
    s_waitcnt vmcnt(26)
    ds_read_b64_tr_b16 v[24:25], v50 offset:2048
    ds_read_b64_tr_b16 v[26:27], v50 offset:3072
    ds_read_b64_tr_b16 v[28:29], v51 offset:2048
    ds_read_b64_tr_b16 v[30:31], v51 offset:3072
    s_waitcnt lgkmcnt(4)
    v_mfma_f32_32x32x16_bf16 v[64:79], v[16:19], v[128:131], v[64:79]
    v_mfma_f32_32x32x16_bf16 v[80:95], v[16:19], v[132:135], v[80:95]
    v_mfma_f32_32x32x16_bf16 v[96:111], v[20:23], v[128:131], v[96:111]
    v_mfma_f32_32x32x16_bf16 v[112:127], v[20:23], v[132:135], v[112:127]
    s_add_u32 m0, s40, 0
    s_add_u32 s45, s41, 262144
    buffer_load_dwordx4 v49, s[84:87], s45 offen lds
    s_add_u32 m0, s40, 1024
    s_add_u32 s45, s41, 270336
    buffer_load_dwordx4 v49, s[84:87], s45 offen lds
    s_add_u32 s45, s42, 16384
    buffer_load_dwordx4 v[128:131], v48, s[20:23], s45 offen sc1
    s_add_u32 s45, s42, 131072
    buffer_load_dwordx4 v[132:135], v48, s[20:23], s45 offen sc1
    s_waitcnt vmcnt(26)
    ds_read_b64_tr_b16 v[16:17], v50 offset:4096
    ds_read_b64_tr_b16 v[18:19], v50 offset:5120
    ds_read_b64_tr_b16 v[20:21], v51 offset:4096
    ds_read_b64_tr_b16 v[22:23], v51 offset:5120
    s_waitcnt lgkmcnt(4)
    v_mfma_f32_32x32x16_bf16 v[64:79], v[24:27], v[136:139], v[64:79]
    v_mfma_f32_32x32x16_bf16 v[80:95], v[24:27], v[140:143], v[80:95]
    v_mfma_f32_32x32x16_bf16 v[96:111], v[28:31], v[136:139], v[96:111]
    v_mfma_f32_32x32x16_bf16 v[112:127], v[28:31], v[140:143], v[112:127]
    s_add_u32 m0, s40, 2048
    s_add_u32 s45, s41, 278528
    buffer_load_dwordx4 v49, s[84:87], s45 offen lds
    s_add_u32 m0, s40, 3072
    s_add_u32 s45, s41, 286720
    buffer_load_dwordx4 v49, s[84:87], s45 offen lds
    s_add_u32 s45, s42, 17408
    buffer_load_dwordx4 v[136:139], v48, s[20:23], s45 offen sc1
    s_add_u32 s45, s42, 132096
    buffer_load_dwordx4 v[140:143], v48, s[20:23], s45 offen sc1
    s_waitcnt vmcnt(26)
    ds_read_b64_tr_b16 v[24:25], v50 offset:6144
    ds_read_b64_tr_b16 v[26:27], v50 offset:7168
    ds_read_b64_tr_b16 v[28:29], v51 offset:6144
    ds_read_b64_tr_b16 v[30:31], v51 offset:7168
    s_waitcnt lgkmcnt(4)
    v_mfma_f32_32x32x16_bf16 v[64:79], v[16:19], v[144:147], v[64:79]
    v_mfma_f32_32x32x16_bf16 v[80:95], v[16:19], v[148:151], v[80:95]
    v_mfma_f32_32x32x16_bf16 v[96:111], v[20:23], v[144:147], v[96:111]
    v_mfma_f32_32x32x16_bf16 v[112:127], v[20:23], v[148:151], v[112:127]
    s_add_u32 m0, s40, 4096
    s_add_u32 s45, s41, 294912
    buffer_load_dwordx4 v49, s[84:87], s45 offen lds
    s_add_u32 m0, s40, 5120
    s_add_u32 s45, s41, 303104
    buffer_load_dwordx4 v49, s[84:87], s45 offen lds
    s_add_u32 s45, s42, 18432
    buffer_load_dwordx4 v[144:147], v48, s[20:23], s45 offen sc1
    s_add_u32 s45, s42, 133120
    buffer_load_dwordx4 v[148:151], v48, s[20:23], s45 offen sc1
    s_waitcnt vmcnt(26)
    ds_read_b64_tr_b16 v[16:17], v50 offset:8192
    ds_read_b64_tr_b16 v[18:19], v50 offset:9216
    ds_read_b64_tr_b16 v[20:21], v51 offset:8192
    ds_read_b64_tr_b16 v[22:23], v51 offset:9216
    s_waitcnt lgkmcnt(4)
    v_mfma_f32_32x32x16_bf16 v[64:79], v[24:27], v[152:155], v[64:79]
    v_mfma_f32_32x32x16_bf16 v[80:95], v[24:27], v[156:159], v[80:95]
    v_mfma_f32_32x32x16_bf16 v[96:111], v[28:31], v[152:155], v[96:111]
    v_mfma_f32_32x32x16_bf16 v[112:127], v[28:31], v[156:159], v[112:127]
    s_add_u32 m0, s40, 6144
    s_add_u32 s45, s41, 311296
    buffer_load_dwordx4 v49, s[84:87], s45 offen lds
    s_add_u32 m0, s40, 7168
    s_add_u32 s45, s41, 319488
    buffer_load_dwordx4 v49, s[84:87], s45 offen lds
    s_add_u32 s45, s42, 19456
    buffer_load_dwordx4 v[152:155], v48, s[20:23], s45 offen sc1
    s_add_u32 s45, s42, 134144
    buffer_load_dwordx4 v[156:159], v48, s[20:23], s45 offen sc1
    s_waitcnt vmcnt(26)
    ds_read_b64_tr_b16 v[24:25], v50 offset:10240
    ds_read_b64_tr_b16 v[26:27], v50 offset:11264
    ds_read_b64_tr_b16 v[28:29], v51 offset:10240
    ds_read_b64_tr_b16 v[30:31], v51 offset:11264
    s_waitcnt lgkmcnt(4)
    v_mfma_f32_32x32x16_bf16 v[64:79], v[16:19], v[160:163], v[64:79]
    v_mfma_f32_32x32x16_bf16 v[80:95], v[16:19], v[164:167], v[80:95]
    v_mfma_f32_32x32x16_bf16 v[96:111], v[20:23], v[160:163], v[96:111]
    v_mfma_f32_32x32x16_bf16 v[112:127], v[20:23], v[164:167], v[112:127]
    s_add_u32 m0, s40, 8192
    s_add_u32 s45, s41, 327680
    buffer_load_dwordx4 v49, s[84:87], s45 offen lds
    s_add_u32 m0, s40, 9216
    s_add_u32 s45, s41, 335872
    buffer_load_dwordx4 v49, s[84:87], s45 offen lds
    s_add_u32 s45, s42, 20480
    buffer_load_dwordx4 v[160:163], v48, s[20:23], s45 offen sc1
    s_add_u32 s45, s42, 135168
    buffer_load_dwordx4 v[164:167], v48, s[20:23], s45 offen sc1
    s_waitcnt vmcnt(26)
    ds_read_b64_tr_b16 v[16:17], v50 offset:12288
    ds_read_b64_tr_b16 v[18:19], v50 offset:13312
    ds_read_b64_tr_b16 v[20:21], v51 offset:12288
    ds_read_b64_tr_b16 v[22:23], v51 offset:13312
    s_waitcnt lgkmcnt(4)
    v_mfma_f32_32x32x16_bf16 v[64:79], v[24:27], v[168:171], v[64:79]
    v_mfma_f32_32x32x16_bf16 v[80:95], v[24:27], v[172:175], v[80:95]
    v_mfma_f32_32x32x16_bf16 v[96:111], v[28:31], v[168:171], v[96:111]
    v_mfma_f32_32x32x16_bf16 v[112:127], v[28:31], v[172:175], v[112:127]
    s_add_u32 m0, s40, 10240
    s_add_u32 s45, s41, 344064
    buffer_load_dwordx4 v49, s[84:87], s45 offen lds
    s_add_u32 m0, s40, 11264
    s_add_u32 s45, s41, 352256
    buffer_load_dwordx4 v49, s[84:87], s45 offen lds
    s_add_u32 s45, s42, 21504
    buffer_load_dwordx4 v[168:171], v48, s[20:23], s45 offen sc1
    s_add_u32 s45, s42, 136192
    buffer_load_dwordx4 v[172:175], v48, s[20:23], s45 offen sc1
    s_waitcnt vmcnt(26)
    ds_read_b64_tr_b16 v[24:25], v50 offset:14336
    ds_read_b64_tr_b16 v[26:27], v50 offset:15360
    ds_read_b64_tr_b16 v[28:29], v51 offset:14336
    ds_read_b64_tr_b16 v[30:31], v51 offset:15360
    s_waitcnt lgkmcnt(4)
    v_mfma_f32_32x32x16_bf16 v[64:79], v[16:19], v[176:179], v[64:79]
    v_mfma_f32_32x32x16_bf16 v[80:95], v[16:19], v[180:183], v[80:95]
    v_mfma_f32_32x32x16_bf16 v[96:111], v[20:23], v[176:179], v[96:111]
    v_mfma_f32_32x32x16_bf16 v[112:127], v[20:23], v[180:183], v[112:127]
    s_add_u32 m0, s40, 12288
    s_add_u32 s45, s41, 360448
    buffer_load_dwordx4 v49, s[84:87], s45 offen lds
    s_add_u32 m0, s40, 13312
    s_add_u32 s45, s41, 368640
    buffer_load_dwordx4 v49, s[84:87], s45 offen lds
    s_add_u32 s45, s42, 22528
    buffer_load_dwordx4 v[176:179], v48, s[20:23], s45 offen sc1
    s_add_u32 s45, s42, 137216
    buffer_load_dwordx4 v[180:183], v48, s[20:23], s45 offen sc1
    s_waitcnt vmcnt(26)
    ds_read_b64_tr_b16 v[16:17], v50 offset:0
    ds_read_b64_tr_b16 v[18:19], v50 offset:1024
    ds_read_b64_tr_b16 v[20:21], v51 offset:0
    ds_read_b64_tr_b16 v[22:23], v51 offset:1024
    s_waitcnt lgkmcnt(4)
    v_mfma_f32_32x32x16_bf16 v[64:79], v[24:27], v[184:187], v[64:79]
    v_mfma_f32_32x32x16_bf16 v[80:95], v[24:27], v[188:191], v[80:95]
    v_mfma_f32_32x32x16_bf16 v[96:111], v[28:31], v[184:187], v[96:111]
    v_mfma_f32_32x32x16_bf16 v[112:127], v[28:31], v[188:191], v[112:127]
    s_add_u32 m0, s40, 14336
    s_add_u32 s45, s41, 376832
    buffer_load_dwordx4 v49, s[84:87], s45 offen lds
    s_add_u32 m0, s40, 15360
    s_add_u32 s45, s41, 385024
    buffer_load_dwordx4 v49, s[84:87], s45 offen lds
    s_add_u32 s45, s42, 23552
    buffer_load_dwordx4 v[184:187], v48, s[20:23], s45 offen sc1
    s_add_u32 s45, s42, 138240
    buffer_load_dwordx4 v[188:191], v48, s[20:23], s45 offen sc1
    s_waitcnt vmcnt(26)
    ds_read_b64_tr_b16 v[24:25], v50 offset:2048
    ds_read_b64_tr_b16 v[26:27], v50 offset:3072
    ds_read_b64_tr_b16 v[28:29], v51 offset:2048
    ds_read_b64_tr_b16 v[30:31], v51 offset:3072
    s_waitcnt lgkmcnt(4)
    v_mfma_f32_32x32x16_bf16 v[64:79], v[16:19], v[128:131], v[64:79]
    v_mfma_f32_32x32x16_bf16 v[80:95], v[16:19], v[132:135], v[80:95]
    v_mfma_f32_32x32x16_bf16 v[96:111], v[20:23], v[128:131], v[96:111]
    v_mfma_f32_32x32x16_bf16 v[112:127], v[20:23], v[132:135], v[112:127]
    s_add_u32 m0, s40, 0
    s_add_u32 s45, s41, 393216
    buffer_load_dwordx4 v49, s[84:87], s45 offen lds
    s_add_u32 m0, s40, 1024
    s_add_u32 s45, s41, 401408
    buffer_load_dwordx4 v49, s[84:87], s45 offen lds
    s_add_u32 s45, s42, 24576
    buffer_load_dwordx4 v[128:131], v48, s[20:23], s45 offen sc1
    s_add_u32 s45, s42, 139264
    buffer_load_dwordx4 v[132:135], v48, s[20:23], s45 offen sc1
    s_waitcnt vmcnt(26)
    ds_read_b64_tr_b16 v[16:17], v50 offset:4096
    ds_read_b64_tr_b16 v[18:19], v50 offset:5120
    ds_read_b64_tr_b16 v[20:21], v51 offset:4096
    ds_read_b64_tr_b16 v[22:23], v51 offset:5120
    s_waitcnt lgkmcnt(4)
    v_mfma_f32_32x32x16_bf16 v[64:79], v[24:27], v[136:139], v[64:79]
    v_mfma_f32_32x32x16_bf16 v[80:95], v[24:27], v[140:143], v[80:95]
    v_mfma_f32_32x32x16_bf16 v[96:111], v[28:31], v[136:139], v[96:111]
    v_mfma_f32_32x32x16_bf16 v[112:127], v[28:31], v[140:143], v[112:127]
    s_add_u32 m0, s40, 2048
    s_add_u32 s45, s41, 409600
    buffer_load_dwordx4 v49, s[84:87], s45 offen lds
    s_add_u32 m0, s40, 3072
    s_add_u32 s45, s41, 417792
    buffer_load_dwordx4 v49, s[84:87], s45 offen lds
    s_add_u32 s45, s42, 25600
    buffer_load_dwordx4 v[136:139], v48, s[20:23], s45 offen sc1
    s_add_u32 s45, s42, 140288
    buffer_load_dwordx4 v[140:143], v48, s[20:23], s45 offen sc1
    s_waitcnt vmcnt(26)
    ds_read_b64_tr_b16 v[24:25], v50 offset:6144
    ds_read_b64_tr_b16 v[26:27], v50 offset:7168
    ds_read_b64_tr_b16 v[28:29], v51 offset:6144
    ds_read_b64_tr_b16 v[30:31], v51 offset:7168
    s_waitcnt lgkmcnt(4)
    v_mfma_f32_32x32x16_bf16 v[64:79], v[16:19], v[144:147], v[64:79]
    v_mfma_f32_32x32x16_bf16 v[80:95], v[16:19], v[148:151], v[80:95]
    v_mfma_f32_32x32x16_bf16 v[96:111], v[20:23], v[144:147], v[96:111]
    v_mfma_f32_32x32x16_bf16 v[112:127], v[20:23], v[148:151], v[112:127]
    s_add_u32 m0, s40, 4096
    s_add_u32 s45, s41, 425984
    buffer_load_dwordx4 v49, s[84:87], s45 offen lds
    s_add_u32 m0, s40, 5120
    s_add_u32 s45, s41, 434176
    buffer_load_dwordx4 v49, s[84:87], s45 offen lds
    s_add_u32 s45, s42, 26624
    buffer_load_dwordx4 v[144:147], v48, s[20:23], s45 offen sc1
    s_add_u32 s45, s42, 141312
    buffer_load_dwordx4 v[148:151], v48, s[20:23], s45 offen sc1
    s_waitcnt vmcnt(26)
    ds_read_b64_tr_b16 v[16:17], v50 offset:8192
    ds_read_b64_tr_b16 v[18:19], v50 offset:9216
    ds_read_b64_tr_b16 v[20:21], v51 offset:8192
    ds_read_b64_tr_b16 v[22:23], v51 offset:9216
    s_waitcnt lgkmcnt(4)
    v_mfma_f32_32x32x16_bf16 v[64:79], v[24:27], v[152:155], v[64:79]
    v_mfma_f32_32x32x16_bf16 v[80:95], v[24:27], v[156:159], v[80:95]
    v_mfma_f32_32x32x16_bf16 v[96:111], v[28:31], v[152:155], v[96:111]
    v_mfma_f32_32x32x16_bf16 v[112:127], v[28:31], v[156:159], v[112:127]
    s_add_u32 m0, s40, 6144
    s_add_u32 s45, s41, 442368
    buffer_load_dwordx4 v49, s[84:87], s45 offen lds
    s_add_u32 m0, s40, 7168
    s_add_u32 s45, s41, 450560
    buffer_load_dwordx4 v49, s[84:87], s45 offen lds
    s_add_u32 s45, s42, 27648
    buffer_load_dwordx4 v[152:155], v48, s[20:23], s45 offen sc1
    s_add_u32 s45, s42, 142336
    buffer_load_dwordx4 v[156:159], v48, s[20:23], s45 offen sc1
    s_waitcnt vmcnt(26)
    ds_read_b64_tr_b16 v[24:25], v50 offset:10240
    ds_read_b64_tr_b16 v[26:27], v50 offset:11264
    ds_read_b64_tr_b16 v[28:29], v51 offset:10240
    ds_read_b64_tr_b16 v[30:31], v51 offset:11264
    s_waitcnt lgkmcnt(4)
    v_mfma_f32_32x32x16_bf16 v[64:79], v[16:19], v[160:163], v[64:79]
    v_mfma_f32_32x32x16_bf16 v[80:95], v[16:19], v[164:167], v[80:95]
    v_mfma_f32_32x32x16_bf16 v[96:111], v[20:23], v[160:163], v[96:111]
    v_mfma_f32_32x32x16_bf16 v[112:127], v[20:23], v[164:167], v[112:127]
    s_add_u32 m0, s40, 8192
    s_add_u32 s45, s43, 0
    buffer_load_dwordx4 v49, s[88:91], s45 offen lds
    s_add_u32 m0, s40, 9216
    s_add_u32 s45, s43, 8192
    buffer_load_dwordx4 v49, s[88:91], s45 offen lds
    s_waitcnt vmcnt(24)
    ds_read_b64_tr_b16 v[16:17], v50 offset:12288
    ds_read_b64_tr_b16 v[18:19], v50 offset:13312
    ds_read_b64_tr_b16 v[20:21], v51 offset:12288
    ds_read_b64_tr_b16 v[22:23], v51 offset:13312
    s_waitcnt lgkmcnt(4)
    v_mfma_f32_32x32x16_bf16 v[64:79], v[24:27], v[168:171], v[64:79]
    v_mfma_f32_32x32x16_bf16 v[80:95], v[24:27], v[172:175], v[80:95]
    v_mfma_f32_32x32x16_bf16 v[96:111], v[28:31], v[168:171], v[96:111]
    v_mfma_f32_32x32x16_bf16 v[112:127], v[28:31], v[172:175], v[112:127]
    s_add_u32 m0, s40, 10240
    s_add_u32 s45, s43, 16384
    buffer_load_dwordx4 v49, s[88:91], s45 offen lds
    s_add_u32 m0, s40, 11264
    s_add_u32 s45, s43, 24576
    buffer_load_dwordx4 v49, s[88:91], s45 offen lds
    s_waitcnt vmcnt(22)
    ds_read_b64_tr_b16 v[24:25], v50 offset:14336
    ds_read_b64_tr_b16 v[26:27], v50 offset:15360
    ds_read_b64_tr_b16 v[28:29], v51 offset:14336
    ds_read_b64_tr_b16 v[30:31], v51 offset:15360
    s_waitcnt lgkmcnt(4)
    v_mfma_f32_32x32x16_bf16 v[64:79], v[16:19], v[176:179], v[64:79]
    v_mfma_f32_32x32x16_bf16 v[80:95], v[16:19], v[180:183], v[80:95]
    v_mfma_f32_32x32x16_bf16 v[96:111], v[20:23], v[176:179], v[96:111]
    v_mfma_f32_32x32x16_bf16 v[112:127], v[20:23], v[180:183], v[112:127]
    s_add_u32 m0, s40, 12288
    s_add_u32 s45, s43, 32768
    buffer_load_dwordx4 v49, s[88:91], s45 offen lds
    s_add_u32 m0, s40, 13312
    s_add_u32 s45, s43, 40960
    buffer_load_dwordx4 v49, s[88:91], s45 offen lds
    s_waitcnt vmcnt(20)
    ds_read_b64_tr_b16 v[16:17], v50 offset:0
    ds_read_b64_tr_b16 v[18:19], v50 offset:1024
    ds_read_b64_tr_b16 v[20:21], v51 offset:0
    ds_read_b64_tr_b16 v[22:23], v51 offset:1024
    s_waitcnt lgkmcnt(4)
    v_mfma_f32_32x32x16_bf16 v[64:79], v[24:27], v[184:187], v[64:79]
    v_mfma_f32_32x32x16_bf16 v[80:95], v[24:27], v[188:191], v[80:95]
    v_mfma_f32_32x32x16_bf16 v[96:111], v[28:31], v[184:187], v[96:111]
    v_mfma_f32_32x32x16_bf16 v[112:127], v[28:31], v[188:191], v[112:127]
    s_add_u32 m0, s40, 14336
    s_add_u32 s45, s43, 49152
    buffer_load_dwordx4 v49, s[88:91], s45 offen lds
    s_add_u32 m0, s40, 15360
    s_add_u32 s45, s43, 57344
    buffer_load_dwordx4 v49, s[88:91], s45 offen lds
    s_waitcnt vmcnt(18)
    ds_read_b64_tr_b16 v[24:25], v50 offset:2048
    ds_read_b64_tr_b16 v[26:27], v50 offset:3072
    ds_read_b64_tr_b16 v[28:29], v51 offset:2048
    ds_read_b64_tr_b16 v[30:31], v51 offset:3072
    s_waitcnt lgkmcnt(4)
    v_mfma_f32_32x32x16_bf16 v[64:79], v[16:19], v[128:131], v[64:79]
    v_mfma_f32_32x32x16_bf16 v[80:95], v[16:19], v[132:135], v[80:95]
    v_mfma_f32_32x32x16_bf16 v[96:111], v[20:23], v[128:131], v[96:111]
    v_mfma_f32_32x32x16_bf16 v[112:127], v[20:23], v[132:135], v[112:127]
    s_add_u32 m0, s40, 0
    s_add_u32 s45, s43, 65536
    buffer_load_dwordx4 v49, s[88:91], s45 offen lds
    s_add_u32 m0, s40, 1024
    s_add_u32 s45, s43, 73728
    buffer_load_dwordx4 v49, s[88:91], s45 offen lds
    s_waitcnt vmcnt(16)
    ds_read_b64_tr_b16 v[16:17], v50 offset:4096
    ds_read_b64_tr_b16 v[18:19], v50 offset:5120
    ds_read_b64_tr_b16 v[20:21], v51 offset:4096
    ds_read_b64_tr_b16 v[22:23], v51 offset:5120
    s_waitcnt lgkmcnt(4)
    v_mfma_f32_32x32x16_bf16 v[64:79], v[24:27], v[136:139], v[64:79]
    v_mfma_f32_32x32x16_bf16 v[80:95], v[24:27], v[140:143], v[80:95]
    v_mfma_f32_32x32x16_bf16 v[96:111], v[28:31], v[136:139], v[96:111]
    v_mfma_f32_32x32x16_bf16 v[112:127], v[28:31], v[140:143], v[112:127]
    s_add_u32 m0, s40, 2048
    s_add_u32 s45, s43, 81920
    buffer_load_dwordx4 v49, s[88:91], s45 offen lds
    s_add_u32 m0, s40, 3072
    s_add_u32 s45, s43, 90112
    buffer_load_dwordx4 v49, s[88:91], s45 offen lds
    s_waitcnt vmcnt(14)
    ds_read_b64_tr_b16 v[24:25], v50 offset:6144
    ds_read_b64_tr_b16 v[26:27], v50 offset:7168
    ds_read_b64_tr_b16 v[28:29], v51 offset:6144
    ds_read_b64_tr_b16 v[30:31], v51 offset:7168
    s_waitcnt lgkmcnt(4)
    v_mfma_f32_32x32x16_bf16 v[64:79], v[16:19], v[144:147], v[64:79]
    v_mfma_f32_32x32x16_bf16 v[80:95], v[16:19], v[148:151], v[80:95]
    v_mfma_f32_32x32x16_bf16 v[96:111], v[20:23], v[144:147], v[96:111]
    v_mfma_f32_32x32x16_bf16 v[112:127], v[20:23], v[148:151], v[112:127]
    s_add_u32 m0, s40, 4096
    s_add_u32 s45, s43, 98304
    buffer_load_dwordx4 v49, s[88:91], s45 offen lds
    s_add_u32 m0, s40, 5120
    s_add_u32 s45, s43, 106496
    buffer_load_dwordx4 v49, s[88:91], s45 offen lds
    s_waitcnt vmcnt(14)
    s_waitcnt lgkmcnt(0)
    v_mfma_f32_32x32x16_bf16 v[64:79], v[24:27], v[152:155], v[64:79]
    v_mfma_f32_32x32x16_bf16 v[80:95], v[24:27], v[156:159], v[80:95]
    v_mfma_f32_32x32x16_bf16 v[96:111], v[28:31], v[152:155], v[96:111]
    v_mfma_f32_32x32x16_bf16 v[112:127], v[28:31], v[156:159], v[112:127]
    s_add_u32 m0, s40, 6144
    s_add_u32 s45, s43, 114688
    buffer_load_dwordx4 v49, s[88:91], s45 offen lds
    s_add_u32 m0, s40, 7168
    s_add_u32 s45, s43, 122880
    buffer_load_dwordx4 v49, s[88:91], s45 offen lds
    s_waitcnt vmcnt(14)
    ds_read_b64_tr_b16 v[192:193], v50 offset:8192
    ds_read_b64_tr_b16 v[194:195], v50 offset:9216
    ds_read_b64_tr_b16 v[196:197], v51 offset:8192
    ds_read_b64_tr_b16 v[198:199], v51 offset:9216
    s_waitcnt vmcnt(12)
    ds_read_b64_tr_b16 v[200:201], v50 offset:10240
    ds_read_b64_tr_b16 v[202:203], v50 offset:11264
    ds_read_b64_tr_b16 v[204:205], v51 offset:10240
    ds_read_b64_tr_b16 v[206:207], v51 offset:11264
    s_waitcnt vmcnt(10)
    ds_read_b64_tr_b16 v[208:209], v50 offset:12288
    ds_read_b64_tr_b16 v[210:211], v50 offset:13312
    ds_read_b64_tr_b16 v[212:213], v51 offset:12288
    ds_read_b64_tr_b16 v[214:215], v51 offset:13312
    s_waitcnt vmcnt(8)
    ds_read_b64_tr_b16 v[216:217], v50 offset:14336
    ds_read_b64_tr_b16 v[218:219], v50 offset:15360
    ds_read_b64_tr_b16 v[220:221], v51 offset:14336
    ds_read_b64_tr_b16 v[222:223], v51 offset:15360
    s_waitcnt vmcnt(6)
    ds_read_b64_tr_b16 v[224:225], v50 offset:0
    ds_read_b64_tr_b16 v[226:227], v50 offset:1024
    ds_read_b64_tr_b16 v[228:229], v51 offset:0
    ds_read_b64_tr_b16 v[230:231], v51 offset:1024
    s_waitcnt vmcnt(4)
    ds_read_b64_tr_b16 v[232:233], v50 offset:2048
    ds_read_b64_tr_b16 v[234:235], v50 offset:3072
    ds_read_b64_tr_b16 v[236:237], v51 offset:2048
    ds_read_b64_tr_b16 v[238:239], v51 offset:3072
    s_waitcnt vmcnt(2)
    ds_read_b64_tr_b16 v[240:241], v50 offset:4096
    ds_read_b64_tr_b16 v[242:243], v50 offset:5120
    ds_read_b64_tr_b16 v[244:245], v51 offset:4096
    ds_read_b64_tr_b16 v[246:247], v51 offset:5120
    s_waitcnt vmcnt(0)
    ds_read_b64_tr_b16 v[248:249], v50 offset:6144
    ds_read_b64_tr_b16 v[250:251], v50 offset:7168
    ds_read_b64_tr_b16 v[252:253], v51 offset:6144
    ds_read_b64_tr_b16 v[254:255], v51 offset:7168
    s_waitcnt lgkmcnt(0)
    s_nop 7
    s_barrier
    v_and_b32 v4, 31, v1
    v_mul_u32_u24 v4, 272, v4
    v_lshrrev_b32 v5, 5, v1
    v_lshl_add_u32 v4, v5, 4, v4
    s_mul_i32 s48, s24, 17408
    v_add_u32 v4, s48, v4
    s_nop 3
    ds_write_b128 v4, v[64:67] offset:0
    ds_write_b128 v4, v[68:71] offset:32
    ds_write_b128 v4, v[72:75] offset:64
    ds_write_b128 v4, v[76:79] offset:96
    ds_write_b128 v4, v[80:83] offset:8704
    ds_write_b128 v4, v[84:87] offset:8736
    ds_write_b128 v4, v[88:91] offset:8768
    ds_write_b128 v4, v[92:95] offset:8800
    ds_write_b128 v4, v[96:99] offset:128
    ds_write_b128 v4, v[100:103] offset:160
    ds_write_b128 v4, v[104:107] offset:192
    ds_write_b128 v4, v[108:111] offset:224
    ds_write_b128 v4, v[112:115] offset:8832
    ds_write_b128 v4, v[116:119] offset:8864
    ds_write_b128 v4, v[120:123] offset:8896
    ds_write_b128 v4, v[124:127] offset:8928
    v_lshrrev_b32 v6, 3, v0
    v_mul_u32_u24 v6, 272, v6
    v_and_b32 v5, 7, v0
    v_lshl_add_u32 v6, v5, 5, v6
    s_waitcnt lgkmcnt(0)
    s_barrier
    ds_read_b128 v[64:67], v6 offset:0
    ds_read_b128 v[68:71], v6 offset:16
    ds_read_b128 v[72:75], v6 offset:17408
    ds_read_b128 v[76:79], v6 offset:17424
    ds_read_b128 v[80:83], v6 offset:34816
    ds_read_b128 v[84:87], v6 offset:34832
    ds_read_b128 v[88:91], v6 offset:52224
    ds_read_b128 v[92:95], v6 offset:52240
    ds_read_b128 v[96:99], v6 offset:8704
    ds_read_b128 v[100:103], v6 offset:8720
    ds_read_b128 v[104:107], v6 offset:26112
    ds_read_b128 v[108:111], v6 offset:26128
    ds_read_b128 v[112:115], v6 offset:43520
    ds_read_b128 v[116:119], v6 offset:43536
    ds_read_b128 v[120:123], v6 offset:60928
    ds_read_b128 v[124:127], v6 offset:60944
    s_waitcnt lgkmcnt(8)
    v_add_f32 v64, v64, v72
    v_add_f32 v80, v80, v88
    v_add_f32 v65, v65, v73
    v_add_f32 v81, v81, v89
    v_add_f32 v66, v66, v74
    v_add_f32 v82, v82, v90
    v_add_f32 v67, v67, v75
    v_add_f32 v83, v83, v91
    v_add_f32 v68, v68, v76
    v_add_f32 v84, v84, v92
    v_add_f32 v69, v69, v77
    v_add_f32 v85, v85, v93
    v_add_f32 v70, v70, v78
    v_add_f32 v86, v86, v94
    v_add_f32 v71, v71, v79
    v_add_f32 v87, v87, v95
    v_lshlrev_b32 v72, 16, v40
    v_and_b32 v73, 0xffff0000, v40
    v_lshlrev_b32 v74, 16, v41
    v_and_b32 v75, 0xffff0000, v41
    v_lshlrev_b32 v76, 16, v42
    v_and_b32 v77, 0xffff0000, v42
    v_lshlrev_b32 v78, 16, v43
    v_and_b32 v79, 0xffff0000, v43
    v_add_f32 v64, v64, v80
    v_add_f32 v65, v65, v81
    v_add_f32 v66, v66, v82
    v_add_f32 v67, v67, v83
    v_add_f32 v68, v68, v84
    v_add_f32 v69, v69, v85
    v_add_f32 v70, v70, v86
    v_add_f32 v71, v71, v87
    v_add_f32 v32, v64, v72
    v_add_f32 v33, v65, v73
    v_add_f32 v34, v66, v74
    v_add_f32 v35, v67, v75
    v_add_f32 v36, v68, v76
    v_add_f32 v37, v69, v77
    v_add_f32 v38, v70, v78
    v_add_f32 v39, v71, v79
    s_waitcnt lgkmcnt(0)
    v_add_f32 v96, v96, v104
    v_add_f32 v112, v112, v120
    v_add_f32 v97, v97, v105
    v_add_f32 v113, v113, v121
    v_add_f32 v98, v98, v106
    v_add_f32 v114, v114, v122
    v_add_f32 v99, v99, v107
    v_add_f32 v115, v115, v123
    v_add_f32 v100, v100, v108
    v_add_f32 v116, v116, v124
    v_add_f32 v101, v101, v109
    v_add_f32 v117, v117, v125
    v_add_f32 v102, v102, v110
    v_add_f32 v118, v118, v126
    v_add_f32 v103, v103, v111
    v_add_f32 v119, v119, v127
    v_lshlrev_b32 v104, 16, v44
    v_and_b32 v105, 0xffff0000, v44
    v_lshlrev_b32 v106, 16, v45
    v_and_b32 v107, 0xffff0000, v45
    v_lshlrev_b32 v108, 16, v46
    v_and_b32 v109, 0xffff0000, v46
    v_lshlrev_b32 v110, 16, v47
    v_and_b32 v111, 0xffff0000, v47
    v_add_f32 v96, v96, v112
    v_add_f32 v97, v97, v113
    v_add_f32 v98, v98, v114
    v_add_f32 v99, v99, v115
    v_add_f32 v100, v100, v116
    v_add_f32 v101, v101, v117
    v_add_f32 v102, v102, v118
    v_add_f32 v103, v103, v119
    v_add_f32 v40, v96, v104
    v_add_f32 v41, v97, v105
    v_add_f32 v42, v98, v106
    v_add_f32 v43, v99, v107
    v_add_f32 v44, v100, v108
    v_add_f32 v45, v101, v109
    v_add_f32 v46, v102, v110
    v_add_f32 v47, v103, v111
    s_barrier
    s_mov_b32 s50, 0
    v_add_u32 v55, 0x2000, v54
    s_mov_b32 s49, 0
L_f1_fused_ker_psp_36:
    buffer_load_dwordx2 v[58:59], v55, s[20:23], 0 offen sc1
    s_add_u32 s49, s49, 1
    s_waitcnt vmcnt(0)
    v_cmp_eq_u64 vcc, s[58:59], v[58:59]
    s_nop 3
    s_cmp_eq_u64 vcc, -1
    s_cbranch_scc1 L_f1_fused_ker_pspc_37
    s_sleep 1
    s_cmp_lt_u32 s49, 0x4000
    s_cbranch_scc1 L_f1_fused_ker_psp_36
L_f1_fused_ker_pspc_37:
    s_add_u32 s45, s44, 0
    buffer_load_dwordx4 v[160:163], v48, s[20:23], s45 offen sc1
    s_add_u32 s45, s44, 32768
    buffer_load_dwordx4 v[164:167], v48, s[20:23], s45 offen sc1
    s_add_u32 s45, s44, 1024
    buffer_load_dwordx4 v[168:171], v48, s[20:23], s45 offen sc1
    s_add_u32 s45, s44, 33792
    buffer_load_dwordx4 v[172:175], v48, s[20:23], s45 offen sc1
    s_add_u32 s45, s44, 2048
    buffer_load_dwordx4 v[176:179], v48, s[20:23], s45 offen sc1
    s_add_u32 s45, s44, 34816
    buffer_load_dwordx4 v[180:183], v48, s[20:23], s45 offen sc1
    s_add_u32 s45, s44, 3072
    buffer_load_dwordx4 v[184:187], v48, s[20:23], s45 offen sc1
    s_add_u32 s45, s44, 35840
    buffer_load_dwordx4 v[188:191], v48, s[20:23], s45 offen sc1
    s_add_u32 s45, s44, 4096
    buffer_load_dwordx4 v[128:131], v48, s[20:23], s45 offen sc1
    s_add_u32 s45, s44, 36864
    buffer_load_dwordx4 v[132:135], v48, s[20:23], s45 offen sc1
    s_add_u32 s45, s44, 5120
    buffer_load_dwordx4 v[136:139], v48, s[20:23], s45 offen sc1
    s_add_u32 s45, s44, 37888
    buffer_load_dwordx4 v[140:143], v48, s[20:23], s45 offen sc1
    s_add_u32 s45, s44, 6144
    buffer_load_dwordx4 v[144:147], v48, s[20:23], s45 offen sc1
    s_add_u32 s45, s44, 38912
    buffer_load_dwordx4 v[148:151], v48, s[20:23], s45 offen sc1
    s_add_u32 s45, s44, 7168
    buffer_load_dwordx4 v[152:155], v48, s[20:23], s45 offen sc1
    s_add_u32 s45, s44, 39936
    buffer_load_dwordx4 v[156:159], v48, s[20:23], s45 offen sc1
L_f1_fused_ker_ochk_38:
    s_waitcnt vmcnt(14)
    v_max3_u32 v56, v160, v161, v162
    v_max3_u32 v56, v163, v164, v56
    v_max3_u32 v56, v165, v166, v56
    v_max_u32 v56, v167, v56
    v_cmp_eq_u32 vcc, -1, v56
    s_nop 3
    s_cmp_eq_u64 vcc, 0
    s_cbranch_scc0 L_f1_fused_ker_ore_40
L_f1_fused_ker_oacc_39:
    v_mfma_f32_32x32x16_bf16 v[64:79], v[192:195], v[160:163], 0
    v_mfma_f32_32x32x16_bf16 v[80:95], v[192:195], v[164:167], 0
    v_mfma_f32_32x32x16_bf16 v[96:111], v[196:199], v[160:163], 0
    v_mfma_f32_32x32x16_bf16 v[112:127], v[196:199], v[164:167], 0
L_f1_fused_ker_ochk_41:
    s_waitcnt vmcnt(12)
    v_max3_u32 v56, v168, v169, v170
    v_max3_u32 v56, v171, v172, v56
    v_max3_u32 v56, v173, v174, v56
    v_max_u32 v56, v175, v56
    v_cmp_eq_u32 vcc, -1, v56
    s_nop 3
    s_cmp_eq_u64 vcc, 0
    s_cbranch_scc0 L_f1_fused_ker_ore_43
L_f1_fused_ker_oacc_42:
    v_mfma_f32_32x32x16_bf16 v[64:79], v[200:203], v[168:171], v[64:79]
    v_mfma_f32_32x32x16_bf16 v[80:95], v[200:203], v[172:175], v[80:95]
    v_mfma_f32_32x32x16_bf16 v[96:111], v[204:207], v[168:171], v[96:111]
    v_mfma_f32_32x32x16_bf16 v[112:127], v[204:207], v[172:175], v[112:127]
L_f1_fused_ker_ochk_44:
    s_waitcnt vmcnt(10)
    v_max3_u32 v56, v176, v177, v178
    v_max3_u32 v56, v179, v180, v56
    v_max3_u32 v56, v181, v182, v56
    v_max_u32 v56, v183, v56
    v_cmp_eq_u32 vcc, -1, v56
    s_nop 3
    s_cmp_eq_u64 vcc, 0
    s_cbranch_scc0 L_f1_fused_ker_ore_46
L_f1_fused_ker_oacc_45:
    v_mfma_f32_32x32x16_bf16 v[64:79], v[208:211], v[176:179], v[64:79]
    v_mfma_f32_32x32x16_bf16 v[80:95], v[208:211], v[180:183], v[80:95]
    v_mfma_f32_32x32x16_bf16 v[96:111], v[212:215], v[176:179], v[96:111]
    v_mfma_f32_32x32x16_bf16 v[112:127], v[212:215], v[180:183], v[112:127]
L_f1_fused_ker_ochk_47:
    s_waitcnt vmcnt(8)
    v_max3_u32 v56, v184, v185, v186
    v_max3_u32 v56, v187, v188, v56
    v_max3_u32 v56, v189, v190, v56
    v_max_u32 v56, v191, v56
    v_cmp_eq_u32 vcc, -1, v56
    s_nop 3
    s_cmp_eq_u64 vcc, 0
    s_cbranch_scc0 L_f1_fused_ker_ore_49
L_f1_fused_ker_oacc_48:
    v_mfma_f32_32x32x16_bf16 v[64:79], v[216:219], v[184:187], v[64:79]
    v_mfma_f32_32x32x16_bf16 v[80:95], v[216:219], v[188:191], v[80:95]
    v_mfma_f32_32x32x16_bf16 v[96:111], v[220:223], v[184:187], v[96:111]
    v_mfma_f32_32x32x16_bf16 v[112:127], v[220:223], v[188:191], v[112:127]
L_f1_fused_ker_ochk_50:
    s_waitcnt vmcnt(6)
    v_max3_u32 v56, v128, v129, v130
    v_max3_u32 v56, v131, v132, v56
    v_max3_u32 v56, v133, v134, v56
    v_max_u32 v56, v135, v56
    v_cmp_eq_u32 vcc, -1, v56
    s_nop 3
    s_cmp_eq_u64 vcc, 0
    s_cbranch_scc0 L_f1_fused_ker_ore_52
L_f1_fused_ker_oacc_51:
    v_mfma_f32_32x32x16_bf16 v[64:79], v[224:227], v[128:131], v[64:79]
    v_mfma_f32_32x32x16_bf16 v[80:95], v[224:227], v[132:135], v[80:95]
    v_mfma_f32_32x32x16_bf16 v[96:111], v[228:231], v[128:131], v[96:111]
    v_mfma_f32_32x32x16_bf16 v[112:127], v[228:231], v[132:135], v[112:127]
L_f1_fused_ker_ochk_53:
    s_waitcnt vmcnt(4)
    v_max3_u32 v56, v136, v137, v138
    v_max3_u32 v56, v139, v140, v56
    v_max3_u32 v56, v141, v142, v56
    v_max_u32 v56, v143, v56
    v_cmp_eq_u32 vcc, -1, v56
    s_nop 3
    s_cmp_eq_u64 vcc, 0
    s_cbranch_scc0 L_f1_fused_ker_ore_55
L_f1_fused_ker_oacc_54:
    v_mfma_f32_32x32x16_bf16 v[64:79], v[232:235], v[136:139], v[64:79]
    v_mfma_f32_32x32x16_bf16 v[80:95], v[232:235], v[140:143], v[80:95]
    v_mfma_f32_32x32x16_bf16 v[96:111], v[236:239], v[136:139], v[96:111]
    v_mfma_f32_32x32x16_bf16 v[112:127], v[236:239], v[140:143], v[112:127]
L_f1_fused_ker_ochk_56:
    s_waitcnt vmcnt(2)
    v_max3_u32 v56, v144, v145, v146
    v_max3_u32 v56, v147, v148, v56
    v_max3_u32 v56, v149, v150, v56
    v_max_u32 v56, v151, v56
    v_cmp_eq_u32 vcc, -1, v56
    s_nop 3
    s_cmp_eq_u64 vcc, 0
    s_cbranch_scc0 L_f1_fused_ker_ore_58
L_f1_fused_ker_oacc_57:
    v_mfma_f32_32x32x16_bf16 v[64:79], v[240:243], v[144:147], v[64:79]
    v_mfma_f32_32x32x16_bf16 v[80:95], v[240:243], v[148:151], v[80:95]
    v_mfma_f32_32x32x16_bf16 v[96:111], v[244:247], v[144:147], v[96:111]
    v_mfma_f32_32x32x16_bf16 v[112:127], v[244:247], v[148:151], v[112:127]
L_f1_fused_ker_ochk_59:
    s_waitcnt vmcnt(0)
    v_max3_u32 v56, v152, v153, v154
    v_max3_u32 v56, v155, v156, v56
    v_max3_u32 v56, v157, v158, v56
    v_max_u32 v56, v159, v56
    v_cmp_eq_u32 vcc, -1, v56
    s_nop 3
    s_cmp_eq_u64 vcc, 0
    s_cbranch_scc0 L_f1_fused_ker_ore_61
L_f1_fused_ker_oacc_60:
    v_mfma_f32_32x32x16_bf16 v[64:79], v[248:251], v[152:155], v[64:79]
    v_mfma_f32_32x32x16_bf16 v[80:95], v[248:251], v[156:159], v[80:95]
    v_mfma_f32_32x32x16_bf16 v[96:111], v[252:255], v[152:155], v[96:111]
    v_mfma_f32_32x32x16_bf16 v[112:127], v[252:255], v[156:159], v[112:127]
L_f1_fused_ker_odone_35:
    s_nop 7
    v_and_b32 v4, 31, v1
    v_mul_u32_u24 v4, 272, v4
    v_lshrrev_b32 v5, 5, v1
    v_lshl_add_u32 v4, v5, 4, v4
    s_mul_i32 s48, s24, 17408
    v_add_u32 v4, s48, v4
    s_nop 3
    ds_write_b128 v4, v[64:67] offset:0
    ds_write_b128 v4, v[68:71] offset:32
    ds_write_b128 v4, v[72:75] offset:64
    ds_write_b128 v4, v[76:79] offset:96
    ds_write_b128 v4, v[80:83] offset:8704
    ds_write_b128 v4, v[84:87] offset:8736
    ds_write_b128 v4, v[88:91] offset:8768
    ds_write_b128 v4, v[92:95] offset:8800
    ds_write_b128 v4, v[96:99] offset:128
    ds_write_b128 v4, v[100:103] offset:160
    ds_write_b128 v4, v[104:107] offset:192
    ds_write_b128 v4, v[108:111] offset:224
    ds_write_b128 v4, v[112:115] offset:8832
    ds_write_b128 v4, v[116:119] offset:8864
    ds_write_b128 v4, v[120:123] offset:8896
    ds_write_b128 v4, v[124:127] offset:8928
    v_lshrrev_b32 v6, 3, v0
    v_mul_u32_u24 v6, 272, v6
    v_and_b32 v5, 7, v0
    v_lshl_add_u32 v6, v5, 5, v6
    s_waitcnt lgkmcnt(0)
    s_barrier
    ds_read_b128 v[64:67], v6 offset:0
    ds_read_b128 v[68:71], v6 offset:16
    ds_read_b128 v[72:75], v6 offset:17408
    ds_read_b128 v[76:79], v6 offset:17424
    ds_read_b128 v[80:83], v6 offset:34816
    ds_read_b128 v[84:87], v6 offset:34832
    ds_read_b128 v[88:91], v6 offset:52224
    ds_read_b128 v[92:95], v6 offset:52240
    ds_read_b128 v[96:99], v6 offset:8704
    ds_read_b128 v[100:103], v6 offset:8720
    ds_read_b128 v[104:107], v6 offset:26112
    ds_read_b128 v[108:111], v6 offset:26128
    ds_read_b128 v[112:115], v6 offset:43520
    ds_read_b128 v[116:119], v6 offset:43536
    ds_read_b128 v[120:123], v6 offset:60928
    ds_read_b128 v[124:127], v6 offset:60944
    s_waitcnt lgkmcnt(8)
    v_add_f32 v64, v64, v72
    v_add_f32 v80, v80, v88
    v_add_f32 v65, v65, v73
    v_add_f32 v81, v81, v89
    v_add_f32 v66, v66, v74
    v_add_f32 v82, v82, v90
    v_add_f32 v67, v67, v75
    v_add_f32 v83, v83, v91
    v_add_f32 v68, v68, v76
    v_add_f32 v84, v84, v92
    v_add_f32 v69, v69, v77
    v_add_f32 v85, v85, v93
    v_add_f32 v70, v70, v78
    v_add_f32 v86, v86, v94
    v_add_f32 v71, v71, v79
    v_add_f32 v87, v87, v95
    v_add_f32 v64, v64, v80
    v_add_f32 v65, v65, v81
    v_add_f32 v66, v66, v82
    v_add_f32 v67, v67, v83
    v_add_f32 v68, v68, v84
    v_add_f32 v69, v69, v85
    v_add_f32 v70, v70, v86
    v_add_f32 v71, v71, v87
    v_add_f32 v32, v32, v64
    v_add_f32 v33, v33, v65
    v_add_f32 v34, v34, v66
    v_add_f32 v35, v35, v67
    v_add_f32 v36, v36, v68
    v_add_f32 v37, v37, v69
    v_add_f32 v38, v38, v70
    v_add_f32 v39, v39, v71
    s_waitcnt lgkmcnt(0)
    v_add_f32 v96, v96, v104
    v_add_f32 v112, v112, v120
    v_add_f32 v97, v97, v105
    v_add_f32 v113, v113, v121
    v_add_f32 v98, v98, v106
    v_add_f32 v114, v114, v122
    v_add_f32 v99, v99, v107
    v_add_f32 v115, v115, v123
    v_add_f32 v100, v100, v108
    v_add_f32 v116, v116, v124
    v_add_f32 v101, v101, v109
    v_add_f32 v117, v117, v125
    v_add_f32 v102, v102, v110
    v_add_f32 v118, v118, v126
    v_add_f32 v103, v103, v111
    v_add_f32 v119, v119, v127
    v_add_f32 v96, v96, v112
    v_add_f32 v97, v97, v113
    v_add_f32 v98, v98, v114
    v_add_f32 v99, v99, v115
    v_add_f32 v100, v100, v116
    v_add_f32 v101, v101, v117
    v_add_f32 v102, v102, v118
    v_add_f32 v103, v103, v119
    v_add_f32 v40, v40, v96
    v_add_f32 v41, v41, v97
    v_add_f32 v42, v42, v98
    v_add_f32 v43, v43, v99
    v_add_f32 v44, v44, v100
    v_add_f32 v45, v45, v101
    v_add_f32 v46, v46, v102
    v_add_f32 v47, v47, v103
    v_cvt_pk_bf16_f32 v16, v32, v33
    v_cvt_pk_bf16_f32 v17, v34, v35
    v_cvt_pk_bf16_f32 v18, v36, v37
    v_cvt_pk_bf16_f32 v19, v38, v39
    v_cvt_pk_bf16_f32 v20, v40, v41
    v_cvt_pk_bf16_f32 v21, v42, v43
    v_cvt_pk_bf16_f32 v22, v44, v45
    v_cvt_pk_bf16_f32 v23, v46, v47
    buffer_store_dwordx4 v[16:19], v52, s[4:7], 0 offen sc1
    s_mov_b32 s45, 32768
    buffer_store_dwordx4 v[20:23], v52, s[4:7], s45 offen sc1
    s_waitcnt vmcnt(0)
    s_waitcnt vmcnt(0)
L_end_f1_fused_kernel:
    s_endpgm
L_e2_fb:
    s_lshl_b32 s33, s25, 16
    s_add_u32 s30, s33, 0x300000
    s_add_u32 s31, s33, 0x500000
    v_mov_b32 v10, 0xff800000
    v_mov_b32 v11, 0xff800000
    s_mov_b32 s36, 64
    s_mov_b32 s33, s30
L_e2_fb1:
    buffer_load_dwordx4 v[184:187], v2, s[20:23], s33 offen sc1
    s_waitcnt vmcnt(0)
    v_mfma_f32_32x32x16_bf16 v[64:79], v[184:187], v[176:179], 0
    v_mfma_f32_32x32x16_bf16 v[80:95], v[184:187], v[180:183], 0
    s_nop 11
    v_max3_f32 v10, v64, v65, v10
    v_max3_f32 v10, v66, v67, v10
    v_max3_f32 v10, v68, v69, v10
    v_max3_f32 v10, v70, v71, v10
    v_max3_f32 v10, v72, v73, v10
    v_max3_f32 v10, v74, v75, v10
    v_max3_f32 v10, v76, v77, v10
    v_max3_f32 v10, v78, v79, v10
    v_max3_f32 v11, v80, v81, v11
    v_max3_f32 v11, v82, v83, v11
    v_max3_f32 v11, v84, v85, v11
    v_max3_f32 v11, v86, v87, v11
    v_max3_f32 v11, v88, v89, v11
    v_max3_f32 v11, v90, v91, v11
    v_max3_f32 v11, v92, v93, v11
    v_max3_f32 v11, v94, v95, v11
    s_add_u32 s33, s33, 1024
    s_sub_u32 s36, s36, 1
    s_cmp_lg_u32 s36, 0
    s_cbranch_scc1 L_e2_fb1
    v_mov_b32 v12, v10
    v_mov_b32 v13, v11
    s_nop 1
    v_permlane32_swap_b32 v10, v12
    v_permlane32_swap_b32 v11, v13
    s_nop 1
    v_max_f32 v10, v10, v12
    v_max_f32 v11, v11, v13
    v_sub_f32 v10, 0, v10
    v_sub_f32 v11, 0, v11
    v_mov_b32 v128, v10
    v_mov_b32 v144, v11
    v_mov_b32 v96, 0
    v_mov_b32 v112, 0
    v_mov_b32 v129, v10
    v_mov_b32 v145, v11
    v_mov_b32 v97, 0
    v_mov_b32 v113, 0
    v_mov_b32 v130, v10
    v_mov_b32 v146, v11
    v_mov_b32 v98, 0
    v_mov_b32 v114, 0
    v_mov_b32 v131, v10
    v_mov_b32 v147, v11
    v_mov_b32 v99, 0
    v_mov_b32 v115, 0
    v_mov_b32 v132, v10
    v_mov_b32 v148, v11
    v_mov_b32 v100, 0
    v_mov_b32 v116, 0
    v_mov_b32 v133, v10
    v_mov_b32 v149, v11
    v_mov_b32 v101, 0
    v_mov_b32 v117, 0
    v_mov_b32 v134, v10
    v_mov_b32 v150, v11
    v_mov_b32 v102, 0
    v_mov_b32 v118, 0
    v_mov_b32 v135, v10
    v_mov_b32 v151, v11
    v_mov_b32 v103, 0
    v_mov_b32 v119, 0
    v_mov_b32 v136, v10
    v_mov_b32 v152, v11
    v_mov_b32 v104, 0
    v_mov_b32 v120, 0
    v_mov_b32 v137, v10
    v_mov_b32 v153, v11
    v_mov_b32 v105, 0
    v_mov_b32 v121, 0
    v_mov_b32 v138, v10
    v_mov_b32 v154, v11
    v_mov_b32 v106, 0
    v_mov_b32 v122, 0
    v_mov_b32 v139, v10
    v_mov_b32 v155, v11
    v_mov_b32 v107, 0
    v_mov_b32 v123, 0
    v_mov_b32 v140, v10
    v_mov_b32 v156, v11
    v_mov_b32 v108, 0
    v_mov_b32 v124, 0
    v_mov_b32 v141, v10
    v_mov_b32 v157, v11
    v_mov_b32 v109, 0
    v_mov_b32 v125, 0
    v_mov_b32 v142, v10
    v_mov_b32 v158, v11
    v_mov_b32 v110, 0
    v_mov_b32 v126, 0
    v_mov_b32 v143, v10
    v_mov_b32 v159, v11
    v_mov_b32 v111, 0
    v_mov_b32 v127, 0
    v_mov_b32 v192, 0x3f803f80
    v_mov_b32 v193, 0x3f803f80
    v_mov_b32 v194, 0x3f803f80
    v_mov_b32 v195, 0x3f803f80
    v_mov_b32 v196, 0x3f803f80
    v_mov_b32 v197, 0x3f803f80
    v_mov_b32 v198, 0x3f803f80
    v_mov_b32 v199, 0x3f803f80
    s_mov_b32 s36, 64
L_e2_fb2:
    buffer_load_dwordx4 v[184:187], v2, s[20:23], s30 offen sc1
    s_mov_b64 exec, s[28:29]
    buffer_load_dwordx4 v[192:195], v3, s[20:23], s31 offen sc1
    buffer_load_dwordx4 v[196:199], v3, s[20:23], s31 offen offset:512 sc1
    s_mov_b64 exec, -1
    s_waitcnt vmcnt(0)
    v_mfma_f32_32x32x16_bf16 v[64:79], v[184:187], v[176:179], v[128:143]
    v_mfma_f32_32x32x16_bf16 v[80:95], v[184:187], v[180:183], v[144:159]
    s_nop 11
    v_exp_f32 v64, v64
    v_exp_f32 v65, v65
    v_exp_f32 v66, v66
    v_exp_f32 v67, v67
    v_exp_f32 v68, v68
    v_exp_f32 v69, v69
    v_exp_f32 v70, v70
    v_exp_f32 v71, v71
    v_exp_f32 v72, v72
    v_exp_f32 v73, v73
    v_exp_f32 v74, v74
    v_exp_f32 v75, v75
    v_exp_f32 v76, v76
    v_exp_f32 v77, v77
    v_exp_f32 v78, v78
    v_exp_f32 v79, v79
    s_nop 0
    v_cvt_pk_bf16_f32 v160, v64, v65
    v_cvt_pk_bf16_f32 v161, v66, v67
    v_cvt_pk_bf16_f32 v162, v68, v69
    v_cvt_pk_bf16_f32 v163, v70, v71
    v_cvt_pk_bf16_f32 v164, v72, v73
    v_cvt_pk_bf16_f32 v165, v74, v75
    v_cvt_pk_bf16_f32 v166, v76, v77
    v_cvt_pk_bf16_f32 v167, v78, v79
    v_exp_f32 v80, v80
    v_exp_f32 v81, v81
    v_exp_f32 v82, v82
    v_exp_f32 v83, v83
    v_exp_f32 v84, v84
    v_exp_f32 v85, v85
    v_exp_f32 v86, v86
    v_exp_f32 v87, v87
    v_exp_f32 v88, v88
    v_exp_f32 v89, v89
    v_exp_f32 v90, v90
    v_exp_f32 v91, v91
    v_exp_f32 v92, v92
    v_exp_f32 v93, v93
    v_exp_f32 v94, v94
    v_exp_f32 v95, v95
    s_nop 0
    v_cvt_pk_bf16_f32 v168, v80, v81
    v_cvt_pk_bf16_f32 v169, v82, v83
    v_cvt_pk_bf16_f32 v170, v84, v85
    v_cvt_pk_bf16_f32 v171, v86, v87
    v_cvt_pk_bf16_f32 v172, v88, v89
    v_cvt_pk_bf16_f32 v173, v90, v91
    v_cvt_pk_bf16_f32 v174, v92, v93
    v_cvt_pk_bf16_f32 v175, v94, v95
    s_nop 1
    v_mfma_f32_32x32x16_bf16 v[96:111], v[192:195], v[160:163], v[96:111]
    v_mfma_f32_32x32x16_bf16 v[96:111], v[196:199], v[164:167], v[96:111]
    v_mfma_f32_32x32x16_bf16 v[112:127], v[192:195], v[168:171], v[112:127]
    v_mfma_f32_32x32x16_bf16 v[112:127], v[196:199], v[172:175], v[112:127]
    s_add_u32 s30, s30, 1024
    s_add_u32 s31, s31, 1024
    s_sub_u32 s36, s36, 1
    s_cmp_lg_u32 s36, 0
    s_cbranch_scc1 L_e2_fb2
    s_nop 11
    s_branch L_e2_fin
L_f1_fused_ker_eps_2:
    s_mov_b32 s54, 0
L_f1_fused_ker_eps_2_l:
    global_load_dwordx2 v[120:121], v122, s[56:57] sc1
    s_add_u32 s54, s54, 1
    s_waitcnt vmcnt(0)
    v_readfirstlane_b32 s58, v120
    v_readfirstlane_b32 s59, v121
    s_nop 3
    s_cmp_lg_u32 s58, 0
    s_cbranch_scc1 L_f1_fused_ker_epc_3
    s_sleep 2
    s_cmp_lt_u32 s54, 0x4000
    s_cbranch_scc1 L_f1_fused_ker_eps_2_l
    s_branch L_f1_fused_ker_epc_3
L_f1_fused_ker_x1s_4:
    s_mov_b32 s54, 0
L_f1_fused_ker_x1s_4_l:
    buffer_load_dwordx4 v[48:51], v117, s[20:23], 0 offen offset:0 sc1
    buffer_load_dwordx4 v[112:115], v117, s[20:23], 0 offen offset:16 sc1
    s_mov_b32 s36, 65536
    buffer_load_dwordx4 v[52:55], v118, s[20:23], s36 offen sc1
    s_mov_b32 s36, 73728
    buffer_load_dwordx4 v[56:59], v118, s[20:23], s36 offen sc1
    s_mov_b32 s36, 81920
    buffer_load_dwordx4 v[60:63], v118, s[20:23], s36 offen sc1
    s_add_u32 s54, s54, 1
    s_waitcnt vmcnt(0)
    v_cmp_eq_u32 vcc, s58, v51
    v_cmp_eq_u32 s[36:37], s58, v114
    s_nop 1
    s_and_b64 vcc, vcc, s[36:37]
    v_cmp_eq_u32 s[36:37], s58, v55
    s_nop 1
    s_and_b64 vcc, vcc, s[36:37]
    v_cmp_eq_u32 s[36:37], s58, v59
    s_nop 1
    s_and_b64 vcc, vcc, s[36:37]
    v_cmp_eq_u32 s[36:37], s58, v63
    s_nop 1
    s_and_b64 vcc, vcc, s[36:37]
    s_cmp_eq_u64 vcc, -1
    s_cbranch_scc1 L_f1_fused_ker_x1c_5
    s_sleep 16
    s_cmp_lt_u32 s54, 0x4000
    s_cbranch_scc1 L_f1_fused_ker_x1s_4_l
    s_branch L_f1_fused_ker_x1c_5
L_f1_fused_ker_eps_16:
    s_mov_b32 s54, 0
L_f1_fused_ker_eps_16_l:
    global_load_dwordx2 v[74:75], v76, s[56:57] sc1
    s_add_u32 s54, s54, 1
    s_waitcnt vmcnt(0)
    v_readfirstlane_b32 s58, v74
    v_readfirstlane_b32 s59, v75
    s_nop 3
    s_cmp_lg_u32 s58, 0
    s_cbranch_scc1 L_f1_fused_ker_epc_17
    s_sleep 2
    s_cmp_lt_u32 s54, 0x4000
    s_cbranch_scc1 L_f1_fused_ker_eps_16_l
    s_branch L_f1_fused_ker_epc_17
L_f1_fused_ker_eps_19:
    s_mov_b32 s54, 0
L_f1_fused_ker_eps_19_l:
    global_load_dwordx2 v[74:75], v76, s[56:57] sc1
    s_add_u32 s54, s54, 1
    s_waitcnt vmcnt(0)
    v_readfirstlane_b32 s58, v74
    v_readfirstlane_b32 s59, v75
    s_nop 3
    s_cmp_lg_u32 s58, 0
    s_cbranch_scc1 L_f1_fused_ker_epc_20
    s_sleep 2
    s_cmp_lt_u32 s54, 0x4000
    s_cbranch_scc1 L_f1_fused_ker_eps_19_l
    s_branch L_f1_fused_ker_epc_20
L_f1_fused_ker_eps_22:
    s_mov_b32 s54, 0
L_f1_fused_ker_eps_22_l:
    global_load_dwordx2 v[112:113], v114, s[56:57] sc1
    s_add_u32 s54, s54, 1
    s_waitcnt vmcnt(0)
    v_readfirstlane_b32 s58, v112
    v_readfirstlane_b32 s59, v113
    s_nop 3
    s_cmp_lg_u32 s58, 0
    s_cbranch_scc1 L_f1_fused_ker_epc_23
    s_sleep 2
    s_cmp_lt_u32 s54, 0x4000
    s_cbranch_scc1 L_f1_fused_ker_eps_22_l
    s_branch L_f1_fused_ker_epc_23
L_f1_fused_ker_x3s_24:
    s_mov_b32 s54, 0
L_f1_fused_ker_x3s_24_l:
    buffer_load_dwordx4 v[76:79], v108, s[20:23], 0 offen offset:0 sc1
    buffer_load_dwordx4 v[100:103], v108, s[20:23], 0 offen offset:16 sc1
    buffer_load_dwordx4 v[80:83], v108, s[20:23], 0 offen offset:1024 sc1
    buffer_load_dwordx4 v[104:107], v108, s[20:23], 0 offen offset:1040 sc1
    s_mov_b32 s36, 90112
    buffer_load_dwordx4 v[84:87], v109, s[20:23], s36 offen offset:0 sc1
    buffer_load_dwordx4 v[88:91], v109, s[20:23], s36 offen offset:512 sc1
    s_mov_b32 s36, 118784
    buffer_load_dwordx4 v[92:95], v109, s[20:23], s36 offen offset:0 sc1
    buffer_load_dwordx4 v[96:99], v109, s[20:23], s36 offen offset:512 sc1
    s_add_u32 s54, s54, 1
    s_waitcnt vmcnt(0)
    v_cmp_eq_u32 vcc, s58, v79
    v_cmp_eq_u32 s[36:37], s58, v83
    s_nop 1
    s_and_b64 vcc, vcc, s[36:37]
    v_cmp_eq_u32 s[36:37], s58, v87
    s_nop 1
    s_and_b64 vcc, vcc, s[36:37]
    v_cmp_eq_u32 s[36:37], s58, v91
    s_nop 1
    s_and_b64 vcc, vcc, s[36:37]
    v_cmp_eq_u32 s[36:37], s58, v95
    s_nop 1
    s_and_b64 vcc, vcc, s[36:37]
    v_cmp_eq_u32 s[36:37], s58, v99
    s_nop 1
    s_and_b64 vcc, vcc, s[36:37]
    v_cmp_eq_u32 s[36:37], s58, v102
    s_nop 1
    s_and_b64 vcc, vcc, s[36:37]
    v_cmp_eq_u32 s[36:37], s58, v106
    s_nop 1
    s_and_b64 vcc, vcc, s[36:37]
    s_cmp_eq_u64 vcc, -1
    s_cbranch_scc1 L_f1_fused_ker_x3c_25
    s_sleep 16
    s_cmp_lt_u32 s54, 0x4000
    s_cbranch_scc1 L_f1_fused_ker_x3s_24_l
    s_branch L_f1_fused_ker_x3c_25
L_f1_fused_ker_eps_26:
    s_mov_b32 s54, 0
L_f1_fused_ker_eps_26_l:
    global_load_dwordx2 v[112:113], v114, s[56:57] sc1
    s_add_u32 s54, s54, 1
    s_waitcnt vmcnt(0)
    v_readfirstlane_b32 s58, v112
    v_readfirstlane_b32 s59, v113
    s_nop 3
    s_cmp_lg_u32 s58, 0
    s_cbranch_scc1 L_f1_fused_ker_epc_27
    s_sleep 2
    s_cmp_lt_u32 s54, 0x4000
    s_cbranch_scc1 L_f1_fused_ker_eps_26_l
    s_branch L_f1_fused_ker_epc_27
L_f1_fused_ker_ore_40:
    s_add_u32 s50, s50, 1
    s_cmp_ge_u32 s50, 80
    s_cbranch_scc1 L_f1_fused_ker_oacc_39
    s_cmp_lg_u32 s50, 16
    s_cbranch_scc1 L_f1_fused_ker_orego_62
    s_mov_b32 s49, 0
L_f1_fused_ker_osp_63:
    buffer_load_dwordx2 v[58:59], v54, s[20:23], 0 offen sc1
    s_add_u32 s49, s49, 1
    s_waitcnt vmcnt(0)
    v_cmp_eq_u64 vcc, s[58:59], v[58:59]
    s_nop 3
    s_cmp_eq_u64 vcc, -1
    s_cbranch_scc1 L_f1_fused_ker_ospc_64
    s_sleep 1
    s_cmp_lt_u32 s49, 0x4000
    s_cbranch_scc1 L_f1_fused_ker_osp_63
L_f1_fused_ker_ospc_64:
L_f1_fused_ker_orego_62:
    s_add_u32 s45, s44, 0
    buffer_load_dwordx4 v[160:163], v48, s[20:23], s45 offen sc1
    s_add_u32 s45, s44, 32768
    buffer_load_dwordx4 v[164:167], v48, s[20:23], s45 offen sc1
    s_add_u32 s45, s44, 1024
    buffer_load_dwordx4 v[168:171], v48, s[20:23], s45 offen sc1
    s_add_u32 s45, s44, 33792
    buffer_load_dwordx4 v[172:175], v48, s[20:23], s45 offen sc1
    s_add_u32 s45, s44, 2048
    buffer_load_dwordx4 v[176:179], v48, s[20:23], s45 offen sc1
    s_add_u32 s45, s44, 34816
    buffer_load_dwordx4 v[180:183], v48, s[20:23], s45 offen sc1
    s_add_u32 s45, s44, 3072
    buffer_load_dwordx4 v[184:187], v48, s[20:23], s45 offen sc1
    s_add_u32 s45, s44, 35840
    buffer_load_dwordx4 v[188:191], v48, s[20:23], s45 offen sc1
    s_add_u32 s45, s44, 4096
    buffer_load_dwordx4 v[128:131], v48, s[20:23], s45 offen sc1
    s_add_u32 s45, s44, 36864
    buffer_load_dwordx4 v[132:135], v48, s[20:23], s45 offen sc1
    s_add_u32 s45, s44, 5120
    buffer_load_dwordx4 v[136:139], v48, s[20:23], s45 offen sc1
    s_add_u32 s45, s44, 37888
    buffer_load_dwordx4 v[140:143], v48, s[20:23], s45 offen sc1
    s_add_u32 s45, s44, 6144
    buffer_load_dwordx4 v[144:147], v48, s[20:23], s45 offen sc1
    s_add_u32 s45, s44, 38912
    buffer_load_dwordx4 v[148:151], v48, s[20:23], s45 offen sc1
    s_add_u32 s45, s44, 7168
    buffer_load_dwordx4 v[152:155], v48, s[20:23], s45 offen sc1
    s_add_u32 s45, s44, 39936
    buffer_load_dwordx4 v[156:159], v48, s[20:23], s45 offen sc1
    s_branch L_f1_fused_ker_ochk_38
L_f1_fused_ker_ore_43:
    s_add_u32 s50, s50, 1
    s_cmp_ge_u32 s50, 80
    s_cbranch_scc1 L_f1_fused_ker_oacc_42
    s_cmp_lg_u32 s50, 16
    s_cbranch_scc1 L_f1_fused_ker_orego_65
    s_mov_b32 s49, 0
L_f1_fused_ker_osp_66:
    buffer_load_dwordx2 v[58:59], v54, s[20:23], 0 offen sc1
    s_add_u32 s49, s49, 1
    s_waitcnt vmcnt(0)
    v_cmp_eq_u64 vcc, s[58:59], v[58:59]
    s_nop 3
    s_cmp_eq_u64 vcc, -1
    s_cbranch_scc1 L_f1_fused_ker_ospc_67
    s_sleep 1
    s_cmp_lt_u32 s49, 0x4000
    s_cbranch_scc1 L_f1_fused_ker_osp_66
L_f1_fused_ker_ospc_67:
L_f1_fused_ker_orego_65:
    s_add_u32 s45, s44, 1024
    buffer_load_dwordx4 v[168:171], v48, s[20:23], s45 offen sc1
    s_add_u32 s45, s44, 33792
    buffer_load_dwordx4 v[172:175], v48, s[20:23], s45 offen sc1
    s_add_u32 s45, s44, 2048
    buffer_load_dwordx4 v[176:179], v48, s[20:23], s45 offen sc1
    s_add_u32 s45, s44, 34816
    buffer_load_dwordx4 v[180:183], v48, s[20:23], s45 offen sc1
    s_add_u32 s45, s44, 3072
    buffer_load_dwordx4 v[184:187], v48, s[20:23], s45 offen sc1
    s_add_u32 s45, s44, 35840
    buffer_load_dwordx4 v[188:191], v48, s[20:23], s45 offen sc1
    s_add_u32 s45, s44, 4096
    buffer_load_dwordx4 v[128:131], v48, s[20:23], s45 offen sc1
    s_add_u32 s45, s44, 36864
    buffer_load_dwordx4 v[132:135], v48, s[20:23], s45 offen sc1
    s_add_u32 s45, s44, 5120
    buffer_load_dwordx4 v[136:139], v48, s[20:23], s45 offen sc1
    s_add_u32 s45, s44, 37888
    buffer_load_dwordx4 v[140:143], v48, s[20:23], s45 offen sc1
    s_add_u32 s45, s44, 6144
    buffer_load_dwordx4 v[144:147], v48, s[20:23], s45 offen sc1
    s_add_u32 s45, s44, 38912
    buffer_load_dwordx4 v[148:151], v48, s[20:23], s45 offen sc1
    s_add_u32 s45, s44, 7168
    buffer_load_dwordx4 v[152:155], v48, s[20:23], s45 offen sc1
    s_add_u32 s45, s44, 39936
    buffer_load_dwordx4 v[156:159], v48, s[20:23], s45 offen sc1
    s_branch L_f1_fused_ker_ochk_41
L_f1_fused_ker_ore_46:
    s_add_u32 s50, s50, 1
    s_cmp_ge_u32 s50, 80
    s_cbranch_scc1 L_f1_fused_ker_oacc_45
    s_cmp_lg_u32 s50, 16
    s_cbranch_scc1 L_f1_fused_ker_orego_68
    s_mov_b32 s49, 0
L_f1_fused_ker_osp_69:
    buffer_load_dwordx2 v[58:59], v54, s[20:23], 0 offen sc1
    s_add_u32 s49, s49, 1
    s_waitcnt vmcnt(0)
    v_cmp_eq_u64 vcc, s[58:59], v[58:59]
    s_nop 3
    s_cmp_eq_u64 vcc, -1
    s_cbranch_scc1 L_f1_fused_ker_ospc_70
    s_sleep 1
    s_cmp_lt_u32 s49, 0x4000
    s_cbranch_scc1 L_f1_fused_ker_osp_69
L_f1_fused_ker_ospc_70:
L_f1_fused_ker_orego_68:
    s_add_u32 s45, s44, 2048
    buffer_load_dwordx4 v[176:179], v48, s[20:23], s45 offen sc1
    s_add_u32 s45, s44, 34816
    buffer_load_dwordx4 v[180:183], v48, s[20:23], s45 offen sc1
    s_add_u32 s45, s44, 3072
    buffer_load_dwordx4 v[184:187], v48, s[20:23], s45 offen sc1
    s_add_u32 s45, s44, 35840
    buffer_load_dwordx4 v[188:191], v48, s[20:23], s45 offen sc1
    s_add_u32 s45, s44, 4096
    buffer_load_dwordx4 v[128:131], v48, s[20:23], s45 offen sc1
    s_add_u32 s45, s44, 36864
    buffer_load_dwordx4 v[132:135], v48, s[20:23], s45 offen sc1
    s_add_u32 s45, s44, 5120
    buffer_load_dwordx4 v[136:139], v48, s[20:23], s45 offen sc1
    s_add_u32 s45, s44, 37888
    buffer_load_dwordx4 v[140:143], v48, s[20:23], s45 offen sc1
    s_add_u32 s45, s44, 6144
    buffer_load_dwordx4 v[144:147], v48, s[20:23], s45 offen sc1
    s_add_u32 s45, s44, 38912
    buffer_load_dwordx4 v[148:151], v48, s[20:23], s45 offen sc1
    s_add_u32 s45, s44, 7168
    buffer_load_dwordx4 v[152:155], v48, s[20:23], s45 offen sc1
    s_add_u32 s45, s44, 39936
    buffer_load_dwordx4 v[156:159], v48, s[20:23], s45 offen sc1
    s_branch L_f1_fused_ker_ochk_44
L_f1_fused_ker_ore_49:
    s_add_u32 s50, s50, 1
    s_cmp_ge_u32 s50, 80
    s_cbranch_scc1 L_f1_fused_ker_oacc_48
    s_cmp_lg_u32 s50, 16
    s_cbranch_scc1 L_f1_fused_ker_orego_71
    s_mov_b32 s49, 0
L_f1_fused_ker_osp_72:
    buffer_load_dwordx2 v[58:59], v54, s[20:23], 0 offen sc1
    s_add_u32 s49, s49, 1
    s_waitcnt vmcnt(0)
    v_cmp_eq_u64 vcc, s[58:59], v[58:59]
    s_nop 3
    s_cmp_eq_u64 vcc, -1
    s_cbranch_scc1 L_f1_fused_ker_ospc_73
    s_sleep 1
    s_cmp_lt_u32 s49, 0x4000
    s_cbranch_scc1 L_f1_fused_ker_osp_72
L_f1_fused_ker_ospc_73:
L_f1_fused_ker_orego_71:
    s_add_u32 s45, s44, 3072
    buffer_load_dwordx4 v[184:187], v48, s[20:23], s45 offen sc1
    s_add_u32 s45, s44, 35840
    buffer_load_dwordx4 v[188:191], v48, s[20:23], s45 offen sc1
    s_add_u32 s45, s44, 4096
    buffer_load_dwordx4 v[128:131], v48, s[20:23], s45 offen sc1
    s_add_u32 s45, s44, 36864
    buffer_load_dwordx4 v[132:135], v48, s[20:23], s45 offen sc1
    s_add_u32 s45, s44, 5120
    buffer_load_dwordx4 v[136:139], v48, s[20:23], s45 offen sc1
    s_add_u32 s45, s44, 37888
    buffer_load_dwordx4 v[140:143], v48, s[20:23], s45 offen sc1
    s_add_u32 s45, s44, 6144
    buffer_load_dwordx4 v[144:147], v48, s[20:23], s45 offen sc1
    s_add_u32 s45, s44, 38912
    buffer_load_dwordx4 v[148:151], v48, s[20:23], s45 offen sc1
    s_add_u32 s45, s44, 7168
    buffer_load_dwordx4 v[152:155], v48, s[20:23], s45 offen sc1
    s_add_u32 s45, s44, 39936
    buffer_load_dwordx4 v[156:159], v48, s[20:23], s45 offen sc1
    s_branch L_f1_fused_ker_ochk_47
L_f1_fused_ker_ore_52:
    s_add_u32 s50, s50, 1
    s_cmp_ge_u32 s50, 80
    s_cbranch_scc1 L_f1_fused_ker_oacc_51
    s_cmp_lg_u32 s50, 16
    s_cbranch_scc1 L_f1_fused_ker_orego_74
    s_mov_b32 s49, 0
L_f1_fused_ker_osp_75:
    buffer_load_dwordx2 v[58:59], v54, s[20:23], 0 offen sc1
    s_add_u32 s49, s49, 1
    s_waitcnt vmcnt(0)
    v_cmp_eq_u64 vcc, s[58:59], v[58:59]
    s_nop 3
    s_cmp_eq_u64 vcc, -1
    s_cbranch_scc1 L_f1_fused_ker_ospc_76
    s_sleep 1
    s_cmp_lt_u32 s49, 0x4000
    s_cbranch_scc1 L_f1_fused_ker_osp_75
L_f1_fused_ker_ospc_76:
L_f1_fused_ker_orego_74:
    s_add_u32 s45, s44, 4096
    buffer_load_dwordx4 v[128:131], v48, s[20:23], s45 offen sc1
    s_add_u32 s45, s44, 36864
    buffer_load_dwordx4 v[132:135], v48, s[20:23], s45 offen sc1
    s_add_u32 s45, s44, 5120
    buffer_load_dwordx4 v[136:139], v48, s[20:23], s45 offen sc1
    s_add_u32 s45, s44, 37888
    buffer_load_dwordx4 v[140:143], v48, s[20:23], s45 offen sc1
    s_add_u32 s45, s44, 6144
    buffer_load_dwordx4 v[144:147], v48, s[20:23], s45 offen sc1
    s_add_u32 s45, s44, 38912
    buffer_load_dwordx4 v[148:151], v48, s[20:23], s45 offen sc1
    s_add_u32 s45, s44, 7168
    buffer_load_dwordx4 v[152:155], v48, s[20:23], s45 offen sc1
    s_add_u32 s45, s44, 39936
    buffer_load_dwordx4 v[156:159], v48, s[20:23], s45 offen sc1
    s_branch L_f1_fused_ker_ochk_50
L_f1_fused_ker_ore_55:
    s_add_u32 s50, s50, 1
    s_cmp_ge_u32 s50, 80
    s_cbranch_scc1 L_f1_fused_ker_oacc_54
    s_cmp_lg_u32 s50, 16
    s_cbranch_scc1 L_f1_fused_ker_orego_77
    s_mov_b32 s49, 0
L_f1_fused_ker_osp_78:
    buffer_load_dwordx2 v[58:59], v54, s[20:23], 0 offen sc1
    s_add_u32 s49, s49, 1
    s_waitcnt vmcnt(0)
    v_cmp_eq_u64 vcc, s[58:59], v[58:59]
    s_nop 3
    s_cmp_eq_u64 vcc, -1
    s_cbranch_scc1 L_f1_fused_ker_ospc_79
    s_sleep 1
    s_cmp_lt_u32 s49, 0x4000
    s_cbranch_scc1 L_f1_fused_ker_osp_78
L_f1_fused_ker_ospc_79:
L_f1_fused_ker_orego_77:
    s_add_u32 s45, s44, 5120
    buffer_load_dwordx4 v[136:139], v48, s[20:23], s45 offen sc1
    s_add_u32 s45, s44, 37888
    buffer_load_dwordx4 v[140:143], v48, s[20:23], s45 offen sc1
    s_add_u32 s45, s44, 6144
    buffer_load_dwordx4 v[144:147], v48, s[20:23], s45 offen sc1
    s_add_u32 s45, s44, 38912
    buffer_load_dwordx4 v[148:151], v48, s[20:23], s45 offen sc1
    s_add_u32 s45, s44, 7168
    buffer_load_dwordx4 v[152:155], v48, s[20:23], s45 offen sc1
    s_add_u32 s45, s44, 39936
    buffer_load_dwordx4 v[156:159], v48, s[20:23], s45 offen sc1
    s_branch L_f1_fused_ker_ochk_53
L_f1_fused_ker_ore_58:
    s_add_u32 s50, s50, 1
    s_cmp_ge_u32 s50, 80
    s_cbranch_scc1 L_f1_fused_ker_oacc_57
    s_cmp_lg_u32 s50, 16
    s_cbranch_scc1 L_f1_fused_ker_orego_80
    s_mov_b32 s49, 0
L_f1_fused_ker_osp_81:
    buffer_load_dwordx2 v[58:59], v54, s[20:23], 0 offen sc1
    s_add_u32 s49, s49, 1
    s_waitcnt vmcnt(0)
    v_cmp_eq_u64 vcc, s[58:59], v[58:59]
    s_nop 3
    s_cmp_eq_u64 vcc, -1
    s_cbranch_scc1 L_f1_fused_ker_ospc_82
    s_sleep 1
    s_cmp_lt_u32 s49, 0x4000
    s_cbranch_scc1 L_f1_fused_ker_osp_81
L_f1_fused_ker_ospc_82:
L_f1_fused_ker_orego_80:
    s_add_u32 s45, s44, 6144
    buffer_load_dwordx4 v[144:147], v48, s[20:23], s45 offen sc1
    s_add_u32 s45, s44, 38912
    buffer_load_dwordx4 v[148:151], v48, s[20:23], s45 offen sc1
    s_add_u32 s45, s44, 7168
    buffer_load_dwordx4 v[152:155], v48, s[20:23], s45 offen sc1
    s_add_u32 s45, s44, 39936
    buffer_load_dwordx4 v[156:159], v48, s[20:23], s45 offen sc1
    s_branch L_f1_fused_ker_ochk_56
L_f1_fused_ker_ore_61:
    s_add_u32 s50, s50, 1
    s_cmp_ge_u32 s50, 80
    s_cbranch_scc1 L_f1_fused_ker_oacc_60
    s_cmp_lg_u32 s50, 16
    s_cbranch_scc1 L_f1_fused_ker_orego_83
    s_mov_b32 s49, 0
L_f1_fused_ker_osp_84:
    buffer_load_dwordx2 v[58:59], v54, s[20:23], 0 offen sc1
    s_add_u32 s49, s49, 1
    s_waitcnt vmcnt(0)
    v_cmp_eq_u64 vcc, s[58:59], v[58:59]
    s_nop 3
    s_cmp_eq_u64 vcc, -1
    s_cbranch_scc1 L_f1_fused_ker_ospc_85
    s_sleep 1
    s_cmp_lt_u32 s49, 0x4000
    s_cbranch_scc1 L_f1_fused_ker_osp_84
L_f1_fused_ker_ospc_85:
L_f1_fused_ker_orego_83:
    s_add_u32 s45, s44, 7168
    buffer_load_dwordx4 v[152:155], v48, s[20:23], s45 offen sc1
    s_add_u32 s45, s44, 39936
    buffer_load_dwordx4 v[156:159], v48, s[20:23], s45 offen sc1
    s_branch L_f1_fused_ker_ochk_59
L_code_end:
    s_endpgm

.section .rodata,"a"
.p2align 6
.amdhsa_kernel f1_fused_kernel
  .amdhsa_next_free_vgpr 256
  .amdhsa_next_free_sgpr 102
  .amdhsa_accum_offset 256
  .amdhsa_group_segment_fixed_size 0
  .amdhsa_kernarg_size 80
  .amdhsa_user_sgpr_count 2
  .amdhsa_user_sgpr_kernarg_segment_ptr 1
  .amdhsa_system_sgpr_workgroup_id_x 1
.end_amdhsa_kernel
```
